```python
import torch

def _softmax(x, axis=-1):
    return torch.softmax(x, dim=axis)
def _gelu(x):
    return torch.nn.functional.gelu(x, approximate="tanh")
def _silu(x):
    return torch.nn.functional.silu(x)
def _sigmoid(x):
    return torch.sigmoid(x)
def _layernorm(x, axis=-1, eps=1e-5):
    m = x.mean(dim=axis, keepdim=True)
    v = x.var(dim=axis, keepdim=True, unbiased=False)
    return (x - m) / torch.sqrt(v + eps)
def _scatter_add(tgt, idx, src, axis=0):
    return tgt.clone().index_add_(axis, idx, src)
def _segment_sum(src, seg, n):
    out = torch.zeros((n,) + src.shape[1:], dtype=src.dtype)
    return out.index_add_(0, seg, src)
def _pad(x, pw):
    flat = tuple(v for pair in reversed(pw) for v in pair)
    return torch.nn.functional.pad(x, flat)

kernel_name = 'sequential_preLN__sliding_block__glu_gated_geglu__prompt'

def setup_inputs():

    _w = (lambda a: (lambda t: t.to(torch.bfloat16) if t.is_floating_point() else t)(torch.as_tensor(a)))
    def _A_setup():
        B, S, D = 1, 2048, 640
        return {
            "x": _w((lambda *s: torch.randn(*s, dtype=torch.bfloat16) * 0.05)(B, S, D)),
            "wqkv": _w((lambda *s: torch.randn(*s, dtype=torch.bfloat16) * 0.05)(D, 3 * D)),
            "wo": _w((lambda *s: torch.randn(*s, dtype=torch.bfloat16) * 0.05)(D, D)),
        }
    _A_in = _A_setup()

    def _B_setup():
        B, S, Dm, Df = 1, 2048, 640, 1536
        return {
            "x": _w((lambda *s: torch.randn(*s, dtype=torch.bfloat16) * 0.05)(B, S, Dm)),
            "w_gate": _w((lambda *s: torch.randn(*s, dtype=torch.bfloat16) * 0.8)(Dm, Df) * (Dm ** -0.5)),
            "w_up": _w((lambda *s: torch.randn(*s, dtype=torch.bfloat16) * 0.8)(Dm, Df) * (Dm ** -0.5)),
            "w_down": _w((lambda *s: torch.randn(*s, dtype=torch.bfloat16) * 0.8)(Df, Dm) * (Df ** -0.5)),
        }
    _B_in = _B_setup()

    return {
        "A_x": _A_in["x"],
        "A_wqkv": _A_in["wqkv"],
        "A_wo": _A_in["wo"],
        "B_x": _B_in["x"],
        "B_w_gate": _B_in["w_gate"],
        "B_w_up": _B_in["w_up"],
        "B_w_down": _B_in["w_down"],
    }

def reference(A_x, A_wqkv, A_wo, B_x, B_w_gate, B_w_up, B_w_down):
    def _A_ref(x, wqkv, wo):
        B, S, D = x.shape
        H = 32; Dh = D // H; W = 256
        qkv = (lambda x, *d: x.permute(*d))((x @ wqkv).reshape(B, S, 3, H, Dh), 2, 0, 3, 1, 4)
        q, k, v = qkv[0], qkv[1], qkv[2]
        scores = torch.einsum("bhqd,bhkd->bhqk", q, k) * (Dh ** -0.5)
        idx = torch.arange(S)
        mask = (idx[:, None] - idx[None, :] >= 0) & (idx[:, None] - idx[None, :] < W)
        scores = torch.where(mask[None, None], scores, -1e9)
        p = _softmax(scores, axis=-1)
        o = torch.einsum("bhqk,bhkd->bhqd", p, v)
        return (lambda x, *d: x.permute(*d))(o, 0, 2, 1, 3).reshape(B, S, D) @ wo

    def _B_ref(x, w_gate, w_up, w_down):
        g = torch.einsum("bsd,df->bsf", x, w_gate)
        u = torch.einsum("bsd,df->bsf", x, w_up)
        h = _gelu(g) * u
        return torch.einsum("bsf,fd->bsd", h, w_down)

    x = A_x
    h = x + _A_ref(_layernorm(x, axis=-1), A_wqkv, A_wo)
    h2 = h + _B_ref(_layernorm(h, axis=-1), B_w_gate, B_w_up, B_w_down)
    return h2
```

```asm
; @launch grid=(256,1,1) block=(512,1,1) lds=163840
.amdgcn_target "amdgcn-amd-amdhsa--gfx950"
.text
.p2align 8
.globl sequential_preLN__sliding_block__glu_gated_geglu__prompt_kernel
.type sequential_preLN__sliding_block__glu_gated_geglu__prompt_kernel,@function
sequential_preLN__sliding_block__glu_gated_geglu__prompt_kernel:
    s_cmp_ge_u32 s2, 256
    s_cbranch_scc1 K_END
    s_getpc_b64 s[88:89]
CODE_PC:
    s_sub_u32 s88, s88, CODE_PC-sequential_preLN__sliding_block__glu_gated_geglu__prompt_kernel
    s_subb_u32 s89, s89, 0
    s_and_b32 s89, s89, 0xffff
    s_mov_b32 s90, CODE_END-sequential_preLN__sliding_block__glu_gated_geglu__prompt_kernel
    s_mov_b32 s91, 0x00020000
    s_lshr_b32 s92, s2, 3
    s_lshl_b32 s92, s92, 12
    v_lshlrev_b32 v250, 7, v0
    v_cmp_gt_u32 vcc, 32, v0
    v_mov_b32 v251, 1073741824
    s_nop 0
    v_cndmask_b32 v250, v251, v250, vcc
    buffer_load_dword v251, v250, s[88:91], s92 offen
    s_load_dwordx8 s[64:71], s[0:1], 0
    s_load_dwordx8 s[72:79], s[0:1], 32
    s_load_dwordx4 s[80:83], s[0:1], 64
    s_memrealtime s[84:85]
    v_and_b32 v1, 63, v0
    v_lshrrev_b32 v2, 6, v0
    s_nop 0
    v_readfirstlane_b32 s40, v2
    s_and_b32 s41, s2, 7
    s_lshr_b32 s42, s2, 3
    s_mov_b32 s57, 100000
    s_and_b32 s43, s40, 3
    v_and_b32 v0, 255, v0
    v_mov_b32 v253, 0
    s_waitcnt lgkmcnt(0)
    s_mov_b32 s4, s64
    s_and_b32 s5, s65, 0xffff
    s_mov_b32 s6, 2621440
    s_mov_b32 s7, 0x00020000
    s_mov_b32 s8, s66
    s_and_b32 s9, s67, 0xffff
    s_mov_b32 s10, 2457600
    s_mov_b32 s11, 0x00020000
    s_cmp_ge_u32 s40, 4
    s_cbranch_scc1 L1_1
    s_mov_b32 s12, s68
    s_and_b32 s13, s69, 0xffff
    s_mov_b32 s14, 819200
    s_mov_b32 s15, 0x00020000
    s_mov_b32 s16, s72
    s_and_b32 s17, s73, 0xffff
    s_mov_b32 s18, 1966080
    s_mov_b32 s19, 0x00020000
    s_mov_b32 s20, s74
    s_and_b32 s21, s75, 0xffff
    s_mov_b32 s22, 1966080
    s_mov_b32 s23, 0x00020000
    s_mov_b32 s24, s76
    s_and_b32 s25, s77, 0xffff
    s_mov_b32 s26, 1966080
    s_mov_b32 s27, 0x00020000
    s_mov_b32 s28, s78
    s_and_b32 s29, s79, 0xffff
    s_mov_b32 s30, 2621440
    s_mov_b32 s31, 0x00020000
    s_mov_b32 s32, s82
    s_and_b32 s33, s83, 0xffff
    s_mov_b32 s34, 20971520
    s_mov_b32 s35, 0x00020000
    s_mov_b32 s36, s80
    s_and_b32 s37, s81, 0xffff
    s_mov_b32 s38, 256
    s_mov_b32 s39, 0x00020000
    s_or_b32 s60, s2, s40
    s_cmp_eq_u32 s60, 0
    s_cselect_b32 s61, 0, 0x10000
    s_or_b32 s60, s84, 1
    v_mov_b32 v2, s60
    v_mov_b32 v3, 0
    s_mov_b64 exec, 1
    buffer_store_dword v2, v3, s[36:39], s61 offen sc1
    s_mov_b64 exec, -1
    s_and_b32 s47, s41, 3
    s_lshr_b32 s46, s41, 2
    s_mul_i32 s46, s46, 30
    s_add_u32 s46, s46, s42
    s_lshr_b32 s44, s46, 2
    s_and_b32 s46, s46, 3
    s_lshl_b32 s47, s47, 2
    s_add_u32 s45, s47, s46
    s_add_u32 s56, s45, s44
    s_sub_u32 s47, s56, 10
    s_cmp_ge_u32 s56, 10
    s_cselect_b32 s56, s47, s56
    s_sub_u32 s47, s56, 10
    s_cmp_ge_u32 s56, 10
    s_cselect_b32 s56, s47, s56
    s_lshl_b32 s46, s45, 7
    s_lshl_b32 s47, s43, 5
    s_add_u32 s46, s46, s47
    s_lshl_b32 s48, s43, 12
    v_mov_b32 v96, -1
    v_mov_b32 v97, -1
    v_mov_b32 v98, -1
    v_mov_b32 v99, -1
    v_lshlrev_b32 v100, 4, v1
    v_lshlrev_b32 v101, 3, v1
    v_and_b32 v40, 31, v1
    v_lshlrev_b32 v109, 3, v40
    v_lshlrev_b32 v102, 2, v40
    s_lshl_b32 s51, s56, 14
    s_lshl_b32 s47, s46, 3
    s_add_u32 s51, s51, s47
    s_add_u32 s51, s51, 19562496
    s_mov_b32 s47, 1073741824
    s_cmp_lt_u32 s44, 10
    s_cselect_b32 s51, s51, s47
    s_mul_i32 s52, s56, 7680
    s_lshl_b32 s49, s44, 9
    s_add_u32 s52, s52, s49
    s_lshl_b32 s49, s43, 7
    s_add_u32 s52, s52, s49
    s_add_u32 s52, s52, 19464192
    s_cmp_lt_u32 s45, 10
    s_cselect_b32 s52, s52, s47
    s_cmp_lt_u32 s42, 30
    s_cselect_b32 s51, s51, s47
    s_cselect_b32 s52, s52, s47
    buffer_store_dwordx2 v[96:97], v109, s[32:35], s51 offen sc1
    buffer_store_dword v96, v102, s[32:35], s52 offen sc1
    v_lshrrev_b32 v41, 5, v1
    v_bfe_u32 v42, v1, 1, 3
    v_xor_b32 v42, v42, v41
    v_lshlrev_b32 v43, 7, v40
    v_lshl_add_u32 v43, v42, 4, v43
    v_add_u32 v10, s48, v43
    v_xor_b32 v11, 32, v10
    v_xor_b32 v12, 64, v10
    v_xor_b32 v13, 96, v10
    v_bfe_u32 v42, v1, 2, 2
    v_lshl_add_u32 v43, v41, 3, v42
    v_lshlrev_b32 v43, 8, v43
    v_bfe_u32 v44, v1, 4, 1
    v_lshl_add_u32 v43, v44, 5, v43
    v_and_b32 v44, 3, v1
    v_lshl_add_u32 v43, v44, 3, v43
    v_add_u32 v43, 16384, v43
    s_add_u32 s49, s43, 0
    s_and_b32 s49, s49, 3
    v_xor_b32 v44, s49, v42
    v_lshl_add_u32 v14, v44, 6, v43
    s_add_u32 s49, s43, 1
    s_and_b32 s49, s49, 3
    v_xor_b32 v44, s49, v42
    v_lshl_add_u32 v15, v44, 6, v43
    s_add_u32 s49, s43, 2
    s_and_b32 s49, s49, 3
    v_xor_b32 v44, s49, v42
    v_lshl_add_u32 v16, v44, 6, v43
    s_add_u32 s49, s43, 3
    s_and_b32 s49, s49, 3
    v_xor_b32 v44, s49, v42
    v_lshl_add_u32 v17, v44, 6, v43
    v_add_u32 v18, 65536, v10
    v_add_u32 v19, 65536, v11
    v_add_u32 v20, 65536, v12
    v_add_u32 v21, 65536, v13
    v_add_u32 v22, 65536, v14
    v_add_u32 v23, 65536, v15
    v_add_u32 v24, 65536, v16
    v_add_u32 v25, 65536, v17
    v_mov_b32 v34, 0
    v_mov_b32 v35, 0
    v_mov_b32 v36, 0
    v_mov_b32 v37, 0x3f803f80
    v_lshrrev_b32 v105, 5, v1
    v_mul_u32_u24 v103, 81920, v105
    v_add_u32 v103, v103, v109
    v_mul_u32_u24 v104, 38400, v105
    v_add_u32 v104, v104, v102
    s_lshl_b32 s53, s46, 3
    s_add_u32 s53, s53, 19562496
    s_lshl_b32 s54, s44, 9
    s_lshl_b32 s49, s43, 7
    s_add_u32 s54, s54, s49
    s_add_u32 s54, s54, 19464192
    s_sub_u32 s55, s56, 5
    s_cmp_ge_u32 s56, 5
    s_cselect_b32 s55, s55, s56
    v_mov_b32 v107, 162824
    v_mov_b32 v108, 0
    ds_write_b32 v107, v108
    ds_write_b32 v107, v108 offset:4
    s_waitcnt lgkmcnt(0)
    s_barrier
    s_cmp_eq_u32 s40, 0
    s_cbranch_scc1 OUT_5
OBK_6:
    s_cmp_ge_u32 s42, 30
    s_cbranch_scc1 C_HELP_8
    s_cmp_ge_u32 s44, 10
    s_cbranch_scc1 P1_V_7
    ds_read_b128 v[40:43], v10 offset:0
    ds_read_b64_tr_b16 v[48:49], v14 offset:0
    ds_read_b64_tr_b16 v[50:51], v14 offset:1024
    ds_read_b64_tr_b16 v[52:53], v15 offset:0
    ds_read_b64_tr_b16 v[54:55], v15 offset:1024
    ds_read_b64_tr_b16 v[56:57], v16 offset:0
    ds_read_b64_tr_b16 v[58:59], v16 offset:1024
    ds_read_b64_tr_b16 v[60:61], v17 offset:0
    ds_read_b64_tr_b16 v[62:63], v17 offset:1024
    s_waitcnt lgkmcnt(6)
    v_mfma_f32_32x32x16_bf16 v[128:143], v[48:51], v[40:43], 0
    ds_read_b128 v[44:47], v11 offset:0
    ds_read_b64_tr_b16 v[64:65], v14 offset:4096
    ds_read_b64_tr_b16 v[66:67], v14 offset:5120
    s_cmp_eq_u32 s55, 0
    s_cbranch_scc1 OUT_10
OBK_11:
    s_waitcnt lgkmcnt(7)
    v_mfma_f32_32x32x16_bf16 v[144:159], v[52:55], v[40:43], 0
    ds_read_b64_tr_b16 v[68:69], v15 offset:4096
    ds_read_b64_tr_b16 v[70:71], v15 offset:5120
    s_waitcnt lgkmcnt(7)
    v_mfma_f32_32x32x16_bf16 v[160:175], v[56:59], v[40:43], 0
    ds_read_b64_tr_b16 v[72:73], v16 offset:4096
    ds_read_b64_tr_b16 v[74:75], v16 offset:5120
    s_waitcnt lgkmcnt(7)
    v_mfma_f32_32x32x16_bf16 v[176:191], v[60:63], v[40:43], 0
    ds_read_b64_tr_b16 v[76:77], v17 offset:4096
    ds_read_b64_tr_b16 v[78:79], v17 offset:5120
    s_waitcnt lgkmcnt(6)
    v_mfma_f32_32x32x16_bf16 v[128:143], v[64:67], v[44:47], v[128:143]
    ds_read_b128 v[40:43], v12 offset:0
    ds_read_b64_tr_b16 v[48:49], v14 offset:8192
    ds_read_b64_tr_b16 v[50:51], v14 offset:9216
    s_cmp_eq_u32 s55, 0
    s_cbranch_scc1 OUT_12
OBK_13:
    s_waitcnt lgkmcnt(7)
    v_mfma_f32_32x32x16_bf16 v[144:159], v[68:71], v[44:47], v[144:159]
    ds_read_b64_tr_b16 v[52:53], v15 offset:8192
    ds_read_b64_tr_b16 v[54:55], v15 offset:9216
    s_waitcnt lgkmcnt(7)
    v_mfma_f32_32x32x16_bf16 v[160:175], v[72:75], v[44:47], v[160:175]
    ds_read_b64_tr_b16 v[56:57], v16 offset:8192
    ds_read_b64_tr_b16 v[58:59], v16 offset:9216
    s_waitcnt lgkmcnt(7)
    v_mfma_f32_32x32x16_bf16 v[176:191], v[76:79], v[44:47], v[176:191]
    ds_read_b64_tr_b16 v[60:61], v17 offset:8192
    ds_read_b64_tr_b16 v[62:63], v17 offset:9216
    s_waitcnt lgkmcnt(6)
    v_mfma_f32_32x32x16_bf16 v[128:143], v[48:51], v[40:43], v[128:143]
    ds_read_b128 v[44:47], v13 offset:0
    ds_read_b64_tr_b16 v[64:65], v14 offset:12288
    ds_read_b64_tr_b16 v[66:67], v14 offset:13312
    s_cmp_eq_u32 s55, 0
    s_cbranch_scc1 OUT_14
OBK_15:
    s_waitcnt lgkmcnt(7)
    v_mfma_f32_32x32x16_bf16 v[144:159], v[52:55], v[40:43], v[144:159]
    ds_read_b64_tr_b16 v[68:69], v15 offset:12288
    ds_read_b64_tr_b16 v[70:71], v15 offset:13312
    s_waitcnt lgkmcnt(7)
    v_mfma_f32_32x32x16_bf16 v[160:175], v[56:59], v[40:43], v[160:175]
    ds_read_b64_tr_b16 v[72:73], v16 offset:12288
    ds_read_b64_tr_b16 v[74:75], v16 offset:13312
    s_waitcnt lgkmcnt(7)
    v_mfma_f32_32x32x16_bf16 v[176:191], v[60:63], v[40:43], v[176:191]
    ds_read_b64_tr_b16 v[76:77], v17 offset:12288
    ds_read_b64_tr_b16 v[78:79], v17 offset:13312
    s_waitcnt lgkmcnt(0)
    s_barrier
    v_mfma_f32_32x32x16_bf16 v[128:143], v[64:67], v[44:47], v[128:143]
    ds_read_b128 v[40:43], v10 offset:32768
    ds_read_b64_tr_b16 v[48:49], v14 offset:32768
    ds_read_b64_tr_b16 v[50:51], v14 offset:33792
    s_cmp_eq_u32 s55, 0
    s_cbranch_scc1 OUT_16
OBK_17:
    v_mfma_f32_32x32x16_bf16 v[144:159], v[68:71], v[44:47], v[144:159]
    ds_read_b64_tr_b16 v[52:53], v15 offset:32768
    ds_read_b64_tr_b16 v[54:55], v15 offset:33792
    v_mfma_f32_32x32x16_bf16 v[160:175], v[72:75], v[44:47], v[160:175]
    ds_read_b64_tr_b16 v[56:57], v16 offset:32768
    ds_read_b64_tr_b16 v[58:59], v16 offset:33792
    v_mfma_f32_32x32x16_bf16 v[176:191], v[76:79], v[44:47], v[176:191]
    ds_read_b64_tr_b16 v[60:61], v17 offset:32768
    ds_read_b64_tr_b16 v[62:63], v17 offset:33792
    s_waitcnt lgkmcnt(6)
    v_mfma_f32_32x32x16_bf16 v[128:143], v[48:51], v[40:43], v[128:143]
    ds_read_b128 v[44:47], v11 offset:32768
    ds_read_b64_tr_b16 v[64:65], v14 offset:36864
    ds_read_b64_tr_b16 v[66:67], v14 offset:37888
    s_cmp_eq_u32 s55, 1
    s_cbranch_scc1 OUT_18
OBK_19:
    s_waitcnt lgkmcnt(7)
    v_mfma_f32_32x32x16_bf16 v[144:159], v[52:55], v[40:43], v[144:159]
    ds_read_b64_tr_b16 v[68:69], v15 offset:36864
    ds_read_b64_tr_b16 v[70:71], v15 offset:37888
    s_waitcnt lgkmcnt(7)
    v_mfma_f32_32x32x16_bf16 v[160:175], v[56:59], v[40:43], v[160:175]
    ds_read_b64_tr_b16 v[72:73], v16 offset:36864
    ds_read_b64_tr_b16 v[74:75], v16 offset:37888
    s_waitcnt lgkmcnt(7)
    v_mfma_f32_32x32x16_bf16 v[176:191], v[60:63], v[40:43], v[176:191]
    ds_read_b64_tr_b16 v[76:77], v17 offset:36864
    ds_read_b64_tr_b16 v[78:79], v17 offset:37888
    s_waitcnt lgkmcnt(6)
    v_mfma_f32_32x32x16_bf16 v[128:143], v[64:67], v[44:47], v[128:143]
    ds_read_b128 v[40:43], v12 offset:32768
    ds_read_b64_tr_b16 v[48:49], v14 offset:40960
    ds_read_b64_tr_b16 v[50:51], v14 offset:41984
    s_cmp_eq_u32 s55, 1
    s_cbranch_scc1 OUT_20
OBK_21:
    s_waitcnt lgkmcnt(7)
    v_mfma_f32_32x32x16_bf16 v[144:159], v[68:71], v[44:47], v[144:159]
    ds_read_b64_tr_b16 v[52:53], v15 offset:40960
    ds_read_b64_tr_b16 v[54:55], v15 offset:41984
    s_waitcnt lgkmcnt(7)
    v_mfma_f32_32x32x16_bf16 v[160:175], v[72:75], v[44:47], v[160:175]
    ds_read_b64_tr_b16 v[56:57], v16 offset:40960
    ds_read_b64_tr_b16 v[58:59], v16 offset:41984
    s_waitcnt lgkmcnt(7)
    v_mfma_f32_32x32x16_bf16 v[176:191], v[76:79], v[44:47], v[176:191]
    ds_read_b64_tr_b16 v[60:61], v17 offset:40960
    ds_read_b64_tr_b16 v[62:63], v17 offset:41984
    s_waitcnt lgkmcnt(6)
    v_mfma_f32_32x32x16_bf16 v[128:143], v[48:51], v[40:43], v[128:143]
    ds_read_b128 v[44:47], v13 offset:32768
    ds_read_b64_tr_b16 v[64:65], v14 offset:45056
    ds_read_b64_tr_b16 v[66:67], v14 offset:46080
    s_cmp_eq_u32 s55, 1
    s_cbranch_scc1 OUT_22
OBK_23:
    s_waitcnt lgkmcnt(7)
    v_mfma_f32_32x32x16_bf16 v[144:159], v[52:55], v[40:43], v[144:159]
    ds_read_b64_tr_b16 v[68:69], v15 offset:45056
    ds_read_b64_tr_b16 v[70:71], v15 offset:46080
    s_waitcnt lgkmcnt(7)
    v_mfma_f32_32x32x16_bf16 v[160:175], v[56:59], v[40:43], v[160:175]
    ds_read_b64_tr_b16 v[72:73], v16 offset:45056
    ds_read_b64_tr_b16 v[74:75], v16 offset:46080
    s_waitcnt lgkmcnt(7)
    v_mfma_f32_32x32x16_bf16 v[176:191], v[60:63], v[40:43], v[176:191]
    ds_read_b64_tr_b16 v[76:77], v17 offset:45056
    ds_read_b64_tr_b16 v[78:79], v17 offset:46080
    s_cmp_eq_u32 s40, 0
    s_cbranch_scc1 OUT_24
OBK_25:
    s_waitcnt vmcnt(0)
    s_waitcnt lgkmcnt(0)
    s_barrier
    v_mov_b32 v107, s3
    v_lshlrev_b32 v108, 10, v1
    s_lshl_b32 s60, s2, 2
    s_add_u32 s60, s60, 19447808
    s_mov_b32 s61, 1073741824
    s_cmp_eq_u32 s40, 0
    s_cselect_b32 s60, s60, s61
    s_mov_b64 exec, 0xff
    buffer_store_dword v107, v108, s[32:35], s60 offen sc1
    s_mov_b64 exec, -1
    v_mov_b32 v107, 162816
    ds_read_b32 v107, v107
    s_waitcnt lgkmcnt(0)
    v_readfirstlane_b32 s3, v107
    v_mfma_f32_32x32x16_bf16 v[128:143], v[64:67], v[44:47], v[128:143]
    ds_read_b128 v[40:43], v18 offset:0
    ds_read_b64_tr_b16 v[48:49], v22 offset:0
    ds_read_b64_tr_b16 v[50:51], v22 offset:1024
    s_cmp_eq_u32 s55, 1
    s_cbranch_scc1 OUT_29
OBK_30:
    v_mfma_f32_32x32x16_bf16 v[144:159], v[68:71], v[44:47], v[144:159]
    ds_read_b64_tr_b16 v[52:53], v23 offset:0
    ds_read_b64_tr_b16 v[54:55], v23 offset:1024
    v_mfma_f32_32x32x16_bf16 v[160:175], v[72:75], v[44:47], v[160:175]
    ds_read_b64_tr_b16 v[56:57], v24 offset:0
    ds_read_b64_tr_b16 v[58:59], v24 offset:1024
    v_mfma_f32_32x32x16_bf16 v[176:191], v[76:79], v[44:47], v[176:191]
    ds_read_b64_tr_b16 v[60:61], v25 offset:0
    ds_read_b64_tr_b16 v[62:63], v25 offset:1024
    s_waitcnt lgkmcnt(6)
    v_mfma_f32_32x32x16_bf16 v[128:143], v[48:51], v[40:43], v[128:143]
    ds_read_b128 v[44:47], v19 offset:0
    ds_read_b64_tr_b16 v[64:65], v22 offset:4096
    ds_read_b64_tr_b16 v[66:67], v22 offset:5120
    s_cmp_eq_u32 s55, 2
    s_cbranch_scc1 OUT_31
OBK_32:
    s_waitcnt lgkmcnt(7)
    v_mfma_f32_32x32x16_bf16 v[144:159], v[52:55], v[40:43], v[144:159]
    ds_read_b64_tr_b16 v[68:69], v23 offset:4096
    ds_read_b64_tr_b16 v[70:71], v23 offset:5120
    s_waitcnt lgkmcnt(7)
    v_mfma_f32_32x32x16_bf16 v[160:175], v[56:59], v[40:43], v[160:175]
    ds_read_b64_tr_b16 v[72:73], v24 offset:4096
    ds_read_b64_tr_b16 v[74:75], v24 offset:5120
    s_waitcnt lgkmcnt(7)
    v_mfma_f32_32x32x16_bf16 v[176:191], v[60:63], v[40:43], v[176:191]
    ds_read_b64_tr_b16 v[76:77], v25 offset:4096
    ds_read_b64_tr_b16 v[78:79], v25 offset:5120
    s_waitcnt lgkmcnt(6)
    v_mfma_f32_32x32x16_bf16 v[128:143], v[64:67], v[44:47], v[128:143]
    ds_read_b128 v[40:43], v20 offset:0
    ds_read_b64_tr_b16 v[48:49], v22 offset:8192
    ds_read_b64_tr_b16 v[50:51], v22 offset:9216
    s_cmp_eq_u32 s55, 2
    s_cbranch_scc1 OUT_33
OBK_34:
    s_waitcnt lgkmcnt(7)
    v_mfma_f32_32x32x16_bf16 v[144:159], v[68:71], v[44:47], v[144:159]
    ds_read_b64_tr_b16 v[52:53], v23 offset:8192
    ds_read_b64_tr_b16 v[54:55], v23 offset:9216
    s_waitcnt lgkmcnt(7)
    v_mfma_f32_32x32x16_bf16 v[160:175], v[72:75], v[44:47], v[160:175]
    ds_read_b64_tr_b16 v[56:57], v24 offset:8192
    ds_read_b64_tr_b16 v[58:59], v24 offset:9216
    s_waitcnt lgkmcnt(7)
    v_mfma_f32_32x32x16_bf16 v[176:191], v[76:79], v[44:47], v[176:191]
    ds_read_b64_tr_b16 v[60:61], v25 offset:8192
    ds_read_b64_tr_b16 v[62:63], v25 offset:9216
    s_waitcnt lgkmcnt(6)
    v_mfma_f32_32x32x16_bf16 v[128:143], v[48:51], v[40:43], v[128:143]
    ds_read_b128 v[44:47], v21 offset:0
    ds_read_b64_tr_b16 v[64:65], v22 offset:12288
    ds_read_b64_tr_b16 v[66:67], v22 offset:13312
    s_cmp_eq_u32 s55, 2
    s_cbranch_scc1 OUT_35
OBK_36:
    s_waitcnt lgkmcnt(7)
    v_mfma_f32_32x32x16_bf16 v[144:159], v[52:55], v[40:43], v[144:159]
    ds_read_b64_tr_b16 v[68:69], v23 offset:12288
    ds_read_b64_tr_b16 v[70:71], v23 offset:13312
    s_waitcnt lgkmcnt(7)
    v_mfma_f32_32x32x16_bf16 v[160:175], v[56:59], v[40:43], v[160:175]
    ds_read_b64_tr_b16 v[72:73], v24 offset:12288
    ds_read_b64_tr_b16 v[74:75], v24 offset:13312
    s_waitcnt lgkmcnt(7)
    v_mfma_f32_32x32x16_bf16 v[176:191], v[60:63], v[40:43], v[176:191]
    ds_read_b64_tr_b16 v[76:77], v25 offset:12288
    ds_read_b64_tr_b16 v[78:79], v25 offset:13312
    s_waitcnt lgkmcnt(0)
    s_barrier
    v_mfma_f32_32x32x16_bf16 v[128:143], v[64:67], v[44:47], v[128:143]
    ds_read_b128 v[40:43], v18 offset:32768
    ds_read_b64_tr_b16 v[48:49], v22 offset:32768
    ds_read_b64_tr_b16 v[50:51], v22 offset:33792
    s_cmp_eq_u32 s55, 2
    s_cbranch_scc1 OUT_37
OBK_38:
    v_mfma_f32_32x32x16_bf16 v[144:159], v[68:71], v[44:47], v[144:159]
    ds_read_b64_tr_b16 v[52:53], v23 offset:32768
    ds_read_b64_tr_b16 v[54:55], v23 offset:33792
    v_mfma_f32_32x32x16_bf16 v[160:175], v[72:75], v[44:47], v[160:175]
    ds_read_b64_tr_b16 v[56:57], v24 offset:32768
    ds_read_b64_tr_b16 v[58:59], v24 offset:33792
    v_mfma_f32_32x32x16_bf16 v[176:191], v[76:79], v[44:47], v[176:191]
    ds_read_b64_tr_b16 v[60:61], v25 offset:32768
    ds_read_b64_tr_b16 v[62:63], v25 offset:33792
    s_waitcnt lgkmcnt(6)
    v_mfma_f32_32x32x16_bf16 v[128:143], v[48:51], v[40:43], v[128:143]
    ds_read_b128 v[44:47], v19 offset:32768
    ds_read_b64_tr_b16 v[64:65], v22 offset:36864
    ds_read_b64_tr_b16 v[66:67], v22 offset:37888
    s_cmp_eq_u32 s55, 3
    s_cbranch_scc1 OUT_39
OBK_40:
    s_waitcnt lgkmcnt(7)
    v_mfma_f32_32x32x16_bf16 v[144:159], v[52:55], v[40:43], v[144:159]
    ds_read_b64_tr_b16 v[68:69], v23 offset:36864
    ds_read_b64_tr_b16 v[70:71], v23 offset:37888
    s_waitcnt lgkmcnt(7)
    v_mfma_f32_32x32x16_bf16 v[160:175], v[56:59], v[40:43], v[160:175]
    ds_read_b64_tr_b16 v[72:73], v24 offset:36864
    ds_read_b64_tr_b16 v[74:75], v24 offset:37888
    s_waitcnt lgkmcnt(7)
    v_mfma_f32_32x32x16_bf16 v[176:191], v[60:63], v[40:43], v[176:191]
    ds_read_b64_tr_b16 v[76:77], v25 offset:36864
    ds_read_b64_tr_b16 v[78:79], v25 offset:37888
    s_waitcnt lgkmcnt(6)
    v_mfma_f32_32x32x16_bf16 v[128:143], v[64:67], v[44:47], v[128:143]
    ds_read_b128 v[40:43], v20 offset:32768
    ds_read_b64_tr_b16 v[48:49], v22 offset:40960
    ds_read_b64_tr_b16 v[50:51], v22 offset:41984
    s_cmp_eq_u32 s55, 3
    s_cbranch_scc1 OUT_41
OBK_42:
    s_waitcnt lgkmcnt(7)
    v_mfma_f32_32x32x16_bf16 v[144:159], v[68:71], v[44:47], v[144:159]
    ds_read_b64_tr_b16 v[52:53], v23 offset:40960
    ds_read_b64_tr_b16 v[54:55], v23 offset:41984
    s_waitcnt lgkmcnt(7)
    v_mfma_f32_32x32x16_bf16 v[160:175], v[72:75], v[44:47], v[160:175]
    ds_read_b64_tr_b16 v[56:57], v24 offset:40960
    ds_read_b64_tr_b16 v[58:59], v24 offset:41984
    s_waitcnt lgkmcnt(7)
    v_mfma_f32_32x32x16_bf16 v[176:191], v[76:79], v[44:47], v[176:191]
    ds_read_b64_tr_b16 v[60:61], v25 offset:40960
    ds_read_b64_tr_b16 v[62:63], v25 offset:41984
    s_waitcnt lgkmcnt(6)
    v_mfma_f32_32x32x16_bf16 v[128:143], v[48:51], v[40:43], v[128:143]
    ds_read_b128 v[44:47], v21 offset:32768
    ds_read_b64_tr_b16 v[64:65], v22 offset:45056
    ds_read_b64_tr_b16 v[66:67], v22 offset:46080
    s_cmp_eq_u32 s55, 3
    s_cbranch_scc1 OUT_43
OBK_44:
    s_waitcnt lgkmcnt(7)
    v_mfma_f32_32x32x16_bf16 v[144:159], v[52:55], v[40:43], v[144:159]
    ds_read_b64_tr_b16 v[68:69], v23 offset:45056
    ds_read_b64_tr_b16 v[70:71], v23 offset:46080
    s_waitcnt lgkmcnt(7)
    v_mfma_f32_32x32x16_bf16 v[160:175], v[56:59], v[40:43], v[160:175]
    ds_read_b64_tr_b16 v[72:73], v24 offset:45056
    ds_read_b64_tr_b16 v[74:75], v24 offset:46080
    s_waitcnt lgkmcnt(7)
    v_mfma_f32_32x32x16_bf16 v[176:191], v[60:63], v[40:43], v[176:191]
    ds_read_b64_tr_b16 v[76:77], v25 offset:45056
    ds_read_b64_tr_b16 v[78:79], v25 offset:46080
    s_waitcnt lgkmcnt(0)
    s_barrier
    v_mfma_f32_32x32x16_bf16 v[128:143], v[64:67], v[44:47], v[128:143]
    ds_read_b128 v[40:43], v10 offset:0
    ds_read_b64_tr_b16 v[48:49], v14 offset:0
    ds_read_b64_tr_b16 v[50:51], v14 offset:1024
    s_cmp_eq_u32 s55, 3
    s_cbranch_scc1 OUT_45
OBK_46:
    v_mfma_f32_32x32x16_bf16 v[144:159], v[68:71], v[44:47], v[144:159]
    ds_read_b64_tr_b16 v[52:53], v15 offset:0
    ds_read_b64_tr_b16 v[54:55], v15 offset:1024
    v_mfma_f32_32x32x16_bf16 v[160:175], v[72:75], v[44:47], v[160:175]
    ds_read_b64_tr_b16 v[56:57], v16 offset:0
    ds_read_b64_tr_b16 v[58:59], v16 offset:1024
    v_mfma_f32_32x32x16_bf16 v[176:191], v[76:79], v[44:47], v[176:191]
    ds_read_b64_tr_b16 v[60:61], v17 offset:0
    ds_read_b64_tr_b16 v[62:63], v17 offset:1024
    s_waitcnt lgkmcnt(6)
    v_mfma_f32_32x32x16_bf16 v[128:143], v[48:51], v[40:43], v[128:143]
    ds_read_b128 v[44:47], v11 offset:0
    ds_read_b64_tr_b16 v[64:65], v14 offset:4096
    ds_read_b64_tr_b16 v[66:67], v14 offset:5120
    s_cmp_eq_u32 s55, 4
    s_cbranch_scc1 OUT_47
OBK_48:
    s_waitcnt lgkmcnt(7)
    v_mfma_f32_32x32x16_bf16 v[144:159], v[52:55], v[40:43], v[144:159]
    ds_read_b64_tr_b16 v[68:69], v15 offset:4096
    ds_read_b64_tr_b16 v[70:71], v15 offset:5120
    s_waitcnt lgkmcnt(7)
    v_mfma_f32_32x32x16_bf16 v[160:175], v[56:59], v[40:43], v[160:175]
    ds_read_b64_tr_b16 v[72:73], v16 offset:4096
    ds_read_b64_tr_b16 v[74:75], v16 offset:5120
    s_waitcnt lgkmcnt(7)
    v_mfma_f32_32x32x16_bf16 v[176:191], v[60:63], v[40:43], v[176:191]
    ds_read_b64_tr_b16 v[76:77], v17 offset:4096
    ds_read_b64_tr_b16 v[78:79], v17 offset:5120
    s_waitcnt lgkmcnt(6)
    v_mfma_f32_32x32x16_bf16 v[128:143], v[64:67], v[44:47], v[128:143]
    ds_read_b128 v[40:43], v12 offset:0
    ds_read_b64_tr_b16 v[48:49], v14 offset:8192
    ds_read_b64_tr_b16 v[50:51], v14 offset:9216
    s_cmp_eq_u32 s55, 4
    s_cbranch_scc1 OUT_49
OBK_50:
    s_waitcnt lgkmcnt(7)
    v_mfma_f32_32x32x16_bf16 v[144:159], v[68:71], v[44:47], v[144:159]
    ds_read_b64_tr_b16 v[52:53], v15 offset:8192
    ds_read_b64_tr_b16 v[54:55], v15 offset:9216
    s_waitcnt lgkmcnt(7)
    v_mfma_f32_32x32x16_bf16 v[160:175], v[72:75], v[44:47], v[160:175]
    ds_read_b64_tr_b16 v[56:57], v16 offset:8192
    ds_read_b64_tr_b16 v[58:59], v16 offset:9216
    s_waitcnt lgkmcnt(7)
    v_mfma_f32_32x32x16_bf16 v[176:191], v[76:79], v[44:47], v[176:191]
    ds_read_b64_tr_b16 v[60:61], v17 offset:8192
    ds_read_b64_tr_b16 v[62:63], v17 offset:9216
    s_waitcnt lgkmcnt(6)
    v_mfma_f32_32x32x16_bf16 v[128:143], v[48:51], v[40:43], v[128:143]
    ds_read_b128 v[44:47], v13 offset:0
    ds_read_b64_tr_b16 v[64:65], v14 offset:12288
    ds_read_b64_tr_b16 v[66:67], v14 offset:13312
    s_cmp_eq_u32 s55, 4
    s_cbranch_scc1 OUT_51
OBK_52:
    s_waitcnt lgkmcnt(7)
    v_mfma_f32_32x32x16_bf16 v[144:159], v[52:55], v[40:43], v[144:159]
    ds_read_b64_tr_b16 v[68:69], v15 offset:12288
    ds_read_b64_tr_b16 v[70:71], v15 offset:13312
    s_waitcnt lgkmcnt(7)
    v_mfma_f32_32x32x16_bf16 v[160:175], v[56:59], v[40:43], v[160:175]
    ds_read_b64_tr_b16 v[72:73], v16 offset:12288
    ds_read_b64_tr_b16 v[74:75], v16 offset:13312
    s_waitcnt lgkmcnt(7)
    v_mfma_f32_32x32x16_bf16 v[176:191], v[60:63], v[40:43], v[176:191]
    ds_read_b64_tr_b16 v[76:77], v17 offset:12288
    ds_read_b64_tr_b16 v[78:79], v17 offset:13312
    s_waitcnt lgkmcnt(0)
    s_barrier
    v_mfma_f32_32x32x16_bf16 v[128:143], v[64:67], v[44:47], v[128:143]
    ds_read_b128 v[40:43], v10 offset:32768
    ds_read_b64_tr_b16 v[48:49], v14 offset:32768
    ds_read_b64_tr_b16 v[50:51], v14 offset:33792
    s_cmp_eq_u32 s55, 4
    s_cbranch_scc1 OUT_53
OBK_54:
    v_mfma_f32_32x32x16_bf16 v[144:159], v[68:71], v[44:47], v[144:159]
    ds_read_b64_tr_b16 v[52:53], v15 offset:32768
    ds_read_b64_tr_b16 v[54:55], v15 offset:33792
    v_mfma_f32_32x32x16_bf16 v[160:175], v[72:75], v[44:47], v[160:175]
    ds_read_b64_tr_b16 v[56:57], v16 offset:32768
    ds_read_b64_tr_b16 v[58:59], v16 offset:33792
    v_mfma_f32_32x32x16_bf16 v[176:191], v[76:79], v[44:47], v[176:191]
    ds_read_b64_tr_b16 v[60:61], v17 offset:32768
    ds_read_b64_tr_b16 v[62:63], v17 offset:33792
    s_waitcnt lgkmcnt(6)
    v_mfma_f32_32x32x16_bf16 v[128:143], v[48:51], v[40:43], v[128:143]
    ds_read_b128 v[44:47], v11 offset:32768
    ds_read_b64_tr_b16 v[64:65], v14 offset:36864
    ds_read_b64_tr_b16 v[66:67], v14 offset:37888
    v_lshlrev_b32 v106, 4, v1
    s_lshl_b32 s60, s41, 10
    v_add_u32 v106, s60, v106
    s_mov_b32 s60, 19447808
    buffer_load_dwordx4 v[248:251], v106, s[32:35], s60 offen sc1
    s_waitcnt lgkmcnt(7)
    v_mfma_f32_32x32x16_bf16 v[144:159], v[52:55], v[40:43], v[144:159]
    ds_read_b64_tr_b16 v[68:69], v15 offset:36864
    ds_read_b64_tr_b16 v[70:71], v15 offset:37888
    s_waitcnt lgkmcnt(7)
    v_mfma_f32_32x32x16_bf16 v[160:175], v[56:59], v[40:43], v[160:175]
    ds_read_b64_tr_b16 v[72:73], v16 offset:36864
    ds_read_b64_tr_b16 v[74:75], v16 offset:37888
    s_waitcnt lgkmcnt(7)
    v_mfma_f32_32x32x16_bf16 v[176:191], v[60:63], v[40:43], v[176:191]
    ds_read_b64_tr_b16 v[76:77], v17 offset:36864
    ds_read_b64_tr_b16 v[78:79], v17 offset:37888
    s_waitcnt lgkmcnt(6)
    v_mfma_f32_32x32x16_bf16 v[128:143], v[64:67], v[44:47], v[128:143]
    ds_read_b128 v[40:43], v12 offset:32768
    ds_read_b64_tr_b16 v[48:49], v14 offset:40960
    ds_read_b64_tr_b16 v[50:51], v14 offset:41984
    s_waitcnt lgkmcnt(7)
    v_mfma_f32_32x32x16_bf16 v[144:159], v[68:71], v[44:47], v[144:159]
    ds_read_b64_tr_b16 v[52:53], v15 offset:40960
    ds_read_b64_tr_b16 v[54:55], v15 offset:41984
    s_waitcnt lgkmcnt(7)
    v_mfma_f32_32x32x16_bf16 v[160:175], v[72:75], v[44:47], v[160:175]
    ds_read_b64_tr_b16 v[56:57], v16 offset:40960
    ds_read_b64_tr_b16 v[58:59], v16 offset:41984
    s_waitcnt lgkmcnt(7)
    v_mfma_f32_32x32x16_bf16 v[176:191], v[76:79], v[44:47], v[176:191]
    ds_read_b64_tr_b16 v[60:61], v17 offset:40960
    ds_read_b64_tr_b16 v[62:63], v17 offset:41984
    s_waitcnt lgkmcnt(6)
    v_mfma_f32_32x32x16_bf16 v[128:143], v[48:51], v[40:43], v[128:143]
    ds_read_b128 v[44:47], v13 offset:32768
    ds_read_b64_tr_b16 v[64:65], v14 offset:45056
    ds_read_b64_tr_b16 v[66:67], v14 offset:46080
    s_waitcnt lgkmcnt(7)
    v_mfma_f32_32x32x16_bf16 v[144:159], v[52:55], v[40:43], v[144:159]
    ds_read_b64_tr_b16 v[68:69], v15 offset:45056
    ds_read_b64_tr_b16 v[70:71], v15 offset:46080
    s_waitcnt lgkmcnt(7)
    v_mfma_f32_32x32x16_bf16 v[160:175], v[56:59], v[40:43], v[160:175]
    ds_read_b64_tr_b16 v[72:73], v16 offset:45056
    ds_read_b64_tr_b16 v[74:75], v16 offset:46080
    s_waitcnt lgkmcnt(7)
    v_mfma_f32_32x32x16_bf16 v[176:191], v[60:63], v[40:43], v[176:191]
    ds_read_b64_tr_b16 v[76:77], v17 offset:45056
    ds_read_b64_tr_b16 v[78:79], v17 offset:46080
    s_waitcnt lgkmcnt(0)
    s_barrier
    v_mfma_f32_32x32x16_bf16 v[128:143], v[64:67], v[44:47], v[128:143]
    ds_read_b128 v[40:43], v18 offset:0
    ds_read_b64_tr_b16 v[48:49], v22 offset:0
    ds_read_b64_tr_b16 v[50:51], v22 offset:1024
    v_mfma_f32_32x32x16_bf16 v[144:159], v[68:71], v[44:47], v[144:159]
    ds_read_b64_tr_b16 v[52:53], v23 offset:0
    ds_read_b64_tr_b16 v[54:55], v23 offset:1024
    v_mfma_f32_32x32x16_bf16 v[160:175], v[72:75], v[44:47], v[160:175]
    ds_read_b64_tr_b16 v[56:57], v24 offset:0
    ds_read_b64_tr_b16 v[58:59], v24 offset:1024
    v_mfma_f32_32x32x16_bf16 v[176:191], v[76:79], v[44:47], v[176:191]
    ds_read_b64_tr_b16 v[60:61], v25 offset:0
    ds_read_b64_tr_b16 v[62:63], v25 offset:1024
    s_waitcnt lgkmcnt(6)
    v_mfma_f32_32x32x16_bf16 v[128:143], v[48:51], v[40:43], v[128:143]
    ds_read_b128 v[44:47], v19 offset:0
    ds_read_b64_tr_b16 v[64:65], v22 offset:4096
    ds_read_b64_tr_b16 v[66:67], v22 offset:5120
    s_waitcnt lgkmcnt(7)
    v_mfma_f32_32x32x16_bf16 v[144:159], v[52:55], v[40:43], v[144:159]
    ds_read_b64_tr_b16 v[68:69], v23 offset:4096
    ds_read_b64_tr_b16 v[70:71], v23 offset:5120
    s_waitcnt lgkmcnt(7)
    v_mfma_f32_32x32x16_bf16 v[160:175], v[56:59], v[40:43], v[160:175]
    ds_read_b64_tr_b16 v[72:73], v24 offset:4096
    ds_read_b64_tr_b16 v[74:75], v24 offset:5120
    s_waitcnt lgkmcnt(7)
    v_mfma_f32_32x32x16_bf16 v[176:191], v[60:63], v[40:43], v[176:191]
    ds_read_b64_tr_b16 v[76:77], v25 offset:4096
    ds_read_b64_tr_b16 v[78:79], v25 offset:5120
    s_waitcnt lgkmcnt(6)
    v_mfma_f32_32x32x16_bf16 v[128:143], v[64:67], v[44:47], v[128:143]
    ds_read_b128 v[40:43], v20 offset:0
    ds_read_b64_tr_b16 v[48:49], v22 offset:8192
    ds_read_b64_tr_b16 v[50:51], v22 offset:9216
    s_waitcnt lgkmcnt(7)
    v_mfma_f32_32x32x16_bf16 v[144:159], v[68:71], v[44:47], v[144:159]
    ds_read_b64_tr_b16 v[52:53], v23 offset:8192
    ds_read_b64_tr_b16 v[54:55], v23 offset:9216
    s_waitcnt lgkmcnt(7)
    v_mfma_f32_32x32x16_bf16 v[160:175], v[72:75], v[44:47], v[160:175]
    ds_read_b64_tr_b16 v[56:57], v24 offset:8192
    ds_read_b64_tr_b16 v[58:59], v24 offset:9216
    s_waitcnt lgkmcnt(7)
    v_mfma_f32_32x32x16_bf16 v[176:191], v[76:79], v[44:47], v[176:191]
    ds_read_b64_tr_b16 v[60:61], v25 offset:8192
    ds_read_b64_tr_b16 v[62:63], v25 offset:9216
    s_waitcnt lgkmcnt(6)
    v_mfma_f32_32x32x16_bf16 v[128:143], v[48:51], v[40:43], v[128:143]
    ds_read_b128 v[44:47], v21 offset:0
    ds_read_b64_tr_b16 v[64:65], v22 offset:12288
    ds_read_b64_tr_b16 v[66:67], v22 offset:13312
    s_waitcnt lgkmcnt(7)
    v_mfma_f32_32x32x16_bf16 v[144:159], v[52:55], v[40:43], v[144:159]
    ds_read_b64_tr_b16 v[68:69], v23 offset:12288
    ds_read_b64_tr_b16 v[70:71], v23 offset:13312
    s_waitcnt lgkmcnt(7)
    v_mfma_f32_32x32x16_bf16 v[160:175], v[56:59], v[40:43], v[160:175]
    ds_read_b64_tr_b16 v[72:73], v24 offset:12288
    ds_read_b64_tr_b16 v[74:75], v24 offset:13312
    s_waitcnt lgkmcnt(7)
    v_mfma_f32_32x32x16_bf16 v[176:191], v[60:63], v[40:43], v[176:191]
    ds_read_b64_tr_b16 v[76:77], v25 offset:12288
    ds_read_b64_tr_b16 v[78:79], v25 offset:13312
    s_waitcnt lgkmcnt(0)
    s_barrier
    v_mfma_f32_32x32x16_bf16 v[128:143], v[64:67], v[44:47], v[128:143]
    ds_read_b128 v[40:43], v18 offset:32768
    ds_read_b64_tr_b16 v[48:49], v22 offset:32768
    ds_read_b64_tr_b16 v[50:51], v22 offset:33792
    s_waitcnt vmcnt(0)
    v_xor_b32 v248, s3, v248
    v_xor_b32 v249, s3, v249
    v_xor_b32 v250, s3, v250
    v_xor_b32 v251, s3, v251
    v_or3_b32 v248, v248, v249, v250
    v_or_b32 v248, v248, v251
    v_cmp_ne_u32 vcc, 0, v248
    s_cbranch_vccnz FSLOW_55
FBACK_56:
    s_add_u32 s58, s53, 0
    buffer_load_dwordx2 v[232:233], v103, s[32:35], s58 offen sc1
    s_add_u32 s58, s53, 16384
    buffer_load_dwordx2 v[234:235], v103, s[32:35], s58 offen sc1
    s_add_u32 s58, s53, 32768
    buffer_load_dwordx2 v[236:237], v103, s[32:35], s58 offen sc1
    s_add_u32 s58, s53, 49152
    buffer_load_dwordx2 v[238:239], v103, s[32:35], s58 offen sc1
    s_add_u32 s58, s53, 65536
    buffer_load_dwordx2 v[240:241], v103, s[32:35], s58 offen sc1
    s_add_u32 s58, s54, 0
    buffer_load_dword v242, v104, s[32:35], s58 offen sc1
    s_add_u32 s58, s54, 7680
    buffer_load_dword v243, v104, s[32:35], s58 offen sc1
    s_add_u32 s58, s54, 15360
    buffer_load_dword v244, v104, s[32:35], s58 offen sc1
    s_add_u32 s58, s54, 23040
    buffer_load_dword v245, v104, s[32:35], s58 offen sc1
    s_add_u32 s58, s54, 30720
    buffer_load_dword v246, v104, s[32:35], s58 offen sc1
    v_mfma_f32_32x32x16_bf16 v[144:159], v[68:71], v[44:47], v[144:159]
    ds_read_b64_tr_b16 v[52:53], v23 offset:32768
    ds_read_b64_tr_b16 v[54:55], v23 offset:33792
    v_mfma_f32_32x32x16_bf16 v[160:175], v[72:75], v[44:47], v[160:175]
    ds_read_b64_tr_b16 v[56:57], v24 offset:32768
    ds_read_b64_tr_b16 v[58:59], v24 offset:33792
    v_mfma_f32_32x32x16_bf16 v[176:191], v[76:79], v[44:47], v[176:191]
    ds_read_b64_tr_b16 v[60:61], v25 offset:32768
    ds_read_b64_tr_b16 v[62:63], v25 offset:33792
    s_waitcnt lgkmcnt(6)
    v_mfma_f32_32x32x16_bf16 v[128:143], v[48:51], v[40:43], v[128:143]
    ds_read_b128 v[44:47], v19 offset:32768
    ds_read_b64_tr_b16 v[64:65], v22 offset:36864
    ds_read_b64_tr_b16 v[66:67], v22 offset:37888
    s_and_b32 s60, s42, 3
    s_lshl_b32 s61, s41, 2
    s_add_u32 s60, s60, s61
    s_and_b32 s65, s60, 1
    s_lshr_b32 s60, s60, 1
    s_mul_i32 s60, s60, 5
    s_lshl_b32 s60, s60, 15
    s_lshr_b32 s61, s42, 2
    s_lshl_b32 s61, s61, 12
    s_add_u32 s60, s60, s61
    s_lshl_b32 s61, s43, 10
    s_add_u32 s60, s60, s61
    s_add_u32 s64, s60, 7864320
    s_mul_i32 s61, s65, 98304
    s_add_u32 s66, s64, s61
    buffer_store_dwordx4 v[96:99], v100, s[32:35], s66 offen sc1
    s_waitcnt lgkmcnt(7)
    v_mfma_f32_32x32x16_bf16 v[144:159], v[52:55], v[40:43], v[144:159]
    ds_read_b64_tr_b16 v[68:69], v23 offset:36864
    ds_read_b64_tr_b16 v[70:71], v23 offset:37888
    s_waitcnt lgkmcnt(7)
    v_mfma_f32_32x32x16_bf16 v[160:175], v[56:59], v[40:43], v[160:175]
    ds_read_b64_tr_b16 v[72:73], v24 offset:36864
    ds_read_b64_tr_b16 v[74:75], v24 offset:37888
    s_waitcnt lgkmcnt(7)
    v_mfma_f32_32x32x16_bf16 v[176:191], v[60:63], v[40:43], v[176:191]
    ds_read_b64_tr_b16 v[76:77], v25 offset:36864
    ds_read_b64_tr_b16 v[78:79], v25 offset:37888
    s_waitcnt lgkmcnt(6)
    v_mfma_f32_32x32x16_bf16 v[128:143], v[64:67], v[44:47], v[128:143]
    ds_read_b128 v[40:43], v20 offset:32768
    ds_read_b64_tr_b16 v[48:49], v22 offset:40960
    ds_read_b64_tr_b16 v[50:51], v22 offset:41984
    s_add_u32 s60, s66, 32768
    buffer_store_dwordx4 v[96:99], v100, s[32:35], s60 offen sc1
    s_waitcnt lgkmcnt(7)
    v_mfma_f32_32x32x16_bf16 v[144:159], v[68:71], v[44:47], v[144:159]
    ds_read_b64_tr_b16 v[52:53], v23 offset:40960
    ds_read_b64_tr_b16 v[54:55], v23 offset:41984
    s_waitcnt lgkmcnt(7)
    v_mfma_f32_32x32x16_bf16 v[160:175], v[72:75], v[44:47], v[160:175]
    ds_read_b64_tr_b16 v[56:57], v24 offset:40960
    ds_read_b64_tr_b16 v[58:59], v24 offset:41984
    s_waitcnt lgkmcnt(7)
    v_mfma_f32_32x32x16_bf16 v[176:191], v[76:79], v[44:47], v[176:191]
    ds_read_b64_tr_b16 v[60:61], v25 offset:40960
    ds_read_b64_tr_b16 v[62:63], v25 offset:41984
    s_waitcnt lgkmcnt(6)
    v_mfma_f32_32x32x16_bf16 v[128:143], v[48:51], v[40:43], v[128:143]
    ds_read_b128 v[44:47], v21 offset:32768
    ds_read_b64_tr_b16 v[64:65], v22 offset:45056
    ds_read_b64_tr_b16 v[66:67], v22 offset:46080
    s_lshl_b32 s61, s65, 3
    s_add_u32 s60, s64, s61
    s_add_u32 s60, s60, 65536
    buffer_store_dwordx2 v[96:97], v100, s[32:35], s60 offen sc1
    s_waitcnt lgkmcnt(7)
    v_mfma_f32_32x32x16_bf16 v[144:159], v[52:55], v[40:43], v[144:159]
    ds_read_b64_tr_b16 v[68:69], v23 offset:45056
    ds_read_b64_tr_b16 v[70:71], v23 offset:46080
    s_waitcnt lgkmcnt(7)
    v_mfma_f32_32x32x16_bf16 v[160:175], v[56:59], v[40:43], v[160:175]
    ds_read_b64_tr_b16 v[72:73], v24 offset:45056
    ds_read_b64_tr_b16 v[74:75], v24 offset:46080
    s_waitcnt lgkmcnt(7)
    v_mfma_f32_32x32x16_bf16 v[176:191], v[60:63], v[40:43], v[176:191]
    ds_read_b64_tr_b16 v[76:77], v25 offset:45056
    ds_read_b64_tr_b16 v[78:79], v25 offset:46080
    s_waitcnt lgkmcnt(0)
    s_barrier
    v_mfma_f32_32x32x16_bf16 v[128:143], v[64:67], v[44:47], v[128:143]
    ds_read_b128 v[40:43], v10 offset:0
    ds_read_b64_tr_b16 v[48:49], v14 offset:0
    ds_read_b64_tr_b16 v[50:51], v14 offset:1024
    s_and_b32 s64, s41, 3
    s_lshl_b32 s64, s64, 3
    s_and_b32 s60, s42, 7
    s_add_u32 s60, s60, s64
    s_lshr_b32 s64, s41, 2
    s_lshl_b32 s64, s64, 2
    s_lshr_b32 s61, s42, 3
    s_add_u32 s61, s61, s64
    s_lshl_b32 s67, s61, 14
    s_lshl_b32 s64, s60, 9
    s_add_u32 s67, s67, s64
    s_add_u32 s67, s67, 19726336
    s_mul_i32 s61, s61, 10
    s_add_u32 s61, s61, s43
    s_lshl_b32 s61, s61, 15
    s_lshl_b32 s60, s60, 10
    s_add_u32 s64, s61, s60
    s_add_u32 s64, s64, 10485760
    buffer_store_dwordx4 v[96:99], v100, s[32:35], s64 offen sc1
    v_mfma_f32_32x32x16_bf16 v[144:159], v[68:71], v[44:47], v[144:159]
    ds_read_b64_tr_b16 v[52:53], v15 offset:0
    ds_read_b64_tr_b16 v[54:55], v15 offset:1024
    v_mfma_f32_32x32x16_bf16 v[160:175], v[72:75], v[44:47], v[160:175]
    ds_read_b64_tr_b16 v[56:57], v16 offset:0
    ds_read_b64_tr_b16 v[58:59], v16 offset:1024
    v_mfma_f32_32x32x16_bf16 v[176:191], v[76:79], v[44:47], v[176:191]
    ds_read_b64_tr_b16 v[60:61], v17 offset:0
    ds_read_b64_tr_b16 v[62:63], v17 offset:1024
    s_waitcnt lgkmcnt(6)
    v_mfma_f32_32x32x16_bf16 v[128:143], v[48:51], v[40:43], v[128:143]
    ds_read_b128 v[44:47], v11 offset:0
    ds_read_b64_tr_b16 v[64:65], v14 offset:4096
    ds_read_b64_tr_b16 v[66:67], v14 offset:5120
    s_add_u32 s60, s64, 131072
    buffer_store_dwordx4 v[96:99], v100, s[32:35], s60 offen sc1
    s_waitcnt lgkmcnt(7)
    v_mfma_f32_32x32x16_bf16 v[144:159], v[52:55], v[40:43], v[144:159]
    ds_read_b64_tr_b16 v[68:69], v15 offset:4096
    ds_read_b64_tr_b16 v[70:71], v15 offset:5120
    s_waitcnt lgkmcnt(7)
    v_mfma_f32_32x32x16_bf16 v[160:175], v[56:59], v[40:43], v[160:175]
    ds_read_b64_tr_b16 v[72:73], v16 offset:4096
    ds_read_b64_tr_b16 v[74:75], v16 offset:5120
    s_waitcnt lgkmcnt(7)
    v_mfma_f32_32x32x16_bf16 v[176:191], v[60:63], v[40:43], v[176:191]
    ds_read_b64_tr_b16 v[76:77], v17 offset:4096
    ds_read_b64_tr_b16 v[78:79], v17 offset:5120
    s_waitcnt lgkmcnt(6)
    v_mfma_f32_32x32x16_bf16 v[128:143], v[64:67], v[44:47], v[128:143]
    ds_read_b128 v[40:43], v12 offset:0
    ds_read_b64_tr_b16 v[48:49], v14 offset:8192
    ds_read_b64_tr_b16 v[50:51], v14 offset:9216
    s_add_u32 s60, s64, 262144
    s_mov_b32 s65, 1073741824
    s_cmp_lt_u32 s43, 2
    s_cselect_b32 s60, s60, s65
    buffer_store_dwordx4 v[96:99], v100, s[32:35], s60 offen sc1
    s_waitcnt lgkmcnt(7)
    v_mfma_f32_32x32x16_bf16 v[144:159], v[68:71], v[44:47], v[144:159]
    ds_read_b64_tr_b16 v[52:53], v15 offset:8192
    ds_read_b64_tr_b16 v[54:55], v15 offset:9216
    s_waitcnt lgkmcnt(7)
    v_mfma_f32_32x32x16_bf16 v[160:175], v[72:75], v[44:47], v[160:175]
    ds_read_b64_tr_b16 v[56:57], v16 offset:8192
    ds_read_b64_tr_b16 v[58:59], v16 offset:9216
    s_waitcnt lgkmcnt(7)
    v_mfma_f32_32x32x16_bf16 v[176:191], v[76:79], v[44:47], v[176:191]
    ds_read_b64_tr_b16 v[60:61], v17 offset:8192
    ds_read_b64_tr_b16 v[62:63], v17 offset:9216
    s_waitcnt lgkmcnt(6)
    v_mfma_f32_32x32x16_bf16 v[128:143], v[48:51], v[40:43], v[128:143]
    ds_read_b128 v[44:47], v13 offset:0
    ds_read_b64_tr_b16 v[64:65], v14 offset:12288
    ds_read_b64_tr_b16 v[66:67], v14 offset:13312
    s_waitcnt vmcnt(6)
    v_max3_u32 v80, v232, v233, v234
    v_max3_u32 v80, v80, v235, v236
    v_max3_u32 v80, v80, v237, v238
    v_max3_u32 v80, v80, v239, v240
    v_max3_u32 v80, v80, v241, v242
    v_max3_u32 v80, v80, v243, v244
    v_max3_u32 v80, v80, v245, v246
    v_cmp_eq_u32 vcc, -1, v80
    s_cbranch_vccnz SLOW_57
BACK_58:
    v_pk_add_f32 v[232:233], v[232:233], v[234:235]
    v_add_f32 v242, v242, v243
    v_pk_add_f32 v[232:233], v[232:233], v[236:237]
    v_add_f32 v242, v242, v244
    v_pk_add_f32 v[232:233], v[232:233], v[238:239]
    v_add_f32 v242, v242, v245
    v_pk_add_f32 v[232:233], v[232:233], v[240:241]
    v_add_f32 v242, v242, v246
    v_mov_b32 v80, v242
    v_mov_b32 v81, v242
    s_nop 1
    v_permlane32_swap_b32 v80, v81
    v_add_f32 v242, v80, v81
    s_lshl_b32 s49, s43, 7
    s_add_u32 s49, s49, 159744
    v_add_u32 v82, s49, v102
    ds_write_b32 v82, v242
    v_mov_b32 v80, v232
    v_mov_b32 v81, v232
    s_nop 1
    v_permlane32_swap_b32 v80, v81
    v_add_f32 v232, v80, v81
    v_mov_b32 v80, v233
    v_mov_b32 v81, v233
    s_nop 1
    v_permlane32_swap_b32 v80, v81
    v_add_f32 v233, v80, v81
    v_mul_f32 v232, 0x3acccccd, v232
    v_mul_f32 v233, 0x3acccccd, v233
    v_fma_f32 v233, -v232, v232, v233
    v_max_f32 v233, 0, v233
    v_cvt_pk_bf16_f32 v80, v232, v232
    v_lshlrev_b32 v80, 16, v80
    v_cvt_pk_bf16_f32 v81, v233, v233
    v_lshlrev_b32 v81, 16, v81
    v_add_f32 v81, 0x3727c5ac, v81
    v_cvt_pk_bf16_f32 v81, v81, v81
    v_lshlrev_b32 v81, 16, v81
    v_sqrt_f32 v81, v81
    s_nop 0
    v_cvt_pk_bf16_f32 v81, v81, v81
    v_lshlrev_b32 v81, 16, v81
    v_rcp_f32 v38, v81
    s_mov_b32 s49, 0x3ea52b5c
    s_cmp_lt_u32 s44, 5
    s_cselect_b32 s49, s49, 1.0
    v_mul_f32 v38, s49, v38
    v_mul_f32 v39, v80, v38
    v_sub_f32 v39, 0, v39
    s_waitcnt lgkmcnt(8)
    v_mfma_f32_32x32x16_bf16 v[144:159], v[52:55], v[40:43], v[144:159]
    ds_read_b64_tr_b16 v[68:69], v15 offset:12288
    ds_read_b64_tr_b16 v[70:71], v15 offset:13312
    s_waitcnt lgkmcnt(8)
    v_mfma_f32_32x32x16_bf16 v[160:175], v[56:59], v[40:43], v[160:175]
    ds_read_b64_tr_b16 v[72:73], v16 offset:12288
    ds_read_b64_tr_b16 v[74:75], v16 offset:13312
    s_waitcnt lgkmcnt(8)
    v_mfma_f32_32x32x16_bf16 v[176:191], v[60:63], v[40:43], v[176:191]
    ds_read_b64_tr_b16 v[76:77], v17 offset:12288
    ds_read_b64_tr_b16 v[78:79], v17 offset:13312
    s_waitcnt lgkmcnt(0)
    s_barrier
    v_mfma_f32_32x32x16_bf16 v[128:143], v[64:67], v[44:47], v[128:143]
    ds_read_b128 v[40:43], v10 offset:32768
    ds_read_b64_tr_b16 v[48:49], v14 offset:32768
    ds_read_b64_tr_b16 v[50:51], v14 offset:33792
    s_cmp_eq_u32 s43, 2
    s_cselect_b32 s60, s67, s65
    buffer_store_dwordx2 v[96:97], v101, s[32:35], s60 offen sc1
    v_mfma_f32_32x32x16_bf16 v[144:159], v[68:71], v[44:47], v[144:159]
    ds_read_b64_tr_b16 v[52:53], v15 offset:32768
    ds_read_b64_tr_b16 v[54:55], v15 offset:33792
    v_mfma_f32_32x32x16_bf16 v[160:175], v[72:75], v[44:47], v[160:175]
    ds_read_b64_tr_b16 v[56:57], v16 offset:32768
    ds_read_b64_tr_b16 v[58:59], v16 offset:33792
    v_mfma_f32_32x32x16_bf16 v[176:191], v[76:79], v[44:47], v[176:191]
    ds_read_b64_tr_b16 v[60:61], v17 offset:32768
    ds_read_b64_tr_b16 v[62:63], v17 offset:33792
    s_waitcnt lgkmcnt(6)
    v_mfma_f32_32x32x16_bf16 v[128:143], v[48:51], v[40:43], v[128:143]
    ds_read_b128 v[44:47], v11 offset:32768
    ds_read_b64_tr_b16 v[64:65], v14 offset:36864
    ds_read_b64_tr_b16 v[66:67], v14 offset:37888
    s_and_b32 s64, s41, 1
    s_lshl_b32 s64, s64, 3
    s_and_b32 s60, s42, 7
    s_add_u32 s60, s60, s64
    s_lshr_b32 s64, s41, 1
    s_lshl_b32 s64, s64, 2
    s_lshr_b32 s61, s42, 3
    s_add_u32 s61, s61, s64
    s_mul_i32 s61, s61, 384
    s_mul_i32 s64, s60, 12288
    s_add_u32 s61, s61, s64
    s_mul_i32 s64, s43, 6144
    s_add_u32 s61, s61, s64
    s_add_u32 s61, s61, 20185088
    s_cmp_lt_u32 s60, 10
    s_cselect_b32 s61, s61, s65
    s_cmp_lt_u32 s43, 2
    s_cselect_b32 s61, s61, s65
    s_mov_b64 exec, 0xffffff
    buffer_store_dwordx4 v[96:99], v100, s[32:35], s61 offen sc1
    s_mov_b64 exec, -1
    s_waitcnt lgkmcnt(7)
    v_mfma_f32_32x32x16_bf16 v[144:159], v[52:55], v[40:43], v[144:159]
    ds_read_b64_tr_b16 v[68:69], v15 offset:36864
    ds_read_b64_tr_b16 v[70:71], v15 offset:37888
    s_waitcnt lgkmcnt(7)
    v_mfma_f32_32x32x16_bf16 v[160:175], v[56:59], v[40:43], v[160:175]
    ds_read_b64_tr_b16 v[72:73], v16 offset:36864
    ds_read_b64_tr_b16 v[74:75], v16 offset:37888
    s_lshl_b32 s49, s46, 3
    v_add_u32 v84, s49, v109
    v_lshl_add_u32 v84, v105, 14, v84
    v_lshlrev_b32 v85, 4, v105
    v_add_u32 v85, 159744, v85
    s_add_u32 s49, s43, 0
    s_and_b32 s49, s49, 3
    s_lshl_b32 s52, s49, 7
    v_add_u32 v86, s52, v85
    ds_read_b128 v[192:195], v86 offset:0
    ds_read_b128 v[196:199], v86 offset:32
    ds_read_b128 v[200:203], v86 offset:64
    ds_read_b128 v[204:207], v86 offset:96
    s_add_u32 s49, s43, 1
    s_and_b32 s49, s49, 3
    s_lshl_b32 s52, s49, 7
    v_add_u32 v86, s52, v85
    ds_read_b128 v[208:211], v86 offset:0
    ds_read_b128 v[212:215], v86 offset:32
    ds_read_b128 v[216:219], v86 offset:64
    ds_read_b128 v[220:223], v86 offset:96
    s_waitcnt lgkmcnt(15)
    v_mfma_f32_32x32x16_bf16 v[176:191], v[60:63], v[40:43], v[176:191]
    ds_read_b64_tr_b16 v[76:77], v17 offset:36864
    ds_read_b64_tr_b16 v[78:79], v17 offset:37888
    s_waitcnt lgkmcnt(14)
    v_mfma_f32_32x32x16_bf16 v[128:143], v[64:67], v[44:47], v[128:143]
    ds_read_b128 v[40:43], v12 offset:32768
    ds_read_b64_tr_b16 v[48:49], v14 offset:40960
    ds_read_b64_tr_b16 v[50:51], v14 offset:41984
    s_waitcnt lgkmcnt(9)
    v_pk_mul_f32 v[192:193], v[192:193], v[38:39] op_sel:[0,1] op_sel_hi:[1,1]
    v_pk_mul_f32 v[194:195], v[194:195], v[38:39] op_sel:[0,1] op_sel_hi:[1,1]
    v_pk_mul_f32 v[196:197], v[196:197], v[38:39] op_sel:[0,1] op_sel_hi:[1,1]
    v_pk_mul_f32 v[198:199], v[198:199], v[38:39] op_sel:[0,1] op_sel_hi:[1,1]
    v_pk_mul_f32 v[200:201], v[200:201], v[38:39] op_sel:[0,1] op_sel_hi:[1,1]
    v_pk_mul_f32 v[202:203], v[202:203], v[38:39] op_sel:[0,1] op_sel_hi:[1,1]
    v_pk_mul_f32 v[204:205], v[204:205], v[38:39] op_sel:[0,1] op_sel_hi:[1,1]
    v_pk_mul_f32 v[206:207], v[206:207], v[38:39] op_sel:[0,1] op_sel_hi:[1,1]
    v_mfma_f32_32x32x16_bf16 v[144:159], v[68:71], v[44:47], v[144:159]
    ds_read_b64_tr_b16 v[52:53], v15 offset:40960
    ds_read_b64_tr_b16 v[54:55], v15 offset:41984
    v_mfma_f32_32x32x16_bf16 v[160:175], v[72:75], v[44:47], v[160:175]
    ds_read_b64_tr_b16 v[56:57], v16 offset:40960
    ds_read_b64_tr_b16 v[58:59], v16 offset:41984
    s_waitcnt lgkmcnt(7)
    v_mfma_f32_32x32x16_bf16 v[176:191], v[76:79], v[44:47], v[176:191]
    ds_read_b64_tr_b16 v[60:61], v17 offset:40960
    ds_read_b64_tr_b16 v[62:63], v17 offset:41984
    s_waitcnt lgkmcnt(6)
    v_mfma_f32_32x32x16_bf16 v[128:143], v[48:51], v[40:43], v[128:143]
    ds_read_b128 v[44:47], v13 offset:32768
    ds_read_b64_tr_b16 v[64:65], v14 offset:45056
    ds_read_b64_tr_b16 v[66:67], v14 offset:46080
    v_pk_mul_f32 v[208:209], v[208:209], v[38:39] op_sel:[0,1] op_sel_hi:[1,1]
    v_pk_mul_f32 v[210:211], v[210:211], v[38:39] op_sel:[0,1] op_sel_hi:[1,1]
    v_pk_mul_f32 v[212:213], v[212:213], v[38:39] op_sel:[0,1] op_sel_hi:[1,1]
    v_pk_mul_f32 v[214:215], v[214:215], v[38:39] op_sel:[0,1] op_sel_hi:[1,1]
    v_pk_mul_f32 v[216:217], v[216:217], v[38:39] op_sel:[0,1] op_sel_hi:[1,1]
    v_pk_mul_f32 v[218:219], v[218:219], v[38:39] op_sel:[0,1] op_sel_hi:[1,1]
    v_pk_mul_f32 v[220:221], v[220:221], v[38:39] op_sel:[0,1] op_sel_hi:[1,1]
    v_pk_mul_f32 v[222:223], v[222:223], v[38:39] op_sel:[0,1] op_sel_hi:[1,1]
    s_waitcnt lgkmcnt(7)
    v_mfma_f32_32x32x16_bf16 v[144:159], v[52:55], v[40:43], v[144:159]
    ds_read_b64_tr_b16 v[68:69], v15 offset:45056
    ds_read_b64_tr_b16 v[70:71], v15 offset:46080
    s_waitcnt lgkmcnt(7)
    v_mfma_f32_32x32x16_bf16 v[160:175], v[56:59], v[40:43], v[160:175]
    ds_read_b64_tr_b16 v[72:73], v16 offset:45056
    ds_read_b64_tr_b16 v[74:75], v16 offset:46080
    s_waitcnt lgkmcnt(7)
    v_mfma_f32_32x32x16_bf16 v[176:191], v[60:63], v[40:43], v[176:191]
    ds_read_b64_tr_b16 v[76:77], v17 offset:45056
    ds_read_b64_tr_b16 v[78:79], v17 offset:46080
    s_waitcnt lgkmcnt(6)
    v_mfma_f32_32x32x16_bf16 v[128:143], v[64:67], v[44:47], v[128:143]
    s_waitcnt lgkmcnt(4)
    v_mfma_f32_32x32x16_bf16 v[144:159], v[68:71], v[44:47], v[144:159]
    s_waitcnt lgkmcnt(2)
    v_mfma_f32_32x32x16_bf16 v[160:175], v[72:75], v[44:47], v[160:175]
    s_waitcnt lgkmcnt(0)
    v_mfma_f32_32x32x16_bf16 v[176:191], v[76:79], v[44:47], v[176:191]
    s_barrier
    s_add_u32 s49, s43, 2
    s_and_b32 s49, s49, 3
    s_lshl_b32 s52, s49, 7
    v_add_u32 v86, s52, v85
    ds_read_b128 v[48:51], v86 offset:0
    ds_read_b128 v[52:55], v86 offset:32
    ds_read_b128 v[56:59], v86 offset:64
    ds_read_b128 v[60:63], v86 offset:96
    s_add_u32 s49, s43, 3
    s_and_b32 s49, s49, 3
    s_lshl_b32 s52, s49, 7
    v_add_u32 v86, s52, v85
    ds_read_b128 v[64:67], v86 offset:0
    ds_read_b128 v[68:71], v86 offset:32
    ds_read_b128 v[72:75], v86 offset:64
    ds_read_b128 v[76:79], v86 offset:96
    s_add_u32 s49, s43, 0
    s_and_b32 s49, s49, 3
    s_lshl_b32 s52, s44, 5
    s_lshl_b32 s53, s49, 3
    s_add_u32 s52, s52, s53
    s_lshl_b32 s52, s52, 14
    v_pk_fma_f32 v[128:129], v[128:129], v[38:39], v[192:193] op_sel_hi:[1,0,1]
    v_pk_fma_f32 v[130:131], v[130:131], v[38:39], v[194:195] op_sel_hi:[1,0,1]
    v_cvt_pk_bf16_f32 v112, v128, v129
    v_cvt_pk_bf16_f32 v113, v130, v131
    s_add_u32 s53, s52, 0
    buffer_store_dwordx2 v[112:113], v84, s[32:35], s53 offen sc1
    v_pk_fma_f32 v[132:133], v[132:133], v[38:39], v[196:197] op_sel_hi:[1,0,1]
    v_pk_fma_f32 v[134:135], v[134:135], v[38:39], v[198:199] op_sel_hi:[1,0,1]
    v_cvt_pk_bf16_f32 v114, v132, v133
    v_cvt_pk_bf16_f32 v115, v134, v135
    s_add_u32 s53, s52, 32768
    buffer_store_dwordx2 v[114:115], v84, s[32:35], s53 offen sc1
    v_pk_fma_f32 v[136:137], v[136:137], v[38:39], v[200:201] op_sel_hi:[1,0,1]
    v_pk_fma_f32 v[138:139], v[138:139], v[38:39], v[202:203] op_sel_hi:[1,0,1]
    v_cvt_pk_bf16_f32 v116, v136, v137
    v_cvt_pk_bf16_f32 v117, v138, v139
    s_add_u32 s53, s52, 65536
    buffer_store_dwordx2 v[116:117], v84, s[32:35], s53 offen sc1
    v_pk_fma_f32 v[140:141], v[140:141], v[38:39], v[204:205] op_sel_hi:[1,0,1]
    v_pk_fma_f32 v[142:143], v[142:143], v[38:39], v[206:207] op_sel_hi:[1,0,1]
    v_cvt_pk_bf16_f32 v118, v140, v141
    v_cvt_pk_bf16_f32 v119, v142, v143
    s_add_u32 s53, s52, 98304
    buffer_store_dwordx2 v[118:119], v84, s[32:35], s53 offen sc1
    s_add_u32 s49, s43, 1
    s_and_b32 s49, s49, 3
    s_lshl_b32 s52, s44, 5
    s_lshl_b32 s53, s49, 3
    s_add_u32 s52, s52, s53
    s_lshl_b32 s52, s52, 14
    v_pk_fma_f32 v[144:145], v[144:145], v[38:39], v[208:209] op_sel_hi:[1,0,1]
    v_pk_fma_f32 v[146:147], v[146:147], v[38:39], v[210:211] op_sel_hi:[1,0,1]
    v_cvt_pk_bf16_f32 v112, v144, v145
    v_cvt_pk_bf16_f32 v113, v146, v147
    s_add_u32 s53, s52, 0
    buffer_store_dwordx2 v[112:113], v84, s[32:35], s53 offen sc1
    v_pk_fma_f32 v[148:149], v[148:149], v[38:39], v[212:213] op_sel_hi:[1,0,1]
    v_pk_fma_f32 v[150:151], v[150:151], v[38:39], v[214:215] op_sel_hi:[1,0,1]
    v_cvt_pk_bf16_f32 v114, v148, v149
    v_cvt_pk_bf16_f32 v115, v150, v151
    s_add_u32 s53, s52, 32768
    buffer_store_dwordx2 v[114:115], v84, s[32:35], s53 offen sc1
    v_pk_fma_f32 v[152:153], v[152:153], v[38:39], v[216:217] op_sel_hi:[1,0,1]
    v_pk_fma_f32 v[154:155], v[154:155], v[38:39], v[218:219] op_sel_hi:[1,0,1]
    v_cvt_pk_bf16_f32 v116, v152, v153
    v_cvt_pk_bf16_f32 v117, v154, v155
    s_add_u32 s53, s52, 65536
    buffer_store_dwordx2 v[116:117], v84, s[32:35], s53 offen sc1
    v_pk_fma_f32 v[156:157], v[156:157], v[38:39], v[220:221] op_sel_hi:[1,0,1]
    v_pk_fma_f32 v[158:159], v[158:159], v[38:39], v[222:223] op_sel_hi:[1,0,1]
    v_cvt_pk_bf16_f32 v118, v156, v157
    v_cvt_pk_bf16_f32 v119, v158, v159
    s_add_u32 s53, s52, 98304
    buffer_store_dwordx2 v[118:119], v84, s[32:35], s53 offen sc1
    s_add_u32 s49, s43, 2
    s_and_b32 s49, s49, 3
    s_lshl_b32 s52, s44, 5
    s_lshl_b32 s53, s49, 3
    s_add_u32 s52, s52, s53
    s_lshl_b32 s52, s52, 14
    s_waitcnt lgkmcnt(4)
    v_pk_mul_f32 v[48:49], v[48:49], v[38:39] op_sel:[0,1] op_sel_hi:[1,1]
    v_pk_mul_f32 v[50:51], v[50:51], v[38:39] op_sel:[0,1] op_sel_hi:[1,1]
    v_pk_mul_f32 v[52:53], v[52:53], v[38:39] op_sel:[0,1] op_sel_hi:[1,1]
    v_pk_mul_f32 v[54:55], v[54:55], v[38:39] op_sel:[0,1] op_sel_hi:[1,1]
    v_pk_mul_f32 v[56:57], v[56:57], v[38:39] op_sel:[0,1] op_sel_hi:[1,1]
    v_pk_mul_f32 v[58:59], v[58:59], v[38:39] op_sel:[0,1] op_sel_hi:[1,1]
    v_pk_mul_f32 v[60:61], v[60:61], v[38:39] op_sel:[0,1] op_sel_hi:[1,1]
    v_pk_mul_f32 v[62:63], v[62:63], v[38:39] op_sel:[0,1] op_sel_hi:[1,1]
    v_pk_fma_f32 v[160:161], v[160:161], v[38:39], v[48:49] op_sel_hi:[1,0,1]
    v_pk_fma_f32 v[162:163], v[162:163], v[38:39], v[50:51] op_sel_hi:[1,0,1]
    v_cvt_pk_bf16_f32 v112, v160, v161
    v_cvt_pk_bf16_f32 v113, v162, v163
    s_add_u32 s53, s52, 0
    buffer_store_dwordx2 v[112:113], v84, s[32:35], s53 offen sc1
    v_pk_fma_f32 v[164:165], v[164:165], v[38:39], v[52:53] op_sel_hi:[1,0,1]
    v_pk_fma_f32 v[166:167], v[166:167], v[38:39], v[54:55] op_sel_hi:[1,0,1]
    v_cvt_pk_bf16_f32 v114, v164, v165
    v_cvt_pk_bf16_f32 v115, v166, v167
    s_add_u32 s53, s52, 32768
    buffer_store_dwordx2 v[114:115], v84, s[32:35], s53 offen sc1
    v_pk_fma_f32 v[168:169], v[168:169], v[38:39], v[56:57] op_sel_hi:[1,0,1]
    v_pk_fma_f32 v[170:171], v[170:171], v[38:39], v[58:59] op_sel_hi:[1,0,1]
    v_cvt_pk_bf16_f32 v116, v168, v169
    v_cvt_pk_bf16_f32 v117, v170, v171
    s_add_u32 s53, s52, 65536
    buffer_store_dwordx2 v[116:117], v84, s[32:35], s53 offen sc1
    v_pk_fma_f32 v[172:173], v[172:173], v[38:39], v[60:61] op_sel_hi:[1,0,1]
    v_pk_fma_f32 v[174:175], v[174:175], v[38:39], v[62:63] op_sel_hi:[1,0,1]
    v_cvt_pk_bf16_f32 v118, v172, v173
    v_cvt_pk_bf16_f32 v119, v174, v175
    s_add_u32 s53, s52, 98304
    buffer_store_dwordx2 v[118:119], v84, s[32:35], s53 offen sc1
    s_add_u32 s49, s43, 3
    s_and_b32 s49, s49, 3
    s_lshl_b32 s52, s44, 5
    s_lshl_b32 s53, s49, 3
    s_add_u32 s52, s52, s53
    s_lshl_b32 s52, s52, 14
    s_waitcnt lgkmcnt(0)
    v_pk_mul_f32 v[64:65], v[64:65], v[38:39] op_sel:[0,1] op_sel_hi:[1,1]
    v_pk_mul_f32 v[66:67], v[66:67], v[38:39] op_sel:[0,1] op_sel_hi:[1,1]
    v_pk_mul_f32 v[68:69], v[68:69], v[38:39] op_sel:[0,1] op_sel_hi:[1,1]
    v_pk_mul_f32 v[70:71], v[70:71], v[38:39] op_sel:[0,1] op_sel_hi:[1,1]
    v_pk_mul_f32 v[72:73], v[72:73], v[38:39] op_sel:[0,1] op_sel_hi:[1,1]
    v_pk_mul_f32 v[74:75], v[74:75], v[38:39] op_sel:[0,1] op_sel_hi:[1,1]
    v_pk_mul_f32 v[76:77], v[76:77], v[38:39] op_sel:[0,1] op_sel_hi:[1,1]
    v_pk_mul_f32 v[78:79], v[78:79], v[38:39] op_sel:[0,1] op_sel_hi:[1,1]
    v_pk_fma_f32 v[176:177], v[176:177], v[38:39], v[64:65] op_sel_hi:[1,0,1]
    v_pk_fma_f32 v[178:179], v[178:179], v[38:39], v[66:67] op_sel_hi:[1,0,1]
    v_cvt_pk_bf16_f32 v112, v176, v177
    v_cvt_pk_bf16_f32 v113, v178, v179
    s_add_u32 s53, s52, 0
    buffer_store_dwordx2 v[112:113], v84, s[32:35], s53 offen sc1
    v_pk_fma_f32 v[180:181], v[180:181], v[38:39], v[68:69] op_sel_hi:[1,0,1]
    v_pk_fma_f32 v[182:183], v[182:183], v[38:39], v[70:71] op_sel_hi:[1,0,1]
    v_cvt_pk_bf16_f32 v114, v180, v181
    v_cvt_pk_bf16_f32 v115, v182, v183
    s_add_u32 s53, s52, 32768
    buffer_store_dwordx2 v[114:115], v84, s[32:35], s53 offen sc1
    v_pk_fma_f32 v[184:185], v[184:185], v[38:39], v[72:73] op_sel_hi:[1,0,1]
    v_pk_fma_f32 v[186:187], v[186:187], v[38:39], v[74:75] op_sel_hi:[1,0,1]
    v_cvt_pk_bf16_f32 v116, v184, v185
    v_cvt_pk_bf16_f32 v117, v186, v187
    s_add_u32 s53, s52, 65536
    buffer_store_dwordx2 v[116:117], v84, s[32:35], s53 offen sc1
    v_pk_fma_f32 v[188:189], v[188:189], v[38:39], v[76:77] op_sel_hi:[1,0,1]
    v_pk_fma_f32 v[190:191], v[190:191], v[38:39], v[78:79] op_sel_hi:[1,0,1]
    v_cvt_pk_bf16_f32 v118, v188, v189
    v_cvt_pk_bf16_f32 v119, v190, v191
    s_add_u32 s53, s52, 98304
    buffer_store_dwordx2 v[118:119], v84, s[32:35], s53 offen sc1
    s_lshl_b32 s49, s45, 4
    s_add_u32 s49, s49, s44
    s_waitcnt vmcnt(0) lgkmcnt(0)
    v_mov_b32 v80, 1
    v_mov_b32 v81, 162824
    s_mov_b64 exec, 1
    ds_add_rtn_u32 v80, v81, v80
    s_mov_b64 exec, -1
    s_lshl_b32 s60, s49, 2
    s_add_u32 s60, s60, 19431424
    s_waitcnt lgkmcnt(0)
    v_readfirstlane_b32 s61, v80
    v_mov_b32 v80, s3
    v_lshlrev_b32 v81, 10, v1
    s_cmp_eq_u32 s61, 3
    s_cselect_b32 s60, s60, 1073741824
    s_mov_b64 exec, 0xff
    buffer_store_dword v80, v81, s[32:35], s60 offen sc1
    s_mov_b64 exec, -1
    s_branch C_P1D_9
P1_V_7:
    ds_read_b128 v[40:43], v10 offset:0
    ds_read_b64_tr_b16 v[48:49], v14 offset:0
    ds_read_b64_tr_b16 v[50:51], v14 offset:1024
    ds_read_b64_tr_b16 v[52:53], v15 offset:0
    ds_read_b64_tr_b16 v[54:55], v15 offset:1024
    ds_read_b64_tr_b16 v[56:57], v16 offset:0
    ds_read_b64_tr_b16 v[58:59], v16 offset:1024
    ds_read_b64_tr_b16 v[60:61], v17 offset:0
    ds_read_b64_tr_b16 v[62:63], v17 offset:1024
    s_waitcnt lgkmcnt(6)
    v_mfma_f32_32x32x16_bf16 v[128:143], v[40:43], v[48:51], 0
    ds_read_b128 v[44:47], v11 offset:0
    ds_read_b64_tr_b16 v[64:65], v14 offset:4096
    ds_read_b64_tr_b16 v[66:67], v14 offset:5120
    s_cmp_eq_u32 s55, 0
    s_cbranch_scc1 OUT_60
OBK_61:
    s_waitcnt lgkmcnt(7)
    v_mfma_f32_32x32x16_bf16 v[144:159], v[40:43], v[52:55], 0
    ds_read_b64_tr_b16 v[68:69], v15 offset:4096
    ds_read_b64_tr_b16 v[70:71], v15 offset:5120
    s_waitcnt lgkmcnt(7)
    v_mfma_f32_32x32x16_bf16 v[160:175], v[40:43], v[56:59], 0
    ds_read_b64_tr_b16 v[72:73], v16 offset:4096
    ds_read_b64_tr_b16 v[74:75], v16 offset:5120
    s_waitcnt lgkmcnt(7)
    v_mfma_f32_32x32x16_bf16 v[176:191], v[40:43], v[60:63], 0
    ds_read_b64_tr_b16 v[76:77], v17 offset:4096
    ds_read_b64_tr_b16 v[78:79], v17 offset:5120
    s_waitcnt lgkmcnt(6)
    v_mfma_f32_32x32x16_bf16 v[128:143], v[44:47], v[64:67], v[128:143]
    ds_read_b128 v[40:43], v12 offset:0
    ds_read_b64_tr_b16 v[48:49], v14 offset:8192
    ds_read_b64_tr_b16 v[50:51], v14 offset:9216
    s_cmp_eq_u32 s55, 0
    s_cbranch_scc1 OUT_62
OBK_63:
    s_waitcnt lgkmcnt(7)
    v_mfma_f32_32x32x16_bf16 v[144:159], v[44:47], v[68:71], v[144:159]
    ds_read_b64_tr_b16 v[52:53], v15 offset:8192
    ds_read_b64_tr_b16 v[54:55], v15 offset:9216
    s_waitcnt lgkmcnt(7)
    v_mfma_f32_32x32x16_bf16 v[160:175], v[44:47], v[72:75], v[160:175]
    ds_read_b64_tr_b16 v[56:57], v16 offset:8192
    ds_read_b64_tr_b16 v[58:59], v16 offset:9216
    s_waitcnt lgkmcnt(7)
    v_mfma_f32_32x32x16_bf16 v[176:191], v[44:47], v[76:79], v[176:191]
    ds_read_b64_tr_b16 v[60:61], v17 offset:8192
    ds_read_b64_tr_b16 v[62:63], v17 offset:9216
    s_waitcnt lgkmcnt(6)
    v_mfma_f32_32x32x16_bf16 v[128:143], v[40:43], v[48:51], v[128:143]
    ds_read_b128 v[44:47], v13 offset:0
    ds_read_b64_tr_b16 v[64:65], v14 offset:12288
    ds_read_b64_tr_b16 v[66:67], v14 offset:13312
    s_cmp_eq_u32 s55, 0
    s_cbranch_scc1 OUT_64
OBK_65:
    s_waitcnt lgkmcnt(7)
    v_mfma_f32_32x32x16_bf16 v[144:159], v[40:43], v[52:55], v[144:159]
    ds_read_b64_tr_b16 v[68:69], v15 offset:12288
    ds_read_b64_tr_b16 v[70:71], v15 offset:13312
    s_waitcnt lgkmcnt(7)
    v_mfma_f32_32x32x16_bf16 v[160:175], v[40:43], v[56:59], v[160:175]
    ds_read_b64_tr_b16 v[72:73], v16 offset:12288
    ds_read_b64_tr_b16 v[74:75], v16 offset:13312
    s_waitcnt lgkmcnt(7)
    v_mfma_f32_32x32x16_bf16 v[176:191], v[40:43], v[60:63], v[176:191]
    ds_read_b64_tr_b16 v[76:77], v17 offset:12288
    ds_read_b64_tr_b16 v[78:79], v17 offset:13312
    s_waitcnt lgkmcnt(0)
    s_barrier
    v_mfma_f32_32x32x16_bf16 v[128:143], v[44:47], v[64:67], v[128:143]
    ds_read_b128 v[40:43], v10 offset:32768
    ds_read_b64_tr_b16 v[48:49], v14 offset:32768
    ds_read_b64_tr_b16 v[50:51], v14 offset:33792
    s_cmp_eq_u32 s55, 0
    s_cbranch_scc1 OUT_66
OBK_67:
    v_mfma_f32_32x32x16_bf16 v[144:159], v[44:47], v[68:71], v[144:159]
    ds_read_b64_tr_b16 v[52:53], v15 offset:32768
    ds_read_b64_tr_b16 v[54:55], v15 offset:33792
    v_mfma_f32_32x32x16_bf16 v[160:175], v[44:47], v[72:75], v[160:175]
    ds_read_b64_tr_b16 v[56:57], v16 offset:32768
    ds_read_b64_tr_b16 v[58:59], v16 offset:33792
    v_mfma_f32_32x32x16_bf16 v[176:191], v[44:47], v[76:79], v[176:191]
    ds_read_b64_tr_b16 v[60:61], v17 offset:32768
    ds_read_b64_tr_b16 v[62:63], v17 offset:33792
    s_waitcnt lgkmcnt(6)
    v_mfma_f32_32x32x16_bf16 v[128:143], v[40:43], v[48:51], v[128:143]
    ds_read_b128 v[44:47], v11 offset:32768
    ds_read_b64_tr_b16 v[64:65], v14 offset:36864
    ds_read_b64_tr_b16 v[66:67], v14 offset:37888
    s_cmp_eq_u32 s55, 1
    s_cbranch_scc1 OUT_68
OBK_69:
    s_waitcnt lgkmcnt(7)
    v_mfma_f32_32x32x16_bf16 v[144:159], v[40:43], v[52:55], v[144:159]
    ds_read_b64_tr_b16 v[68:69], v15 offset:36864
    ds_read_b64_tr_b16 v[70:71], v15 offset:37888
    s_waitcnt lgkmcnt(7)
    v_mfma_f32_32x32x16_bf16 v[160:175], v[40:43], v[56:59], v[160:175]
    ds_read_b64_tr_b16 v[72:73], v16 offset:36864
    ds_read_b64_tr_b16 v[74:75], v16 offset:37888
    s_waitcnt lgkmcnt(7)
    v_mfma_f32_32x32x16_bf16 v[176:191], v[40:43], v[60:63], v[176:191]
    ds_read_b64_tr_b16 v[76:77], v17 offset:36864
    ds_read_b64_tr_b16 v[78:79], v17 offset:37888
    s_waitcnt lgkmcnt(6)
    v_mfma_f32_32x32x16_bf16 v[128:143], v[44:47], v[64:67], v[128:143]
    ds_read_b128 v[40:43], v12 offset:32768
    ds_read_b64_tr_b16 v[48:49], v14 offset:40960
    ds_read_b64_tr_b16 v[50:51], v14 offset:41984
    s_cmp_eq_u32 s55, 1
    s_cbranch_scc1 OUT_70
OBK_71:
    s_waitcnt lgkmcnt(7)
    v_mfma_f32_32x32x16_bf16 v[144:159], v[44:47], v[68:71], v[144:159]
    ds_read_b64_tr_b16 v[52:53], v15 offset:40960
    ds_read_b64_tr_b16 v[54:55], v15 offset:41984
    s_waitcnt lgkmcnt(7)
    v_mfma_f32_32x32x16_bf16 v[160:175], v[44:47], v[72:75], v[160:175]
    ds_read_b64_tr_b16 v[56:57], v16 offset:40960
    ds_read_b64_tr_b16 v[58:59], v16 offset:41984
    s_waitcnt lgkmcnt(7)
    v_mfma_f32_32x32x16_bf16 v[176:191], v[44:47], v[76:79], v[176:191]
    ds_read_b64_tr_b16 v[60:61], v17 offset:40960
    ds_read_b64_tr_b16 v[62:63], v17 offset:41984
    s_waitcnt lgkmcnt(6)
    v_mfma_f32_32x32x16_bf16 v[128:143], v[40:43], v[48:51], v[128:143]
    ds_read_b128 v[44:47], v13 offset:32768
    ds_read_b64_tr_b16 v[64:65], v14 offset:45056
    ds_read_b64_tr_b16 v[66:67], v14 offset:46080
    s_cmp_eq_u32 s55, 1
    s_cbranch_scc1 OUT_72
OBK_73:
    s_waitcnt lgkmcnt(7)
    v_mfma_f32_32x32x16_bf16 v[144:159], v[40:43], v[52:55], v[144:159]
    ds_read_b64_tr_b16 v[68:69], v15 offset:45056
    ds_read_b64_tr_b16 v[70:71], v15 offset:46080
    s_waitcnt lgkmcnt(7)
    v_mfma_f32_32x32x16_bf16 v[160:175], v[40:43], v[56:59], v[160:175]
    ds_read_b64_tr_b16 v[72:73], v16 offset:45056
    ds_read_b64_tr_b16 v[74:75], v16 offset:46080
    s_waitcnt lgkmcnt(7)
    v_mfma_f32_32x32x16_bf16 v[176:191], v[40:43], v[60:63], v[176:191]
    ds_read_b64_tr_b16 v[76:77], v17 offset:45056
    ds_read_b64_tr_b16 v[78:79], v17 offset:46080
    s_cmp_eq_u32 s40, 0
    s_cbranch_scc1 OUT_74
OBK_75:
    s_waitcnt vmcnt(0)
    s_waitcnt lgkmcnt(0)
    s_barrier
    v_mov_b32 v107, s3
    v_lshlrev_b32 v108, 10, v1
    s_lshl_b32 s60, s2, 2
    s_add_u32 s60, s60, 19447808
    s_mov_b32 s61, 1073741824
    s_cmp_eq_u32 s40, 0
    s_cselect_b32 s60, s60, s61
    s_mov_b64 exec, 0xff
    buffer_store_dword v107, v108, s[32:35], s60 offen sc1
    s_mov_b64 exec, -1
    v_mov_b32 v107, 162816
    ds_read_b32 v107, v107
    s_waitcnt lgkmcnt(0)
    v_readfirstlane_b32 s3, v107
    v_mfma_f32_32x32x16_bf16 v[128:143], v[44:47], v[64:67], v[128:143]
    ds_read_b128 v[40:43], v18 offset:0
    ds_read_b64_tr_b16 v[48:49], v22 offset:0
    ds_read_b64_tr_b16 v[50:51], v22 offset:1024
    s_cmp_eq_u32 s55, 1
    s_cbranch_scc1 OUT_79
OBK_80:
    v_mfma_f32_32x32x16_bf16 v[144:159], v[44:47], v[68:71], v[144:159]
    ds_read_b64_tr_b16 v[52:53], v23 offset:0
    ds_read_b64_tr_b16 v[54:55], v23 offset:1024
    v_mfma_f32_32x32x16_bf16 v[160:175], v[44:47], v[72:75], v[160:175]
    ds_read_b64_tr_b16 v[56:57], v24 offset:0
    ds_read_b64_tr_b16 v[58:59], v24 offset:1024
    v_mfma_f32_32x32x16_bf16 v[176:191], v[44:47], v[76:79], v[176:191]
    ds_read_b64_tr_b16 v[60:61], v25 offset:0
    ds_read_b64_tr_b16 v[62:63], v25 offset:1024
    s_waitcnt lgkmcnt(6)
    v_mfma_f32_32x32x16_bf16 v[128:143], v[40:43], v[48:51], v[128:143]
    ds_read_b128 v[44:47], v19 offset:0
    ds_read_b64_tr_b16 v[64:65], v22 offset:4096
    ds_read_b64_tr_b16 v[66:67], v22 offset:5120
    s_cmp_eq_u32 s55, 2
    s_cbranch_scc1 OUT_81
OBK_82:
    s_waitcnt lgkmcnt(7)
    v_mfma_f32_32x32x16_bf16 v[144:159], v[40:43], v[52:55], v[144:159]
    ds_read_b64_tr_b16 v[68:69], v23 offset:4096
    ds_read_b64_tr_b16 v[70:71], v23 offset:5120
    s_waitcnt lgkmcnt(7)
    v_mfma_f32_32x32x16_bf16 v[160:175], v[40:43], v[56:59], v[160:175]
    ds_read_b64_tr_b16 v[72:73], v24 offset:4096
    ds_read_b64_tr_b16 v[74:75], v24 offset:5120
    s_waitcnt lgkmcnt(7)
    v_mfma_f32_32x32x16_bf16 v[176:191], v[40:43], v[60:63], v[176:191]
    ds_read_b64_tr_b16 v[76:77], v25 offset:4096
    ds_read_b64_tr_b16 v[78:79], v25 offset:5120
    s_waitcnt lgkmcnt(6)
    v_mfma_f32_32x32x16_bf16 v[128:143], v[44:47], v[64:67], v[128:143]
    ds_read_b128 v[40:43], v20 offset:0
    ds_read_b64_tr_b16 v[48:49], v22 offset:8192
    ds_read_b64_tr_b16 v[50:51], v22 offset:9216
    s_cmp_eq_u32 s55, 2
    s_cbranch_scc1 OUT_83
OBK_84:
    s_waitcnt lgkmcnt(7)
    v_mfma_f32_32x32x16_bf16 v[144:159], v[44:47], v[68:71], v[144:159]
    ds_read_b64_tr_b16 v[52:53], v23 offset:8192
    ds_read_b64_tr_b16 v[54:55], v23 offset:9216
    s_waitcnt lgkmcnt(7)
    v_mfma_f32_32x32x16_bf16 v[160:175], v[44:47], v[72:75], v[160:175]
    ds_read_b64_tr_b16 v[56:57], v24 offset:8192
    ds_read_b64_tr_b16 v[58:59], v24 offset:9216
    s_waitcnt lgkmcnt(7)
    v_mfma_f32_32x32x16_bf16 v[176:191], v[44:47], v[76:79], v[176:191]
    ds_read_b64_tr_b16 v[60:61], v25 offset:8192
    ds_read_b64_tr_b16 v[62:63], v25 offset:9216
    s_waitcnt lgkmcnt(6)
    v_mfma_f32_32x32x16_bf16 v[128:143], v[40:43], v[48:51], v[128:143]
    ds_read_b128 v[44:47], v21 offset:0
    ds_read_b64_tr_b16 v[64:65], v22 offset:12288
    ds_read_b64_tr_b16 v[66:67], v22 offset:13312
    s_cmp_eq_u32 s55, 2
    s_cbranch_scc1 OUT_85
OBK_86:
    s_waitcnt lgkmcnt(7)
    v_mfma_f32_32x32x16_bf16 v[144:159], v[40:43], v[52:55], v[144:159]
    ds_read_b64_tr_b16 v[68:69], v23 offset:12288
    ds_read_b64_tr_b16 v[70:71], v23 offset:13312
    s_waitcnt lgkmcnt(7)
    v_mfma_f32_32x32x16_bf16 v[160:175], v[40:43], v[56:59], v[160:175]
    ds_read_b64_tr_b16 v[72:73], v24 offset:12288
    ds_read_b64_tr_b16 v[74:75], v24 offset:13312
    s_waitcnt lgkmcnt(7)
    v_mfma_f32_32x32x16_bf16 v[176:191], v[40:43], v[60:63], v[176:191]
    ds_read_b64_tr_b16 v[76:77], v25 offset:12288
    ds_read_b64_tr_b16 v[78:79], v25 offset:13312
    s_waitcnt lgkmcnt(0)
    s_barrier
    v_mfma_f32_32x32x16_bf16 v[128:143], v[44:47], v[64:67], v[128:143]
    ds_read_b128 v[40:43], v18 offset:32768
    ds_read_b64_tr_b16 v[48:49], v22 offset:32768
    ds_read_b64_tr_b16 v[50:51], v22 offset:33792
    s_cmp_eq_u32 s55, 2
    s_cbranch_scc1 OUT_87
OBK_88:
    v_mfma_f32_32x32x16_bf16 v[144:159], v[44:47], v[68:71], v[144:159]
    ds_read_b64_tr_b16 v[52:53], v23 offset:32768
    ds_read_b64_tr_b16 v[54:55], v23 offset:33792
    v_mfma_f32_32x32x16_bf16 v[160:175], v[44:47], v[72:75], v[160:175]
    ds_read_b64_tr_b16 v[56:57], v24 offset:32768
    ds_read_b64_tr_b16 v[58:59], v24 offset:33792
    v_mfma_f32_32x32x16_bf16 v[176:191], v[44:47], v[76:79], v[176:191]
    ds_read_b64_tr_b16 v[60:61], v25 offset:32768
    ds_read_b64_tr_b16 v[62:63], v25 offset:33792
    s_waitcnt lgkmcnt(6)
    v_mfma_f32_32x32x16_bf16 v[128:143], v[40:43], v[48:51], v[128:143]
    ds_read_b128 v[44:47], v19 offset:32768
    ds_read_b64_tr_b16 v[64:65], v22 offset:36864
    ds_read_b64_tr_b16 v[66:67], v22 offset:37888
    s_cmp_eq_u32 s55, 3
    s_cbranch_scc1 OUT_89
OBK_90:
    s_waitcnt lgkmcnt(7)
    v_mfma_f32_32x32x16_bf16 v[144:159], v[40:43], v[52:55], v[144:159]
    ds_read_b64_tr_b16 v[68:69], v23 offset:36864
    ds_read_b64_tr_b16 v[70:71], v23 offset:37888
    s_waitcnt lgkmcnt(7)
    v_mfma_f32_32x32x16_bf16 v[160:175], v[40:43], v[56:59], v[160:175]
    ds_read_b64_tr_b16 v[72:73], v24 offset:36864
    ds_read_b64_tr_b16 v[74:75], v24 offset:37888
    s_waitcnt lgkmcnt(7)
    v_mfma_f32_32x32x16_bf16 v[176:191], v[40:43], v[60:63], v[176:191]
    ds_read_b64_tr_b16 v[76:77], v25 offset:36864
    ds_read_b64_tr_b16 v[78:79], v25 offset:37888
    s_waitcnt lgkmcnt(6)
    v_mfma_f32_32x32x16_bf16 v[128:143], v[44:47], v[64:67], v[128:143]
    ds_read_b128 v[40:43], v20 offset:32768
    ds_read_b64_tr_b16 v[48:49], v22 offset:40960
    ds_read_b64_tr_b16 v[50:51], v22 offset:41984
    s_cmp_eq_u32 s55, 3
    s_cbranch_scc1 OUT_91
OBK_92:
    s_waitcnt lgkmcnt(7)
    v_mfma_f32_32x32x16_bf16 v[144:159], v[44:47], v[68:71], v[144:159]
    ds_read_b64_tr_b16 v[52:53], v23 offset:40960
    ds_read_b64_tr_b16 v[54:55], v23 offset:41984
    s_waitcnt lgkmcnt(7)
    v_mfma_f32_32x32x16_bf16 v[160:175], v[44:47], v[72:75], v[160:175]
    ds_read_b64_tr_b16 v[56:57], v24 offset:40960
    ds_read_b64_tr_b16 v[58:59], v24 offset:41984
    s_waitcnt lgkmcnt(7)
    v_mfma_f32_32x32x16_bf16 v[176:191], v[44:47], v[76:79], v[176:191]
    ds_read_b64_tr_b16 v[60:61], v25 offset:40960
    ds_read_b64_tr_b16 v[62:63], v25 offset:41984
    s_waitcnt lgkmcnt(6)
    v_mfma_f32_32x32x16_bf16 v[128:143], v[40:43], v[48:51], v[128:143]
    ds_read_b128 v[44:47], v21 offset:32768
    ds_read_b64_tr_b16 v[64:65], v22 offset:45056
    ds_read_b64_tr_b16 v[66:67], v22 offset:46080
    s_cmp_eq_u32 s55, 3
    s_cbranch_scc1 OUT_93
OBK_94:
    s_waitcnt lgkmcnt(7)
    v_mfma_f32_32x32x16_bf16 v[144:159], v[40:43], v[52:55], v[144:159]
    ds_read_b64_tr_b16 v[68:69], v23 offset:45056
    ds_read_b64_tr_b16 v[70:71], v23 offset:46080
    s_waitcnt lgkmcnt(7)
    v_mfma_f32_32x32x16_bf16 v[160:175], v[40:43], v[56:59], v[160:175]
    ds_read_b64_tr_b16 v[72:73], v24 offset:45056
    ds_read_b64_tr_b16 v[74:75], v24 offset:46080
    s_waitcnt lgkmcnt(7)
    v_mfma_f32_32x32x16_bf16 v[176:191], v[40:43], v[60:63], v[176:191]
    ds_read_b64_tr_b16 v[76:77], v25 offset:45056
    ds_read_b64_tr_b16 v[78:79], v25 offset:46080
    s_waitcnt lgkmcnt(0)
    s_barrier
    v_mfma_f32_32x32x16_bf16 v[128:143], v[44:47], v[64:67], v[128:143]
    ds_read_b128 v[40:43], v10 offset:0
    ds_read_b64_tr_b16 v[48:49], v14 offset:0
    ds_read_b64_tr_b16 v[50:51], v14 offset:1024
    s_cmp_eq_u32 s55, 3
    s_cbranch_scc1 OUT_95
OBK_96:
    v_mfma_f32_32x32x16_bf16 v[144:159], v[44:47], v[68:71], v[144:159]
    ds_read_b64_tr_b16 v[52:53], v15 offset:0
    ds_read_b64_tr_b16 v[54:55], v15 offset:1024
    v_mfma_f32_32x32x16_bf16 v[160:175], v[44:47], v[72:75], v[160:175]
    ds_read_b64_tr_b16 v[56:57], v16 offset:0
    ds_read_b64_tr_b16 v[58:59], v16 offset:1024
    v_mfma_f32_32x32x16_bf16 v[176:191], v[44:47], v[76:79], v[176:191]
    ds_read_b64_tr_b16 v[60:61], v17 offset:0
    ds_read_b64_tr_b16 v[62:63], v17 offset:1024
    s_waitcnt lgkmcnt(6)
    v_mfma_f32_32x32x16_bf16 v[128:143], v[40:43], v[48:51], v[128:143]
    ds_read_b128 v[44:47], v11 offset:0
    ds_read_b64_tr_b16 v[64:65], v14 offset:4096
    ds_read_b64_tr_b16 v[66:67], v14 offset:5120
    s_cmp_eq_u32 s55, 4
    s_cbranch_scc1 OUT_97
OBK_98:
    s_waitcnt lgkmcnt(7)
    v_mfma_f32_32x32x16_bf16 v[144:159], v[40:43], v[52:55], v[144:159]
    ds_read_b64_tr_b16 v[68:69], v15 offset:4096
    ds_read_b64_tr_b16 v[70:71], v15 offset:5120
    s_waitcnt lgkmcnt(7)
    v_mfma_f32_32x32x16_bf16 v[160:175], v[40:43], v[56:59], v[160:175]
    ds_read_b64_tr_b16 v[72:73], v16 offset:4096
    ds_read_b64_tr_b16 v[74:75], v16 offset:5120
    s_waitcnt lgkmcnt(7)
    v_mfma_f32_32x32x16_bf16 v[176:191], v[40:43], v[60:63], v[176:191]
    ds_read_b64_tr_b16 v[76:77], v17 offset:4096
    ds_read_b64_tr_b16 v[78:79], v17 offset:5120
    s_waitcnt lgkmcnt(6)
    v_mfma_f32_32x32x16_bf16 v[128:143], v[44:47], v[64:67], v[128:143]
    ds_read_b128 v[40:43], v12 offset:0
    ds_read_b64_tr_b16 v[48:49], v14 offset:8192
    ds_read_b64_tr_b16 v[50:51], v14 offset:9216
    s_cmp_eq_u32 s55, 4
    s_cbranch_scc1 OUT_99
OBK_100:
    s_waitcnt lgkmcnt(7)
    v_mfma_f32_32x32x16_bf16 v[144:159], v[44:47], v[68:71], v[144:159]
    ds_read_b64_tr_b16 v[52:53], v15 offset:8192
    ds_read_b64_tr_b16 v[54:55], v15 offset:9216
    s_waitcnt lgkmcnt(7)
    v_mfma_f32_32x32x16_bf16 v[160:175], v[44:47], v[72:75], v[160:175]
    ds_read_b64_tr_b16 v[56:57], v16 offset:8192
    ds_read_b64_tr_b16 v[58:59], v16 offset:9216
    s_waitcnt lgkmcnt(7)
    v_mfma_f32_32x32x16_bf16 v[176:191], v[44:47], v[76:79], v[176:191]
    ds_read_b64_tr_b16 v[60:61], v17 offset:8192
    ds_read_b64_tr_b16 v[62:63], v17 offset:9216
    s_waitcnt lgkmcnt(6)
    v_mfma_f32_32x32x16_bf16 v[128:143], v[40:43], v[48:51], v[128:143]
    ds_read_b128 v[44:47], v13 offset:0
    ds_read_b64_tr_b16 v[64:65], v14 offset:12288
    ds_read_b64_tr_b16 v[66:67], v14 offset:13312
    s_cmp_eq_u32 s55, 4
    s_cbranch_scc1 OUT_101
OBK_102:
    s_waitcnt lgkmcnt(7)
    v_mfma_f32_32x32x16_bf16 v[144:159], v[40:43], v[52:55], v[144:159]
    ds_read_b64_tr_b16 v[68:69], v15 offset:12288
    ds_read_b64_tr_b16 v[70:71], v15 offset:13312
    s_waitcnt lgkmcnt(7)
    v_mfma_f32_32x32x16_bf16 v[160:175], v[40:43], v[56:59], v[160:175]
    ds_read_b64_tr_b16 v[72:73], v16 offset:12288
    ds_read_b64_tr_b16 v[74:75], v16 offset:13312
    s_waitcnt lgkmcnt(7)
    v_mfma_f32_32x32x16_bf16 v[176:191], v[40:43], v[60:63], v[176:191]
    ds_read_b64_tr_b16 v[76:77], v17 offset:12288
    ds_read_b64_tr_b16 v[78:79], v17 offset:13312
    s_waitcnt lgkmcnt(0)
    s_barrier
    v_mfma_f32_32x32x16_bf16 v[128:143], v[44:47], v[64:67], v[128:143]
    ds_read_b128 v[40:43], v10 offset:32768
    ds_read_b64_tr_b16 v[48:49], v14 offset:32768
    ds_read_b64_tr_b16 v[50:51], v14 offset:33792
    s_cmp_eq_u32 s55, 4
    s_cbranch_scc1 OUT_103
OBK_104:
    v_mfma_f32_32x32x16_bf16 v[144:159], v[44:47], v[68:71], v[144:159]
    ds_read_b64_tr_b16 v[52:53], v15 offset:32768
    ds_read_b64_tr_b16 v[54:55], v15 offset:33792
    v_mfma_f32_32x32x16_bf16 v[160:175], v[44:47], v[72:75], v[160:175]
    ds_read_b64_tr_b16 v[56:57], v16 offset:32768
    ds_read_b64_tr_b16 v[58:59], v16 offset:33792
    v_mfma_f32_32x32x16_bf16 v[176:191], v[44:47], v[76:79], v[176:191]
    ds_read_b64_tr_b16 v[60:61], v17 offset:32768
    ds_read_b64_tr_b16 v[62:63], v17 offset:33792
    s_waitcnt lgkmcnt(6)
    v_mfma_f32_32x32x16_bf16 v[128:143], v[40:43], v[48:51], v[128:143]
    ds_read_b128 v[44:47], v11 offset:32768
    ds_read_b64_tr_b16 v[64:65], v14 offset:36864
    ds_read_b64_tr_b16 v[66:67], v14 offset:37888
    v_lshlrev_b32 v106, 4, v1
    s_lshl_b32 s60, s41, 10
    v_add_u32 v106, s60, v106
    s_mov_b32 s60, 19447808
    buffer_load_dwordx4 v[248:251], v106, s[32:35], s60 offen sc1
    s_waitcnt lgkmcnt(7)
    v_mfma_f32_32x32x16_bf16 v[144:159], v[40:43], v[52:55], v[144:159]
    ds_read_b64_tr_b16 v[68:69], v15 offset:36864
    ds_read_b64_tr_b16 v[70:71], v15 offset:37888
    s_waitcnt lgkmcnt(7)
    v_mfma_f32_32x32x16_bf16 v[160:175], v[40:43], v[56:59], v[160:175]
    ds_read_b64_tr_b16 v[72:73], v16 offset:36864
    ds_read_b64_tr_b16 v[74:75], v16 offset:37888
    s_waitcnt lgkmcnt(7)
    v_mfma_f32_32x32x16_bf16 v[176:191], v[40:43], v[60:63], v[176:191]
    ds_read_b64_tr_b16 v[76:77], v17 offset:36864
    ds_read_b64_tr_b16 v[78:79], v17 offset:37888
    s_waitcnt lgkmcnt(6)
    v_mfma_f32_32x32x16_bf16 v[128:143], v[44:47], v[64:67], v[128:143]
    ds_read_b128 v[40:43], v12 offset:32768
    ds_read_b64_tr_b16 v[48:49], v14 offset:40960
    ds_read_b64_tr_b16 v[50:51], v14 offset:41984
    s_waitcnt lgkmcnt(7)
    v_mfma_f32_32x32x16_bf16 v[144:159], v[44:47], v[68:71], v[144:159]
    ds_read_b64_tr_b16 v[52:53], v15 offset:40960
    ds_read_b64_tr_b16 v[54:55], v15 offset:41984
    s_waitcnt lgkmcnt(7)
    v_mfma_f32_32x32x16_bf16 v[160:175], v[44:47], v[72:75], v[160:175]
    ds_read_b64_tr_b16 v[56:57], v16 offset:40960
    ds_read_b64_tr_b16 v[58:59], v16 offset:41984
    s_waitcnt lgkmcnt(7)
    v_mfma_f32_32x32x16_bf16 v[176:191], v[44:47], v[76:79], v[176:191]
    ds_read_b64_tr_b16 v[60:61], v17 offset:40960
    ds_read_b64_tr_b16 v[62:63], v17 offset:41984
    s_waitcnt lgkmcnt(6)
    v_mfma_f32_32x32x16_bf16 v[128:143], v[40:43], v[48:51], v[128:143]
    ds_read_b128 v[44:47], v13 offset:32768
    ds_read_b64_tr_b16 v[64:65], v14 offset:45056
    ds_read_b64_tr_b16 v[66:67], v14 offset:46080
    s_waitcnt lgkmcnt(7)
    v_mfma_f32_32x32x16_bf16 v[144:159], v[40:43], v[52:55], v[144:159]
    ds_read_b64_tr_b16 v[68:69], v15 offset:45056
    ds_read_b64_tr_b16 v[70:71], v15 offset:46080
    s_waitcnt lgkmcnt(7)
    v_mfma_f32_32x32x16_bf16 v[160:175], v[40:43], v[56:59], v[160:175]
    ds_read_b64_tr_b16 v[72:73], v16 offset:45056
    ds_read_b64_tr_b16 v[74:75], v16 offset:46080
    s_waitcnt lgkmcnt(7)
    v_mfma_f32_32x32x16_bf16 v[176:191], v[40:43], v[60:63], v[176:191]
    ds_read_b64_tr_b16 v[76:77], v17 offset:45056
    ds_read_b64_tr_b16 v[78:79], v17 offset:46080
    s_waitcnt lgkmcnt(0)
    s_barrier
    v_mfma_f32_32x32x16_bf16 v[128:143], v[44:47], v[64:67], v[128:143]
    ds_read_b128 v[40:43], v18 offset:0
    ds_read_b64_tr_b16 v[48:49], v22 offset:0
    ds_read_b64_tr_b16 v[50:51], v22 offset:1024
    v_mfma_f32_32x32x16_bf16 v[144:159], v[44:47], v[68:71], v[144:159]
    ds_read_b64_tr_b16 v[52:53], v23 offset:0
    ds_read_b64_tr_b16 v[54:55], v23 offset:1024
    v_mfma_f32_32x32x16_bf16 v[160:175], v[44:47], v[72:75], v[160:175]
    ds_read_b64_tr_b16 v[56:57], v24 offset:0
    ds_read_b64_tr_b16 v[58:59], v24 offset:1024
    v_mfma_f32_32x32x16_bf16 v[176:191], v[44:47], v[76:79], v[176:191]
    ds_read_b64_tr_b16 v[60:61], v25 offset:0
    ds_read_b64_tr_b16 v[62:63], v25 offset:1024
    s_waitcnt lgkmcnt(6)
    v_mfma_f32_32x32x16_bf16 v[128:143], v[40:43], v[48:51], v[128:143]
    ds_read_b128 v[44:47], v19 offset:0
    ds_read_b64_tr_b16 v[64:65], v22 offset:4096
    ds_read_b64_tr_b16 v[66:67], v22 offset:5120
    s_waitcnt lgkmcnt(7)
    v_mfma_f32_32x32x16_bf16 v[144:159], v[40:43], v[52:55], v[144:159]
    ds_read_b64_tr_b16 v[68:69], v23 offset:4096
    ds_read_b64_tr_b16 v[70:71], v23 offset:5120
    s_waitcnt lgkmcnt(7)
    v_mfma_f32_32x32x16_bf16 v[160:175], v[40:43], v[56:59], v[160:175]
    ds_read_b64_tr_b16 v[72:73], v24 offset:4096
    ds_read_b64_tr_b16 v[74:75], v24 offset:5120
    s_waitcnt lgkmcnt(7)
    v_mfma_f32_32x32x16_bf16 v[176:191], v[40:43], v[60:63], v[176:191]
    ds_read_b64_tr_b16 v[76:77], v25 offset:4096
    ds_read_b64_tr_b16 v[78:79], v25 offset:5120
    s_waitcnt lgkmcnt(6)
    v_mfma_f32_32x32x16_bf16 v[128:143], v[44:47], v[64:67], v[128:143]
    ds_read_b128 v[40:43], v20 offset:0
    ds_read_b64_tr_b16 v[48:49], v22 offset:8192
    ds_read_b64_tr_b16 v[50:51], v22 offset:9216
    s_waitcnt lgkmcnt(7)
    v_mfma_f32_32x32x16_bf16 v[144:159], v[44:47], v[68:71], v[144:159]
    ds_read_b64_tr_b16 v[52:53], v23 offset:8192
    ds_read_b64_tr_b16 v[54:55], v23 offset:9216
    s_waitcnt lgkmcnt(7)
    v_mfma_f32_32x32x16_bf16 v[160:175], v[44:47], v[72:75], v[160:175]
    ds_read_b64_tr_b16 v[56:57], v24 offset:8192
    ds_read_b64_tr_b16 v[58:59], v24 offset:9216
    s_waitcnt lgkmcnt(7)
    v_mfma_f32_32x32x16_bf16 v[176:191], v[44:47], v[76:79], v[176:191]
    ds_read_b64_tr_b16 v[60:61], v25 offset:8192
    ds_read_b64_tr_b16 v[62:63], v25 offset:9216
    s_waitcnt lgkmcnt(6)
    v_mfma_f32_32x32x16_bf16 v[128:143], v[40:43], v[48:51], v[128:143]
    ds_read_b128 v[44:47], v21 offset:0
    ds_read_b64_tr_b16 v[64:65], v22 offset:12288
    ds_read_b64_tr_b16 v[66:67], v22 offset:13312
    s_waitcnt lgkmcnt(7)
    v_mfma_f32_32x32x16_bf16 v[144:159], v[40:43], v[52:55], v[144:159]
    ds_read_b64_tr_b16 v[68:69], v23 offset:12288
    ds_read_b64_tr_b16 v[70:71], v23 offset:13312
    s_waitcnt lgkmcnt(7)
    v_mfma_f32_32x32x16_bf16 v[160:175], v[40:43], v[56:59], v[160:175]
    ds_read_b64_tr_b16 v[72:73], v24 offset:12288
    ds_read_b64_tr_b16 v[74:75], v24 offset:13312
    s_waitcnt lgkmcnt(7)
    v_mfma_f32_32x32x16_bf16 v[176:191], v[40:43], v[60:63], v[176:191]
    ds_read_b64_tr_b16 v[76:77], v25 offset:12288
    ds_read_b64_tr_b16 v[78:79], v25 offset:13312
    s_waitcnt lgkmcnt(0)
    s_barrier
    v_mfma_f32_32x32x16_bf16 v[128:143], v[44:47], v[64:67], v[128:143]
    ds_read_b128 v[40:43], v18 offset:32768
    ds_read_b64_tr_b16 v[48:49], v22 offset:32768
    ds_read_b64_tr_b16 v[50:51], v22 offset:33792
    s_waitcnt vmcnt(0)
    v_xor_b32 v248, s3, v248
    v_xor_b32 v249, s3, v249
    v_xor_b32 v250, s3, v250
    v_xor_b32 v251, s3, v251
    v_or3_b32 v248, v248, v249, v250
    v_or_b32 v248, v248, v251
    v_cmp_ne_u32 vcc, 0, v248
    s_cbranch_vccnz FSLOW_105
FBACK_106:
    s_add_u32 s58, s53, 0
    buffer_load_dwordx2 v[232:233], v103, s[32:35], s58 offen sc1
    s_add_u32 s58, s53, 16384
    buffer_load_dwordx2 v[234:235], v103, s[32:35], s58 offen sc1
    s_add_u32 s58, s53, 32768
    buffer_load_dwordx2 v[236:237], v103, s[32:35], s58 offen sc1
    s_add_u32 s58, s53, 49152
    buffer_load_dwordx2 v[238:239], v103, s[32:35], s58 offen sc1
    s_add_u32 s58, s53, 65536
    buffer_load_dwordx2 v[240:241], v103, s[32:35], s58 offen sc1
    s_add_u32 s58, s54, 0
    buffer_load_dword v242, v104, s[32:35], s58 offen sc1
    s_add_u32 s58, s54, 7680
    buffer_load_dword v243, v104, s[32:35], s58 offen sc1
    s_add_u32 s58, s54, 15360
    buffer_load_dword v244, v104, s[32:35], s58 offen sc1
    s_add_u32 s58, s54, 23040
    buffer_load_dword v245, v104, s[32:35], s58 offen sc1
    s_add_u32 s58, s54, 30720
    buffer_load_dword v246, v104, s[32:35], s58 offen sc1
    v_mfma_f32_32x32x16_bf16 v[144:159], v[44:47], v[68:71], v[144:159]
    ds_read_b64_tr_b16 v[52:53], v23 offset:32768
    ds_read_b64_tr_b16 v[54:55], v23 offset:33792
    v_mfma_f32_32x32x16_bf16 v[160:175], v[44:47], v[72:75], v[160:175]
    ds_read_b64_tr_b16 v[56:57], v24 offset:32768
    ds_read_b64_tr_b16 v[58:59], v24 offset:33792
    v_mfma_f32_32x32x16_bf16 v[176:191], v[44:47], v[76:79], v[176:191]
    ds_read_b64_tr_b16 v[60:61], v25 offset:32768
    ds_read_b64_tr_b16 v[62:63], v25 offset:33792
    s_waitcnt lgkmcnt(6)
    v_mfma_f32_32x32x16_bf16 v[128:143], v[40:43], v[48:51], v[128:143]
    ds_read_b128 v[44:47], v19 offset:32768
    ds_read_b64_tr_b16 v[64:65], v22 offset:36864
    ds_read_b64_tr_b16 v[66:67], v22 offset:37888
    s_and_b32 s60, s42, 3
    s_lshl_b32 s61, s41, 2
    s_add_u32 s60, s60, s61
    s_and_b32 s65, s60, 1
    s_lshr_b32 s60, s60, 1
    s_mul_i32 s60, s60, 5
    s_lshl_b32 s60, s60, 15
    s_lshr_b32 s61, s42, 2
    s_lshl_b32 s61, s61, 12
    s_add_u32 s60, s60, s61
    s_lshl_b32 s61, s43, 10
    s_add_u32 s60, s60, s61
    s_add_u32 s64, s60, 7864320
    s_mul_i32 s61, s65, 98304
    s_add_u32 s66, s64, s61
    buffer_store_dwordx4 v[96:99], v100, s[32:35], s66 offen sc1
    s_waitcnt lgkmcnt(7)
    v_mfma_f32_32x32x16_bf16 v[144:159], v[40:43], v[52:55], v[144:159]
    ds_read_b64_tr_b16 v[68:69], v23 offset:36864
    ds_read_b64_tr_b16 v[70:71], v23 offset:37888
    s_waitcnt lgkmcnt(7)
    v_mfma_f32_32x32x16_bf16 v[160:175], v[40:43], v[56:59], v[160:175]
    ds_read_b64_tr_b16 v[72:73], v24 offset:36864
    ds_read_b64_tr_b16 v[74:75], v24 offset:37888
    s_waitcnt lgkmcnt(7)
    v_mfma_f32_32x32x16_bf16 v[176:191], v[40:43], v[60:63], v[176:191]
    ds_read_b64_tr_b16 v[76:77], v25 offset:36864
    ds_read_b64_tr_b16 v[78:79], v25 offset:37888
    s_waitcnt lgkmcnt(6)
    v_mfma_f32_32x32x16_bf16 v[128:143], v[44:47], v[64:67], v[128:143]
    ds_read_b128 v[40:43], v20 offset:32768
    ds_read_b64_tr_b16 v[48:49], v22 offset:40960
    ds_read_b64_tr_b16 v[50:51], v22 offset:41984
    s_add_u32 s60, s66, 32768
    buffer_store_dwordx4 v[96:99], v100, s[32:35], s60 offen sc1
    s_waitcnt lgkmcnt(7)
    v_mfma_f32_32x32x16_bf16 v[144:159], v[44:47], v[68:71], v[144:159]
    ds_read_b64_tr_b16 v[52:53], v23 offset:40960
    ds_read_b64_tr_b16 v[54:55], v23 offset:41984
    s_waitcnt lgkmcnt(7)
    v_mfma_f32_32x32x16_bf16 v[160:175], v[44:47], v[72:75], v[160:175]
    ds_read_b64_tr_b16 v[56:57], v24 offset:40960
    ds_read_b64_tr_b16 v[58:59], v24 offset:41984
    s_waitcnt lgkmcnt(7)
    v_mfma_f32_32x32x16_bf16 v[176:191], v[44:47], v[76:79], v[176:191]
    ds_read_b64_tr_b16 v[60:61], v25 offset:40960
    ds_read_b64_tr_b16 v[62:63], v25 offset:41984
    s_waitcnt lgkmcnt(6)
    v_mfma_f32_32x32x16_bf16 v[128:143], v[40:43], v[48:51], v[128:143]
    ds_read_b128 v[44:47], v21 offset:32768
    ds_read_b64_tr_b16 v[64:65], v22 offset:45056
    ds_read_b64_tr_b16 v[66:67], v22 offset:46080
    s_lshl_b32 s61, s65, 3
    s_add_u32 s60, s64, s61
    s_add_u32 s60, s60, 65536
    buffer_store_dwordx2 v[96:97], v100, s[32:35], s60 offen sc1
    s_waitcnt lgkmcnt(7)
    v_mfma_f32_32x32x16_bf16 v[144:159], v[40:43], v[52:55], v[144:159]
    ds_read_b64_tr_b16 v[68:69], v23 offset:45056
    ds_read_b64_tr_b16 v[70:71], v23 offset:46080
    s_waitcnt lgkmcnt(7)
    v_mfma_f32_32x32x16_bf16 v[160:175], v[40:43], v[56:59], v[160:175]
    ds_read_b64_tr_b16 v[72:73], v24 offset:45056
    ds_read_b64_tr_b16 v[74:75], v24 offset:46080
    s_waitcnt lgkmcnt(7)
    v_mfma_f32_32x32x16_bf16 v[176:191], v[40:43], v[60:63], v[176:191]
    ds_read_b64_tr_b16 v[76:77], v25 offset:45056
    ds_read_b64_tr_b16 v[78:79], v25 offset:46080
    s_waitcnt lgkmcnt(0)
    s_barrier
    v_mfma_f32_32x32x16_bf16 v[128:143], v[44:47], v[64:67], v[128:143]
    ds_read_b128 v[40:43], v10 offset:0
    ds_read_b64_tr_b16 v[48:49], v14 offset:0
    ds_read_b64_tr_b16 v[50:51], v14 offset:1024
    s_and_b32 s64, s41, 3
    s_lshl_b32 s64, s64, 3
    s_and_b32 s60, s42, 7
    s_add_u32 s60, s60, s64
    s_lshr_b32 s64, s41, 2
    s_lshl_b32 s64, s64, 2
    s_lshr_b32 s61, s42, 3
    s_add_u32 s61, s61, s64
    s_lshl_b32 s67, s61, 14
    s_lshl_b32 s64, s60, 9
    s_add_u32 s67, s67, s64
    s_add_u32 s67, s67, 19726336
    s_mul_i32 s61, s61, 10
    s_add_u32 s61, s61, s43
    s_lshl_b32 s61, s61, 15
    s_lshl_b32 s60, s60, 10
    s_add_u32 s64, s61, s60
    s_add_u32 s64, s64, 10485760
    buffer_store_dwordx4 v[96:99], v100, s[32:35], s64 offen sc1
    v_mfma_f32_32x32x16_bf16 v[144:159], v[44:47], v[68:71], v[144:159]
    ds_read_b64_tr_b16 v[52:53], v15 offset:0
    ds_read_b64_tr_b16 v[54:55], v15 offset:1024
    v_mfma_f32_32x32x16_bf16 v[160:175], v[44:47], v[72:75], v[160:175]
    ds_read_b64_tr_b16 v[56:57], v16 offset:0
    ds_read_b64_tr_b16 v[58:59], v16 offset:1024
    v_mfma_f32_32x32x16_bf16 v[176:191], v[44:47], v[76:79], v[176:191]
    ds_read_b64_tr_b16 v[60:61], v17 offset:0
    ds_read_b64_tr_b16 v[62:63], v17 offset:1024
    s_waitcnt lgkmcnt(6)
    v_mfma_f32_32x32x16_bf16 v[128:143], v[40:43], v[48:51], v[128:143]
    ds_read_b128 v[44:47], v11 offset:0
    ds_read_b64_tr_b16 v[64:65], v14 offset:4096
    ds_read_b64_tr_b16 v[66:67], v14 offset:5120
    s_add_u32 s60, s64, 131072
    buffer_store_dwordx4 v[96:99], v100, s[32:35], s60 offen sc1
    s_waitcnt lgkmcnt(7)
    v_mfma_f32_32x32x16_bf16 v[144:159], v[40:43], v[52:55], v[144:159]
    ds_read_b64_tr_b16 v[68:69], v15 offset:4096
    ds_read_b64_tr_b16 v[70:71], v15 offset:5120
    s_waitcnt lgkmcnt(7)
    v_mfma_f32_32x32x16_bf16 v[160:175], v[40:43], v[56:59], v[160:175]
    ds_read_b64_tr_b16 v[72:73], v16 offset:4096
    ds_read_b64_tr_b16 v[74:75], v16 offset:5120
    s_waitcnt lgkmcnt(7)
    v_mfma_f32_32x32x16_bf16 v[176:191], v[40:43], v[60:63], v[176:191]
    ds_read_b64_tr_b16 v[76:77], v17 offset:4096
    ds_read_b64_tr_b16 v[78:79], v17 offset:5120
    s_waitcnt lgkmcnt(6)
    v_mfma_f32_32x32x16_bf16 v[128:143], v[44:47], v[64:67], v[128:143]
    ds_read_b128 v[40:43], v12 offset:0
    ds_read_b64_tr_b16 v[48:49], v14 offset:8192
    ds_read_b64_tr_b16 v[50:51], v14 offset:9216
    s_add_u32 s60, s64, 262144
    s_mov_b32 s65, 1073741824
    s_cmp_lt_u32 s43, 2
    s_cselect_b32 s60, s60, s65
    buffer_store_dwordx4 v[96:99], v100, s[32:35], s60 offen sc1
    s_waitcnt lgkmcnt(7)
    v_mfma_f32_32x32x16_bf16 v[144:159], v[44:47], v[68:71], v[144:159]
    ds_read_b64_tr_b16 v[52:53], v15 offset:8192
    ds_read_b64_tr_b16 v[54:55], v15 offset:9216
    s_waitcnt lgkmcnt(7)
    v_mfma_f32_32x32x16_bf16 v[160:175], v[44:47], v[72:75], v[160:175]
    ds_read_b64_tr_b16 v[56:57], v16 offset:8192
    ds_read_b64_tr_b16 v[58:59], v16 offset:9216
    s_waitcnt lgkmcnt(7)
    v_mfma_f32_32x32x16_bf16 v[176:191], v[44:47], v[76:79], v[176:191]
    ds_read_b64_tr_b16 v[60:61], v17 offset:8192
    ds_read_b64_tr_b16 v[62:63], v17 offset:9216
    s_waitcnt lgkmcnt(6)
    v_mfma_f32_32x32x16_bf16 v[128:143], v[40:43], v[48:51], v[128:143]
    ds_read_b128 v[44:47], v13 offset:0
    ds_read_b64_tr_b16 v[64:65], v14 offset:12288
    ds_read_b64_tr_b16 v[66:67], v14 offset:13312
    s_waitcnt vmcnt(6)
    v_max3_u32 v80, v232, v233, v234
    v_max3_u32 v80, v80, v235, v236
    v_max3_u32 v80, v80, v237, v238
    v_max3_u32 v80, v80, v239, v240
    v_max3_u32 v80, v80, v241, v242
    v_max3_u32 v80, v80, v243, v244
    v_max3_u32 v80, v80, v245, v246
    v_cmp_eq_u32 vcc, -1, v80
    s_cbranch_vccnz SLOW_107
BACK_108:
    v_pk_add_f32 v[232:233], v[232:233], v[234:235]
    v_add_f32 v242, v242, v243
    v_pk_add_f32 v[232:233], v[232:233], v[236:237]
    v_add_f32 v242, v242, v244
    v_pk_add_f32 v[232:233], v[232:233], v[238:239]
    v_add_f32 v242, v242, v245
    v_pk_add_f32 v[232:233], v[232:233], v[240:241]
    v_add_f32 v242, v242, v246
    v_mov_b32 v80, v242
    v_mov_b32 v81, v242
    s_nop 1
    v_permlane32_swap_b32 v80, v81
    v_add_f32 v242, v80, v81
    s_lshl_b32 s49, s43, 7
    s_add_u32 s49, s49, 159744
    v_add_u32 v82, s49, v102
    ds_write_b32 v82, v242
    v_mov_b32 v80, v232
    v_mov_b32 v81, v232
    s_nop 1
    v_permlane32_swap_b32 v80, v81
    v_add_f32 v232, v80, v81
    v_mov_b32 v80, v233
    v_mov_b32 v81, v233
    s_nop 1
    v_permlane32_swap_b32 v80, v81
    v_add_f32 v233, v80, v81
    v_mul_f32 v232, 0x3acccccd, v232
    v_mul_f32 v233, 0x3acccccd, v233
    v_fma_f32 v233, -v232, v232, v233
    v_max_f32 v233, 0, v233
    v_cvt_pk_bf16_f32 v80, v232, v232
    v_lshlrev_b32 v80, 16, v80
    v_cvt_pk_bf16_f32 v81, v233, v233
    v_lshlrev_b32 v81, 16, v81
    v_add_f32 v81, 0x3727c5ac, v81
    v_cvt_pk_bf16_f32 v81, v81, v81
    v_lshlrev_b32 v81, 16, v81
    v_sqrt_f32 v81, v81
    s_nop 0
    v_cvt_pk_bf16_f32 v81, v81, v81
    v_lshlrev_b32 v81, 16, v81
    v_rcp_f32 v38, v81
    s_nop 0
    v_mul_f32 v39, v80, v38
    v_sub_f32 v39, 0, v39
    s_lshl_b32 s49, s43, 8
    s_add_u32 s49, s49, 159744
    v_add_u32 v83, s49, v102
    ds_write_b32 v83, v38 offset:1024
    ds_write_b32 v83, v39 offset:1152
    s_waitcnt lgkmcnt(10)
    v_mfma_f32_32x32x16_bf16 v[144:159], v[40:43], v[52:55], v[144:159]
    ds_read_b64_tr_b16 v[68:69], v15 offset:12288
    ds_read_b64_tr_b16 v[70:71], v15 offset:13312
    s_waitcnt lgkmcnt(10)
    v_mfma_f32_32x32x16_bf16 v[160:175], v[40:43], v[56:59], v[160:175]
    ds_read_b64_tr_b16 v[72:73], v16 offset:12288
    ds_read_b64_tr_b16 v[74:75], v16 offset:13312
    s_waitcnt lgkmcnt(10)
    v_mfma_f32_32x32x16_bf16 v[176:191], v[40:43], v[60:63], v[176:191]
    ds_read_b64_tr_b16 v[76:77], v17 offset:12288
    ds_read_b64_tr_b16 v[78:79], v17 offset:13312
    s_waitcnt lgkmcnt(0)
    s_barrier
    v_mfma_f32_32x32x16_bf16 v[128:143], v[44:47], v[64:67], v[128:143]
    ds_read_b128 v[40:43], v10 offset:32768
    ds_read_b64_tr_b16 v[48:49], v14 offset:32768
    ds_read_b64_tr_b16 v[50:51], v14 offset:33792
    s_cmp_eq_u32 s43, 2
    s_cselect_b32 s60, s67, s65
    buffer_store_dwordx2 v[96:97], v101, s[32:35], s60 offen sc1
    v_mfma_f32_32x32x16_bf16 v[144:159], v[44:47], v[68:71], v[144:159]
    ds_read_b64_tr_b16 v[52:53], v15 offset:32768
    ds_read_b64_tr_b16 v[54:55], v15 offset:33792
    v_mfma_f32_32x32x16_bf16 v[160:175], v[44:47], v[72:75], v[160:175]
    ds_read_b64_tr_b16 v[56:57], v16 offset:32768
    ds_read_b64_tr_b16 v[58:59], v16 offset:33792
    v_mfma_f32_32x32x16_bf16 v[176:191], v[44:47], v[76:79], v[176:191]
    ds_read_b64_tr_b16 v[60:61], v17 offset:32768
    ds_read_b64_tr_b16 v[62:63], v17 offset:33792
    s_waitcnt lgkmcnt(6)
    v_mfma_f32_32x32x16_bf16 v[128:143], v[40:43], v[48:51], v[128:143]
    ds_read_b128 v[44:47], v11 offset:32768
    ds_read_b64_tr_b16 v[64:65], v14 offset:36864
    ds_read_b64_tr_b16 v[66:67], v14 offset:37888
    s_and_b32 s64, s41, 1
    s_lshl_b32 s64, s64, 3
    s_and_b32 s60, s42, 7
    s_add_u32 s60, s60, s64
    s_lshr_b32 s64, s41, 1
    s_lshl_b32 s64, s64, 2
    s_lshr_b32 s61, s42, 3
    s_add_u32 s61, s61, s64
    s_mul_i32 s61, s61, 384
    s_mul_i32 s64, s60, 12288
    s_add_u32 s61, s61, s64
    s_mul_i32 s64, s43, 6144
    s_add_u32 s61, s61, s64
    s_add_u32 s61, s61, 20185088
    s_cmp_lt_u32 s60, 10
    s_cselect_b32 s61, s61, s65
    s_cmp_lt_u32 s43, 2
    s_cselect_b32 s61, s61, s65
    s_mov_b64 exec, 0xffffff
    buffer_store_dwordx4 v[96:99], v100, s[32:35], s61 offen sc1
    s_mov_b64 exec, -1
    s_waitcnt lgkmcnt(7)
    v_mfma_f32_32x32x16_bf16 v[144:159], v[40:43], v[52:55], v[144:159]
    ds_read_b64_tr_b16 v[68:69], v15 offset:36864
    ds_read_b64_tr_b16 v[70:71], v15 offset:37888
    s_waitcnt lgkmcnt(7)
    v_mfma_f32_32x32x16_bf16 v[160:175], v[40:43], v[56:59], v[160:175]
    ds_read_b64_tr_b16 v[72:73], v16 offset:36864
    ds_read_b64_tr_b16 v[74:75], v16 offset:37888
    s_lshl_b32 s49, s43, 8
    s_add_u32 s49, s49, 159744
    v_lshlrev_b32 v86, 4, v105
    v_add_u32 v86, s49, v86
    ds_read_b128 v[192:195], v86 offset:1024
    ds_read_b128 v[196:199], v86 offset:1056
    ds_read_b128 v[200:203], v86 offset:1088
    ds_read_b128 v[204:207], v86 offset:1120
    s_waitcnt lgkmcnt(11)
    v_mfma_f32_32x32x16_bf16 v[176:191], v[40:43], v[60:63], v[176:191]
    ds_read_b64_tr_b16 v[76:77], v17 offset:36864
    ds_read_b64_tr_b16 v[78:79], v17 offset:37888
    s_waitcnt lgkmcnt(10)
    v_mfma_f32_32x32x16_bf16 v[128:143], v[44:47], v[64:67], v[128:143]
    ds_read_b128 v[40:43], v12 offset:32768
    ds_read_b64_tr_b16 v[48:49], v14 offset:40960
    ds_read_b64_tr_b16 v[50:51], v14 offset:41984
    ds_read_b128 v[208:211], v86 offset:1152
    ds_read_b128 v[212:215], v86 offset:1184
    ds_read_b128 v[216:219], v86 offset:1216
    ds_read_b128 v[220:223], v86 offset:1248
    s_waitcnt lgkmcnt(15)
    v_mfma_f32_32x32x16_bf16 v[144:159], v[44:47], v[68:71], v[144:159]
    ds_read_b64_tr_b16 v[52:53], v15 offset:40960
    ds_read_b64_tr_b16 v[54:55], v15 offset:41984
    s_waitcnt lgkmcnt(15)
    v_mfma_f32_32x32x16_bf16 v[160:175], v[44:47], v[72:75], v[160:175]
    ds_read_b64_tr_b16 v[56:57], v16 offset:40960
    ds_read_b64_tr_b16 v[58:59], v16 offset:41984
    s_waitcnt lgkmcnt(11)
    v_mfma_f32_32x32x16_bf16 v[176:191], v[44:47], v[76:79], v[176:191]
    ds_read_b64_tr_b16 v[60:61], v17 offset:40960
    ds_read_b64_tr_b16 v[62:63], v17 offset:41984
    s_waitcnt lgkmcnt(10)
    v_mfma_f32_32x32x16_bf16 v[128:143], v[40:43], v[48:51], v[128:143]
    ds_read_b128 v[44:47], v13 offset:32768
    ds_read_b64_tr_b16 v[64:65], v14 offset:45056
    ds_read_b64_tr_b16 v[66:67], v14 offset:46080
    s_add_u32 s52, s43, 0
    s_and_b32 s52, s52, 3
    s_lshl_b32 s52, s52, 7
    s_add_u32 s52, s52, 159744
    v_add_u32 v87, s52, v102
    ds_read_b32 v224, v87
    s_add_u32 s52, s43, 1
    s_and_b32 s52, s52, 3
    s_lshl_b32 s52, s52, 7
    s_add_u32 s52, s52, 159744
    v_add_u32 v87, s52, v102
    ds_read_b32 v226, v87
    s_add_u32 s52, s43, 2
    s_and_b32 s52, s52, 3
    s_lshl_b32 s52, s52, 7
    s_add_u32 s52, s52, 159744
    v_add_u32 v87, s52, v102
    ds_read_b32 v228, v87
    s_add_u32 s52, s43, 3
    s_and_b32 s52, s52, 3
    s_lshl_b32 s52, s52, 7
    s_add_u32 s52, s52, 159744
    v_add_u32 v87, s52, v102
    ds_read_b32 v230, v87
    v_mul_u32_u24 v84, 10240, v105
    v_lshl_add_u32 v84, v102, 2, v84
    s_lshr_b32 s53, s46, 5
    s_mul_i32 s53, s53, 40960
    s_sub_u32 s54, s44, 10
    s_lshl_b32 s54, s54, 11
    s_add_u32 s53, s53, s54
    s_add_u32 s53, s53, 5242880
    s_waitcnt lgkmcnt(11)
    v_mfma_f32_32x32x16_bf16 v[144:159], v[40:43], v[52:55], v[144:159]
    ds_read_b64_tr_b16 v[68:69], v15 offset:45056
    ds_read_b64_tr_b16 v[70:71], v15 offset:46080
    s_waitcnt lgkmcnt(11)
    v_mfma_f32_32x32x16_bf16 v[160:175], v[40:43], v[56:59], v[160:175]
    ds_read_b64_tr_b16 v[72:73], v16 offset:45056
    ds_read_b64_tr_b16 v[74:75], v16 offset:46080
    s_waitcnt lgkmcnt(11)
    v_mfma_f32_32x32x16_bf16 v[176:191], v[40:43], v[60:63], v[176:191]
    ds_read_b64_tr_b16 v[76:77], v17 offset:45056
    ds_read_b64_tr_b16 v[78:79], v17 offset:46080
    s_waitcnt lgkmcnt(10)
    v_mfma_f32_32x32x16_bf16 v[128:143], v[44:47], v[64:67], v[128:143]
    s_waitcnt lgkmcnt(4)
    v_mfma_f32_32x32x16_bf16 v[144:159], v[44:47], v[68:71], v[144:159]
    s_waitcnt lgkmcnt(2)
    v_mfma_f32_32x32x16_bf16 v[160:175], v[44:47], v[72:75], v[160:175]
    s_waitcnt lgkmcnt(0)
    v_mfma_f32_32x32x16_bf16 v[176:191], v[44:47], v[76:79], v[176:191]
    s_barrier
    s_add_u32 s52, s43, 0
    s_and_b32 s52, s52, 3
    s_lshl_b32 s52, s52, 9
    s_add_u32 s52, s52, s53
    v_pk_mul_f32 v[88:89], v[208:209], v[224:225] op_sel_hi:[1,0]
    v_pk_fma_f32 v[128:129], v[128:129], v[192:193], v[88:89]
    v_cvt_pk_bf16_f32 v112, v128, v129
    v_pk_mul_f32 v[90:91], v[210:211], v[224:225] op_sel_hi:[1,0]
    v_pk_fma_f32 v[130:131], v[130:131], v[194:195], v[90:91]
    v_cvt_pk_bf16_f32 v113, v130, v131
    v_pk_mul_f32 v[88:89], v[212:213], v[224:225] op_sel_hi:[1,0]
    v_pk_fma_f32 v[132:133], v[132:133], v[196:197], v[88:89]
    v_cvt_pk_bf16_f32 v114, v132, v133
    v_pk_mul_f32 v[90:91], v[214:215], v[224:225] op_sel_hi:[1,0]
    v_pk_fma_f32 v[134:135], v[134:135], v[198:199], v[90:91]
    v_cvt_pk_bf16_f32 v115, v134, v135
    s_add_u32 s54, s52, 0
    buffer_store_dwordx4 v[112:115], v84, s[32:35], s54 offen sc1
    v_pk_mul_f32 v[88:89], v[216:217], v[224:225] op_sel_hi:[1,0]
    v_pk_fma_f32 v[136:137], v[136:137], v[200:201], v[88:89]
    v_cvt_pk_bf16_f32 v116, v136, v137
    v_pk_mul_f32 v[90:91], v[218:219], v[224:225] op_sel_hi:[1,0]
    v_pk_fma_f32 v[138:139], v[138:139], v[202:203], v[90:91]
    v_cvt_pk_bf16_f32 v117, v138, v139
    v_pk_mul_f32 v[88:89], v[220:221], v[224:225] op_sel_hi:[1,0]
    v_pk_fma_f32 v[140:141], v[140:141], v[204:205], v[88:89]
    v_cvt_pk_bf16_f32 v118, v140, v141
    v_pk_mul_f32 v[90:91], v[222:223], v[224:225] op_sel_hi:[1,0]
    v_pk_fma_f32 v[142:143], v[142:143], v[206:207], v[90:91]
    v_cvt_pk_bf16_f32 v119, v142, v143
    s_add_u32 s54, s52, 20480
    buffer_store_dwordx4 v[116:119], v84, s[32:35], s54 offen sc1
    s_add_u32 s52, s43, 1
    s_and_b32 s52, s52, 3
    s_lshl_b32 s52, s52, 9
    s_add_u32 s52, s52, s53
    v_pk_mul_f32 v[88:89], v[208:209], v[226:227] op_sel_hi:[1,0]
    v_pk_fma_f32 v[144:145], v[144:145], v[192:193], v[88:89]
    v_cvt_pk_bf16_f32 v120, v144, v145
    v_pk_mul_f32 v[90:91], v[210:211], v[226:227] op_sel_hi:[1,0]
    v_pk_fma_f32 v[146:147], v[146:147], v[194:195], v[90:91]
    v_cvt_pk_bf16_f32 v121, v146, v147
    v_pk_mul_f32 v[88:89], v[212:213], v[226:227] op_sel_hi:[1,0]
    v_pk_fma_f32 v[148:149], v[148:149], v[196:197], v[88:89]
    v_cvt_pk_bf16_f32 v122, v148, v149
    v_pk_mul_f32 v[90:91], v[214:215], v[226:227] op_sel_hi:[1,0]
    v_pk_fma_f32 v[150:151], v[150:151], v[198:199], v[90:91]
    v_cvt_pk_bf16_f32 v123, v150, v151
    s_add_u32 s54, s52, 0
    buffer_store_dwordx4 v[120:123], v84, s[32:35], s54 offen sc1
    v_pk_mul_f32 v[88:89], v[216:217], v[226:227] op_sel_hi:[1,0]
    v_pk_fma_f32 v[152:153], v[152:153], v[200:201], v[88:89]
    v_cvt_pk_bf16_f32 v124, v152, v153
    v_pk_mul_f32 v[90:91], v[218:219], v[226:227] op_sel_hi:[1,0]
    v_pk_fma_f32 v[154:155], v[154:155], v[202:203], v[90:91]
    v_cvt_pk_bf16_f32 v125, v154, v155
    v_pk_mul_f32 v[88:89], v[220:221], v[226:227] op_sel_hi:[1,0]
    v_pk_fma_f32 v[156:157], v[156:157], v[204:205], v[88:89]
    v_cvt_pk_bf16_f32 v126, v156, v157
    v_pk_mul_f32 v[90:91], v[222:223], v[226:227] op_sel_hi:[1,0]
    v_pk_fma_f32 v[158:159], v[158:159], v[206:207], v[90:91]
    v_cvt_pk_bf16_f32 v127, v158, v159
    s_add_u32 s54, s52, 20480
    buffer_store_dwordx4 v[124:127], v84, s[32:35], s54 offen sc1
    s_add_u32 s52, s43, 2
    s_and_b32 s52, s52, 3
    s_lshl_b32 s52, s52, 9
    s_add_u32 s52, s52, s53
    v_pk_mul_f32 v[88:89], v[208:209], v[228:229] op_sel_hi:[1,0]
    v_pk_fma_f32 v[160:161], v[160:161], v[192:193], v[88:89]
    v_cvt_pk_bf16_f32 v112, v160, v161
    v_pk_mul_f32 v[90:91], v[210:211], v[228:229] op_sel_hi:[1,0]
    v_pk_fma_f32 v[162:163], v[162:163], v[194:195], v[90:91]
    v_cvt_pk_bf16_f32 v113, v162, v163
    v_pk_mul_f32 v[88:89], v[212:213], v[228:229] op_sel_hi:[1,0]
    v_pk_fma_f32 v[164:165], v[164:165], v[196:197], v[88:89]
    v_cvt_pk_bf16_f32 v114, v164, v165
    v_pk_mul_f32 v[90:91], v[214:215], v[228:229] op_sel_hi:[1,0]
    v_pk_fma_f32 v[166:167], v[166:167], v[198:199], v[90:91]
    v_cvt_pk_bf16_f32 v115, v166, v167
    s_add_u32 s54, s52, 0
    buffer_store_dwordx4 v[112:115], v84, s[32:35], s54 offen sc1
    v_pk_mul_f32 v[88:89], v[216:217], v[228:229] op_sel_hi:[1,0]
    v_pk_fma_f32 v[168:169], v[168:169], v[200:201], v[88:89]
    v_cvt_pk_bf16_f32 v116, v168, v169
    v_pk_mul_f32 v[90:91], v[218:219], v[228:229] op_sel_hi:[1,0]
    v_pk_fma_f32 v[170:171], v[170:171], v[202:203], v[90:91]
    v_cvt_pk_bf16_f32 v117, v170, v171
    v_pk_mul_f32 v[88:89], v[220:221], v[228:229] op_sel_hi:[1,0]
    v_pk_fma_f32 v[172:173], v[172:173], v[204:205], v[88:89]
    v_cvt_pk_bf16_f32 v118, v172, v173
    v_pk_mul_f32 v[90:91], v[222:223], v[228:229] op_sel_hi:[1,0]
    v_pk_fma_f32 v[174:175], v[174:175], v[206:207], v[90:91]
    v_cvt_pk_bf16_f32 v119, v174, v175
    s_add_u32 s54, s52, 20480
    buffer_store_dwordx4 v[116:119], v84, s[32:35], s54 offen sc1
    s_add_u32 s52, s43, 3
    s_and_b32 s52, s52, 3
    s_lshl_b32 s52, s52, 9
    s_add_u32 s52, s52, s53
    v_pk_mul_f32 v[88:89], v[208:209], v[230:231] op_sel_hi:[1,0]
    v_pk_fma_f32 v[176:177], v[176:177], v[192:193], v[88:89]
    v_cvt_pk_bf16_f32 v120, v176, v177
    v_pk_mul_f32 v[90:91], v[210:211], v[230:231] op_sel_hi:[1,0]
    v_pk_fma_f32 v[178:179], v[178:179], v[194:195], v[90:91]
    v_cvt_pk_bf16_f32 v121, v178, v179
    v_pk_mul_f32 v[88:89], v[212:213], v[230:231] op_sel_hi:[1,0]
    v_pk_fma_f32 v[180:181], v[180:181], v[196:197], v[88:89]
    v_cvt_pk_bf16_f32 v122, v180, v181
    v_pk_mul_f32 v[90:91], v[214:215], v[230:231] op_sel_hi:[1,0]
    v_pk_fma_f32 v[182:183], v[182:183], v[198:199], v[90:91]
    v_cvt_pk_bf16_f32 v123, v182, v183
    s_add_u32 s54, s52, 0
    buffer_store_dwordx4 v[120:123], v84, s[32:35], s54 offen sc1
    v_pk_mul_f32 v[88:89], v[216:217], v[230:231] op_sel_hi:[1,0]
    v_pk_fma_f32 v[184:185], v[184:185], v[200:201], v[88:89]
    v_cvt_pk_bf16_f32 v124, v184, v185
    v_pk_mul_f32 v[90:91], v[218:219], v[230:231] op_sel_hi:[1,0]
    v_pk_fma_f32 v[186:187], v[186:187], v[202:203], v[90:91]
    v_cvt_pk_bf16_f32 v125, v186, v187
    v_pk_mul_f32 v[88:89], v[220:221], v[230:231] op_sel_hi:[1,0]
    v_pk_fma_f32 v[188:189], v[188:189], v[204:205], v[88:89]
    v_cvt_pk_bf16_f32 v126, v188, v189
    v_pk_mul_f32 v[90:91], v[222:223], v[230:231] op_sel_hi:[1,0]
    v_pk_fma_f32 v[190:191], v[190:191], v[206:207], v[90:91]
    v_cvt_pk_bf16_f32 v127, v190, v191
    s_add_u32 s54, s52, 20480
    buffer_store_dwordx4 v[124:127], v84, s[32:35], s54 offen sc1
    s_lshl_b32 s49, s45, 4
    s_add_u32 s49, s49, s44
    s_waitcnt vmcnt(0) lgkmcnt(0)
    v_mov_b32 v80, 1
    v_mov_b32 v81, 162824
    s_mov_b64 exec, 1
    ds_add_rtn_u32 v80, v81, v80
    s_mov_b64 exec, -1
    s_lshl_b32 s60, s49, 2
    s_add_u32 s60, s60, 19431424
    s_waitcnt lgkmcnt(0)
    v_readfirstlane_b32 s61, v80
    v_mov_b32 v80, s3
    v_lshlrev_b32 v81, 10, v1
    s_cmp_eq_u32 s61, 3
    s_cselect_b32 s60, s60, 1073741824
    s_mov_b64 exec, 0xff
    buffer_store_dword v80, v81, s[32:35], s60 offen sc1
    s_mov_b64 exec, -1
    s_branch C_P1D_9
C_HELP_8:
    s_cmp_eq_u32 s40, 0
    s_cbranch_scc1 OUT_110
OBK_111:
    s_waitcnt vmcnt(0)
    s_barrier
    v_mov_b32 v107, s3
    v_lshlrev_b32 v108, 10, v1
    s_lshl_b32 s60, s2, 2
    s_add_u32 s60, s60, 19447808
    s_mov_b32 s61, 1073741824
    s_cmp_eq_u32 s40, 0
    s_cselect_b32 s60, s60, s61
    s_mov_b64 exec, 0xff
    buffer_store_dword v107, v108, s[32:35], s60 offen sc1
    s_mov_b64 exec, -1
    v_mov_b32 v107, 162816
    ds_read_b32 v107, v107
    s_waitcnt lgkmcnt(0)
    v_readfirstlane_b32 s3, v107
    s_barrier
    s_barrier
    s_barrier
    s_barrier
    s_barrier
    s_barrier
    s_barrier
    s_barrier
    s_and_b32 s60, s42, 3
    s_lshl_b32 s61, s41, 2
    s_add_u32 s60, s60, s61
    s_and_b32 s65, s60, 1
    s_lshr_b32 s60, s60, 1
    s_mul_i32 s60, s60, 5
    s_lshl_b32 s60, s60, 15
    s_lshr_b32 s61, s42, 2
    s_lshl_b32 s61, s61, 12
    s_add_u32 s60, s60, s61
    s_lshl_b32 s61, s43, 10
    s_add_u32 s60, s60, s61
    s_add_u32 s64, s60, 7864320
    s_mul_i32 s61, s65, 98304
    s_add_u32 s66, s64, s61
    buffer_store_dwordx4 v[96:99], v100, s[32:35], s66 offen sc1
    s_add_u32 s60, s66, 32768
    buffer_store_dwordx4 v[96:99], v100, s[32:35], s60 offen sc1
    s_lshl_b32 s61, s65, 3
    s_add_u32 s60, s64, s61
    s_add_u32 s60, s60, 65536
    buffer_store_dwordx2 v[96:97], v100, s[32:35], s60 offen sc1
    s_and_b32 s64, s41, 3
    s_lshl_b32 s64, s64, 3
    s_and_b32 s60, s42, 7
    s_add_u32 s60, s60, s64
    s_lshr_b32 s64, s41, 2
    s_lshl_b32 s64, s64, 2
    s_lshr_b32 s61, s42, 3
    s_add_u32 s61, s61, s64
    s_lshl_b32 s67, s61, 14
    s_lshl_b32 s64, s60, 9
    s_add_u32 s67, s67, s64
    s_add_u32 s67, s67, 19726336
    s_mul_i32 s61, s61, 10
    s_add_u32 s61, s61, s43
    s_lshl_b32 s61, s61, 15
    s_lshl_b32 s60, s60, 10
    s_add_u32 s64, s61, s60
    s_add_u32 s64, s64, 10485760
    buffer_store_dwordx4 v[96:99], v100, s[32:35], s64 offen sc1
    s_add_u32 s60, s64, 131072
    buffer_store_dwordx4 v[96:99], v100, s[32:35], s60 offen sc1
    s_add_u32 s60, s64, 262144
    s_mov_b32 s65, 1073741824
    s_cmp_lt_u32 s43, 2
    s_cselect_b32 s60, s60, s65
    buffer_store_dwordx4 v[96:99], v100, s[32:35], s60 offen sc1
    s_cmp_eq_u32 s43, 2
    s_cselect_b32 s60, s67, s65
    buffer_store_dwordx2 v[96:97], v101, s[32:35], s60 offen sc1
    s_and_b32 s64, s41, 1
    s_lshl_b32 s64, s64, 3
    s_and_b32 s60, s42, 7
    s_add_u32 s60, s60, s64
    s_lshr_b32 s64, s41, 1
    s_lshl_b32 s64, s64, 2
    s_lshr_b32 s61, s42, 3
    s_add_u32 s61, s61, s64
    s_mul_i32 s61, s61, 384
    s_mul_i32 s64, s60, 12288
    s_add_u32 s61, s61, s64
    s_mul_i32 s64, s43, 6144
    s_add_u32 s61, s61, s64
    s_add_u32 s61, s61, 20185088
    s_cmp_lt_u32 s60, 10
    s_cselect_b32 s61, s61, s65
    s_cmp_lt_u32 s43, 2
    s_cselect_b32 s61, s61, s65
    s_mov_b64 exec, 0xffffff
    buffer_store_dwordx4 v[96:99], v100, s[32:35], s61 offen sc1
    s_mov_b64 exec, -1
    s_barrier
    s_lshl_b32 s49, s41, 1
    s_add_u32 s49, s49, s42
    s_sub_u32 s49, s49, 30
    s_lshl_b32 s49, s49, 4
    s_add_u32 s49, s49, 15
    s_waitcnt vmcnt(0) lgkmcnt(0)
    v_mov_b32 v80, 1
    v_mov_b32 v81, 162824
    s_mov_b64 exec, 1
    ds_add_rtn_u32 v80, v81, v80
    s_mov_b64 exec, -1
    s_lshl_b32 s60, s49, 2
    s_add_u32 s60, s60, 19431424
    s_waitcnt lgkmcnt(0)
    v_readfirstlane_b32 s61, v80
    v_mov_b32 v80, s3
    v_lshlrev_b32 v81, 10, v1
    s_cmp_eq_u32 s61, 3
    s_cselect_b32 s60, s60, 1073741824
    s_mov_b64 exec, 0xff
    buffer_store_dword v80, v81, s[32:35], s60 offen sc1
    s_mov_b64 exec, -1
C_P1D_9:
    s_and_b32 s0, s41, 3
    s_lshl_b32 s0, s0, 3
    s_and_b32 s61, s42, 7
    s_add_u32 s61, s61, s0
    s_lshr_b32 s0, s41, 2
    s_lshl_b32 s0, s0, 2
    s_lshr_b32 s60, s42, 3
    s_add_u32 s60, s60, s0
    s_sub_u32 s36, s60, 5
    s_cmp_ge_u32 s60, 5
    s_cselect_b32 s36, s36, s60
    s_mul_i32 s60, s60, 160
    s_mul_i32 s1, s43, 204800
    s_add_u32 s60, s60, s1
    v_add_u32 v24, 0, v1
    v_mul_u32_u24 v25, 6554, v24
    v_lshrrev_b32 v25, 16, v25
    v_mul_u32_u24 v26, 10, v25
    v_sub_u32 v26, v24, v26
    v_bfe_u32 v27, v25, 3, 1
    v_lshlrev_b32 v27, 2, v27
    v_xor_b32 v25, v25, v27
    v_mul_u32_u24 v25, 1280, v25
    v_lshl_add_u32 v232, v26, 4, v25
    v_add_u32 v232, s60, v232
    v_add_u32 v24, 64, v1
    v_mul_u32_u24 v25, 6554, v24
    v_lshrrev_b32 v25, 16, v25
    v_mul_u32_u24 v26, 10, v25
    v_sub_u32 v26, v24, v26
    v_bfe_u32 v27, v25, 3, 1
    v_lshlrev_b32 v27, 2, v27
    v_xor_b32 v25, v25, v27
    v_mul_u32_u24 v25, 1280, v25
    v_lshl_add_u32 v233, v26, 4, v25
    v_add_u32 v233, s60, v233
    v_subrev_u32 v233, 1024, v233
    v_add_u32 v24, 128, v1
    v_mul_u32_u24 v25, 6554, v24
    v_lshrrev_b32 v25, 16, v25
    v_mul_u32_u24 v26, 10, v25
    v_sub_u32 v26, v24, v26
    v_bfe_u32 v27, v25, 3, 1
    v_lshlrev_b32 v27, 2, v27
    v_xor_b32 v25, v25, v27
    v_mul_u32_u24 v25, 1280, v25
    v_lshl_add_u32 v234, v26, 4, v25
    v_add_u32 v234, s60, v234
    v_subrev_u32 v234, 2048, v234
    v_add_u32 v24, 192, v1
    v_mul_u32_u24 v25, 6554, v24
    v_lshrrev_b32 v25, 16, v25
    v_mul_u32_u24 v26, 10, v25
    v_sub_u32 v26, v24, v26
    v_bfe_u32 v27, v25, 3, 1
    v_lshlrev_b32 v27, 2, v27
    v_xor_b32 v25, v25, v27
    v_mul_u32_u24 v25, 1280, v25
    v_lshl_add_u32 v235, v26, 4, v25
    v_add_u32 v235, s60, v235
    v_subrev_u32 v235, 3072, v235
    v_add_u32 v24, 256, v1
    v_mul_u32_u24 v25, 6554, v24
    v_lshrrev_b32 v25, 16, v25
    v_mul_u32_u24 v26, 10, v25
    v_sub_u32 v26, v24, v26
    v_bfe_u32 v27, v25, 3, 1
    v_lshlrev_b32 v27, 2, v27
    v_xor_b32 v25, v25, v27
    v_mul_u32_u24 v25, 1280, v25
    v_lshl_add_u32 v236, v26, 4, v25
    v_add_u32 v236, s60, v236
    s_mul_i32 s0, s43, 5120
    s_and_b32 s45, s42, 3
    s_lshl_b32 s44, s41, 2
    s_add_u32 s45, s45, s44
    s_lshr_b32 s44, s42, 2
    s_lshl_b32 s46, s44, 8
    s_sub_u32 s47, s46, 256
    s_max_i32 s47, s47, 0
    s_cmp_lt_u32 s43, 2
    s_cselect_b32 s48, s47, s46
    s_mov_b32 s50, s48
    s_and_b32 s49, s43, 1
    s_lshl_b32 s49, s49, 7
    s_add_u32 s48, s48, s49
    s_lshl_b32 s48, s48, 3
    s_mul_i32 s49, s45, 81920
    s_add_u32 s48, s48, s49
    s_add_u32 s48, s48, 2621440
    v_lshlrev_b32 v2, 4, v1
    s_lshr_b32 s50, s50, 3
    s_mul_i32 s50, s50, 10240
    s_mul_i32 s49, s45, 320
    s_add_u32 s50, s50, s49
    s_add_u32 s50, s50, 5242880
    s_cmp_lt_u32 s40, 4
    s_cselect_b32 s48, s48, s50
    s_cselect_b64 s[96:97], -1, 0
    s_lshl_b32 s49, s43, 10
    s_add_u32 s49, s49, 102400
    s_mul_i32 s50, s43, 5120
    s_add_u32 s50, s50, 122880
    s_cmp_lt_u32 s40, 4
    s_cselect_b32 s50, s49, s50
    s_movk_i32 s56, 1024
    s_cselect_b32 s56, 4096, s56
    s_and_b32 s49, s43, 1
    s_mul_i32 s49, s49, 320
    v_add_u32 v3, 0, v1
    v_add_u32 v3, s49, v3
    v_mul_u32_u24 v4, 3277, v3
    v_lshrrev_b32 v4, 16, v4
    v_mul_u32_u24 v5, 20, v4
    v_sub_u32 v5, v3, v5
    v_mul_u32_u24 v4, 10240, v4
    v_lshl_add_u32 v4, v5, 4, v4
    v_add_u32 v5, 0, v2
    v_cndmask_b32 v6, v4, v5, s[96:97]
    v_add_u32 v3, 64, v1
    v_add_u32 v3, s49, v3
    v_mul_u32_u24 v4, 3277, v3
    v_lshrrev_b32 v4, 16, v4
    v_mul_u32_u24 v5, 20, v4
    v_sub_u32 v5, v3, v5
    v_mul_u32_u24 v4, 10240, v4
    v_lshl_add_u32 v4, v5, 4, v4
    v_add_u32 v5, 16384, v2
    v_cndmask_b32 v7, v4, v5, s[96:97]
    v_add_u32 v3, 128, v1
    v_add_u32 v3, s49, v3
    v_mul_u32_u24 v4, 3277, v3
    v_lshrrev_b32 v4, 16, v4
    v_mul_u32_u24 v5, 20, v4
    v_sub_u32 v5, v3, v5
    v_mul_u32_u24 v4, 10240, v4
    v_lshl_add_u32 v4, v5, 4, v4
    v_add_u32 v5, 32768, v2
    v_cndmask_b32 v8, v4, v5, s[96:97]
    v_add_u32 v3, 192, v1
    v_add_u32 v3, s49, v3
    v_mul_u32_u24 v4, 3277, v3
    v_lshrrev_b32 v4, 16, v4
    v_mul_u32_u24 v5, 20, v4
    v_sub_u32 v5, v3, v5
    v_mul_u32_u24 v4, 10240, v4
    v_lshl_add_u32 v4, v5, 4, v4
    v_add_u32 v5, 49152, v2
    v_cndmask_b32 v9, v4, v5, s[96:97]
    v_add_u32 v3, 256, v1
    v_add_u32 v3, s49, v3
    v_mul_u32_u24 v4, 3277, v3
    v_lshrrev_b32 v4, 16, v4
    v_mul_u32_u24 v5, 20, v4
    v_sub_u32 v5, v3, v5
    v_mul_u32_u24 v4, 10240, v4
    v_lshl_add_u32 v4, v5, 4, v4
    v_add_u32 v5, 65536, v2
    v_cndmask_b32 v10, v4, v5, s[96:97]
    v_and_b32 v12, 31, v1
    v_lshrrev_b32 v13, 5, v1
    v_lshlrev_b32 v14, 3, v12
    v_lshl_add_u32 v15, v13, 15, v14
    s_lshl_b32 s51, s40, 5
    s_add_u32 s51, s51, s46
    s_lshl_b32 s52, s51, 3
    s_mul_i32 s49, s45, 81920
    s_add_u32 s52, s52, s49
    s_add_u32 s52, s52, 0
    s_add_u32 s53, s52, 16384
    s_add_u32 s54, s52, 65536
    v_lshlrev_b32 v3, 2, v13
    v_add_u32 v4, 0, v3
    v_cmp_le_u32 s[64:65], v4, v12
    v_add_u32 v4, 1, v3
    v_cmp_le_u32 s[66:67], v4, v12
    v_add_u32 v4, 2, v3
    v_cmp_le_u32 s[68:69], v4, v12
    v_add_u32 v4, 3, v3
    v_cmp_le_u32 s[70:71], v4, v12
    v_add_u32 v4, 8, v3
    v_cmp_le_u32 s[72:73], v4, v12
    v_add_u32 v4, 9, v3
    v_cmp_le_u32 s[74:75], v4, v12
    v_add_u32 v4, 10, v3
    v_cmp_le_u32 s[76:77], v4, v12
    v_add_u32 v4, 11, v3
    v_cmp_le_u32 s[78:79], v4, v12
    v_add_u32 v4, 16, v3
    v_cmp_le_u32 s[80:81], v4, v12
    v_add_u32 v4, 17, v3
    v_cmp_le_u32 s[82:83], v4, v12
    v_add_u32 v4, 18, v3
    v_cmp_le_u32 s[84:85], v4, v12
    v_add_u32 v4, 19, v3
    v_cmp_le_u32 s[86:87], v4, v12
    v_add_u32 v4, 24, v3
    v_cmp_le_u32 s[88:89], v4, v12
    v_add_u32 v4, 25, v3
    v_cmp_le_u32 s[90:91], v4, v12
    v_add_u32 v4, 26, v3
    v_cmp_le_u32 s[92:93], v4, v12
    v_add_u32 v4, 27, v3
    v_cmp_le_u32 s[94:95], v4, v12
    v_mov_b32 v5, 0xffff
    v_mov_b32 v11, 0xffff0000
    v_cndmask_b32 v3, 0, v5, s[64:65]
    v_cndmask_b32 v4, 0, v11, s[66:67]
    v_or_b32 v24, v3, v4
    v_cndmask_b32 v3, 0, v5, s[68:69]
    v_cndmask_b32 v4, 0, v11, s[70:71]
    v_or_b32 v25, v3, v4
    v_cndmask_b32 v3, 0, v5, s[72:73]
    v_cndmask_b32 v4, 0, v11, s[74:75]
    v_or_b32 v26, v3, v4
    v_cndmask_b32 v3, 0, v5, s[76:77]
    v_cndmask_b32 v4, 0, v11, s[78:79]
    v_or_b32 v27, v3, v4
    v_cndmask_b32 v3, 0, v5, s[80:81]
    v_cndmask_b32 v4, 0, v11, s[82:83]
    v_or_b32 v28, v3, v4
    v_cndmask_b32 v3, 0, v5, s[84:85]
    v_cndmask_b32 v4, 0, v11, s[86:87]
    v_or_b32 v29, v3, v4
    v_cndmask_b32 v3, 0, v5, s[88:89]
    v_cndmask_b32 v4, 0, v11, s[90:91]
    v_or_b32 v30, v3, v4
    v_cndmask_b32 v3, 0, v5, s[92:93]
    v_cndmask_b32 v4, 0, v11, s[94:95]
    v_or_b32 v31, v3, v4
    v_cmp_eq_u32 s[96:97], 1, v13
    v_cmp_gt_u32 s[98:99], 20, v12
    v_cmp_eq_u32 s[100:101], 0, v13
    s_lshl_b32 s49, s40, 8
    s_add_u32 s49, s49, 102400
    v_lshl_add_u32 v16, v13, 13, v14
    v_add_u32 v16, s49, v16
    v_add_u32 v17, s49, v14
    s_and_b32 s55, s45, 1
    v_bfe_u32 v3, v12, 3, 1
    v_bfe_u32 v4, v12, 2, 1
    v_and_b32 v5, 3, v12
    v_lshl_add_u32 v18, v3, 2, v5
    v_lshl_add_u32 v18, v4, 3, v18
    s_lshl_b32 s49, s55, 2
    v_add_u32 v18, s49, v18
    s_lshl_b32 s49, s55, 4
    s_sub_u32 s49, 16, s49
    v_add_u32 v19, s49, v5
    v_cmp_gt_u32 vcc, 16, v12
    s_nop 1
    v_cndmask_b32 v18, v19, v18, vcc
    v_mul_u32_u24 v19, 320, v13
    v_lshl_add_u32 v18, v18, 4, v19
    s_mul_i32 s49, s40, 1280
    s_add_u32 s49, s49, 122880
    v_add_u32 v18, s49, v18
    v_mov_b32 v19, 0
    v_mov_b32 v4, 0x3f803f80
    v_cmp_eq_u32 vcc, 20, v12
    s_nop 1
    v_cndmask_b32 v19, v19, v4, vcc
    v_cmp_eq_u32 vcc, 24, v12
    s_nop 1
    v_cndmask_b32 v19, v19, v4, vcc
    v_mov_b32 v54, 0
    v_mov_b32 v55, 0
    v_mov_b32 v62, 0
    v_mov_b32 v63, 0
    v_mov_b32 v70, 0
    v_mov_b32 v71, 0
    v_mov_b32 v46, 0
    v_mov_b32 v47, 0
    v_cndmask_b32 v36, v4, 0, s[96:97]
    v_mov_b32 v37, 0
    v_mov_b32 v33, 0
    v_mov_b32 v38, 0
    v_mov_b32 v34, 0
    v_mov_b32 v39, 0
    v_mov_b32 v35, 0
    v_and_b32 v3, 15, v1
    s_mul_i32 s49, s45, 20
    s_mov_b64 s[46:47], 0
    s_add_u32 s60, s49, 0
    s_lshr_b32 s60, s60, 7
    v_cmp_eq_u32 vcc, s60, v3
    s_nop 0
    s_and_b64 vcc, vcc, s[96:97]
    s_or_b64 s[46:47], s[46:47], vcc
    s_add_u32 s60, s49, 19
    s_lshr_b32 s60, s60, 7
    v_cmp_eq_u32 vcc, s60, v3
    s_nop 0
    s_and_b64 vcc, vcc, s[96:97]
    s_or_b64 s[46:47], s[46:47], vcc
    s_add_u32 s60, s49, 640
    s_lshr_b32 s60, s60, 7
    v_cmp_eq_u32 vcc, s60, v3
    s_nop 0
    s_or_b64 s[46:47], s[46:47], vcc
    s_add_u32 s60, s49, 659
    s_lshr_b32 s60, s60, 7
    v_cmp_eq_u32 vcc, s60, v3
    s_nop 0
    s_or_b64 s[46:47], s[46:47], vcc
    s_add_u32 s60, s49, 1280
    s_lshr_b32 s60, s60, 7
    v_cmp_eq_u32 vcc, s60, v3
    s_nop 0
    s_or_b64 s[46:47], s[46:47], vcc
    s_add_u32 s60, s49, 1299
    s_lshr_b32 s60, s60, 7
    v_cmp_eq_u32 vcc, s60, v3
    s_nop 0
    s_or_b64 s[46:47], s[46:47], vcc
    s_cmp_eq_u32 s44, 0
    s_cselect_b32 s46, 0, s46
    s_lshl_b32 s49, s44, 7
    s_lshl_b32 s60, s41, 10
    s_add_u32 s49, s49, s60
    s_add_u32 s49, s49, 19431296
    v_lshlrev_b32 v3, 2, v1
    s_nop 1
    s_branch P2_2
L1_1:
    s_and_b32 s47, s41, 3
    s_lshr_b32 s46, s41, 2
    s_mul_i32 s46, s46, 30
    s_add_u32 s46, s46, s42
    s_lshr_b32 s44, s46, 2
    s_and_b32 s46, s46, 3
    s_lshl_b32 s47, s47, 2
    s_add_u32 s45, s47, s46
    s_add_u32 s56, s45, s44
    s_sub_u32 s47, s56, 10
    s_cmp_ge_u32 s56, 10
    s_cselect_b32 s56, s47, s56
    s_sub_u32 s47, s56, 10
    s_cmp_ge_u32 s56, 10
    s_cselect_b32 s56, s47, s56
    s_lshl_b32 s46, s45, 7
    s_lshl_b32 s47, s43, 5
    s_add_u32 s46, s46, s47
    s_cmp_ge_u32 s42, 30
    s_cbranch_scc1 L_HELP_115
    s_cmp_ge_u32 s56, 5
    s_cselect_b32 s55, 5, 0
    v_lshrrev_b32 v10, 3, v1
    v_add_u32 v10, s46, v10
    v_mul_u32_u24 v10, 1280, v10
    v_and_b32 v11, 7, v1
    v_lshrrev_b32 v12, 4, v1
    v_xor_b32 v11, v11, v12
    v_xor_b32 v13, 4, v11
    v_lshl_add_u32 v2, v11, 4, v10
    v_lshl_add_u32 v3, v13, 4, v10
    v_add_u32 v3, 9216, v3
    v_add_u32 v4, 18432, v2
    v_add_u32 v5, 18432, v3
    s_lshl_b32 s47, s43, 4
    v_add_u32 v10, s47, v12
    v_mul_u32_u24 v10, 3840, v10
    s_lshl_b32 s47, s44, 8
    v_add_u32 v10, s47, v10
    v_bfe_u32 v11, v1, 2, 2
    v_xor_b32 v11, v11, v12
    v_lshl_add_u32 v10, v11, 6, v10
    v_and_b32 v11, 3, v1
    v_lshl_add_u32 v6, v11, 4, v10
    v_add_u32 v7, 14336, v6
    v_add_u32 v8, 28672, v6
    v_add_u32 v9, 43008, v6
    s_lshl_b32 s48, s43, 12
    s_add_u32 m0, s48, 0
    s_lshl_b32 s49, s55, 7
    buffer_load_dwordx4 v2, s[4:7], s49 offen offset:0 lds
    buffer_load_dwordx4 v3, s[4:7], s49 offen offset:1024 lds
    buffer_load_dwordx4 v4, s[4:7], s49 offen offset:2048 lds
    buffer_load_dwordx4 v5, s[4:7], s49 offen offset:3072 lds
    s_add_u32 m0, s48, 16384
    s_mul_i32 s50, s55, 245760
    s_add_u32 s55, s55, 1
    s_cmp_eq_u32 s55, 10
    s_cselect_b32 s55, 0, s55
    buffer_load_dwordx4 v6, s[8:11], s50 offen offset:0 lds
    buffer_load_dwordx4 v7, s[8:11], s50 offen offset:1024 lds
    buffer_load_dwordx4 v8, s[8:11], s50 offen offset:2048 lds
    buffer_load_dwordx4 v9, s[8:11], s50 offen offset:3072 lds
    s_mov_b32 s12, s68
    s_and_b32 s13, s69, 0xffff
    s_mov_b32 s14, 819200
    s_mov_b32 s15, 0x00020000
    s_mov_b32 s16, s72
    s_and_b32 s17, s73, 0xffff
    s_mov_b32 s18, 1966080
    s_mov_b32 s19, 0x00020000
    s_mov_b32 s20, s74
    s_and_b32 s21, s75, 0xffff
    s_mov_b32 s22, 1966080
    s_mov_b32 s23, 0x00020000
    s_mov_b32 s24, s76
    s_and_b32 s25, s77, 0xffff
    s_mov_b32 s26, 1966080
    s_mov_b32 s27, 0x00020000
    s_mov_b32 s28, s78
    s_and_b32 s29, s79, 0xffff
    s_mov_b32 s30, 2621440
    s_mov_b32 s31, 0x00020000
    s_mov_b32 s32, s82
    s_and_b32 s33, s83, 0xffff
    s_mov_b32 s34, 20971520
    s_mov_b32 s35, 0x00020000
    s_mov_b32 s36, s80
    s_and_b32 s37, s81, 0xffff
    s_mov_b32 s38, 256
    s_mov_b32 s39, 0x00020000
    s_add_u32 m0, s48, 32768
    s_lshl_b32 s49, s55, 7
    buffer_load_dwordx4 v2, s[4:7], s49 offen offset:0 lds
    buffer_load_dwordx4 v3, s[4:7], s49 offen offset:1024 lds
    buffer_load_dwordx4 v4, s[4:7], s49 offen offset:2048 lds
    buffer_load_dwordx4 v5, s[4:7], s49 offen offset:3072 lds
    s_add_u32 m0, s48, 49152
    s_mul_i32 s50, s55, 245760
    s_add_u32 s55, s55, 1
    s_cmp_eq_u32 s55, 10
    s_cselect_b32 s55, 0, s55
    buffer_load_dwordx4 v6, s[8:11], s50 offen offset:0 lds
    buffer_load_dwordx4 v7, s[8:11], s50 offen offset:1024 lds
    buffer_load_dwordx4 v8, s[8:11], s50 offen offset:2048 lds
    buffer_load_dwordx4 v9, s[8:11], s50 offen offset:3072 lds
    s_waitcnt vmcnt(8)
    s_barrier
    s_add_u32 m0, s48, 65536
    s_lshl_b32 s49, s55, 7
    buffer_load_dwordx4 v2, s[4:7], s49 offen offset:0 lds
    buffer_load_dwordx4 v3, s[4:7], s49 offen offset:1024 lds
    buffer_load_dwordx4 v4, s[4:7], s49 offen offset:2048 lds
    buffer_load_dwordx4 v5, s[4:7], s49 offen offset:3072 lds
    s_add_u32 m0, s48, 81920
    s_mul_i32 s50, s55, 245760
    s_add_u32 s55, s55, 1
    s_cmp_eq_u32 s55, 10
    s_cselect_b32 s55, 0, s55
    buffer_load_dwordx4 v6, s[8:11], s50 offen offset:0 lds
    buffer_load_dwordx4 v7, s[8:11], s50 offen offset:1024 lds
    buffer_load_dwordx4 v8, s[8:11], s50 offen offset:2048 lds
    buffer_load_dwordx4 v9, s[8:11], s50 offen offset:3072 lds
    s_add_u32 m0, s48, 98304
    s_lshl_b32 s49, s55, 7
    buffer_load_dwordx4 v2, s[4:7], s49 offen offset:0 lds
    buffer_load_dwordx4 v3, s[4:7], s49 offen offset:1024 lds
    buffer_load_dwordx4 v4, s[4:7], s49 offen offset:2048 lds
    buffer_load_dwordx4 v5, s[4:7], s49 offen offset:3072 lds
    s_add_u32 m0, s48, 114688
    s_mul_i32 s50, s55, 245760
    s_add_u32 s55, s55, 1
    s_cmp_eq_u32 s55, 10
    s_cselect_b32 s55, 0, s55
    buffer_load_dwordx4 v6, s[8:11], s50 offen offset:0 lds
    buffer_load_dwordx4 v7, s[8:11], s50 offen offset:1024 lds
    buffer_load_dwordx4 v8, s[8:11], s50 offen offset:2048 lds
    buffer_load_dwordx4 v9, s[8:11], s50 offen offset:3072 lds
    s_waitcnt vmcnt(16)
    s_barrier
    s_add_u32 m0, s48, 0
    s_lshl_b32 s49, s55, 7
    buffer_load_dwordx4 v2, s[4:7], s49 offen offset:0 lds
    buffer_load_dwordx4 v3, s[4:7], s49 offen offset:1024 lds
    buffer_load_dwordx4 v4, s[4:7], s49 offen offset:2048 lds
    buffer_load_dwordx4 v5, s[4:7], s49 offen offset:3072 lds
    s_add_u32 m0, s48, 16384
    s_mul_i32 s50, s55, 245760
    s_add_u32 s55, s55, 1
    s_cmp_eq_u32 s55, 10
    s_cselect_b32 s55, 0, s55
    buffer_load_dwordx4 v6, s[8:11], s50 offen offset:0 lds
    buffer_load_dwordx4 v7, s[8:11], s50 offen offset:1024 lds
    buffer_load_dwordx4 v8, s[8:11], s50 offen offset:2048 lds
    buffer_load_dwordx4 v9, s[8:11], s50 offen offset:3072 lds
    s_waitcnt vmcnt(16)
    s_barrier
    s_add_u32 m0, s48, 32768
    s_lshl_b32 s49, s55, 7
    buffer_load_dwordx4 v2, s[4:7], s49 offen offset:0 lds
    buffer_load_dwordx4 v3, s[4:7], s49 offen offset:1024 lds
    buffer_load_dwordx4 v4, s[4:7], s49 offen offset:2048 lds
    buffer_load_dwordx4 v5, s[4:7], s49 offen offset:3072 lds
    s_add_u32 m0, s48, 49152
    s_mul_i32 s50, s55, 245760
    s_add_u32 s55, s55, 1
    s_cmp_eq_u32 s55, 10
    s_cselect_b32 s55, 0, s55
    buffer_load_dwordx4 v6, s[8:11], s50 offen offset:0 lds
    buffer_load_dwordx4 v7, s[8:11], s50 offen offset:1024 lds
    buffer_load_dwordx4 v8, s[8:11], s50 offen offset:2048 lds
    buffer_load_dwordx4 v9, s[8:11], s50 offen offset:3072 lds
    s_waitcnt vmcnt(16)
    s_barrier
    s_add_u32 m0, s48, 65536
    s_lshl_b32 s49, s55, 7
    buffer_load_dwordx4 v2, s[4:7], s49 offen offset:0 lds
    buffer_load_dwordx4 v3, s[4:7], s49 offen offset:1024 lds
    buffer_load_dwordx4 v4, s[4:7], s49 offen offset:2048 lds
    buffer_load_dwordx4 v5, s[4:7], s49 offen offset:3072 lds
    s_add_u32 m0, s48, 81920
    s_mul_i32 s50, s55, 245760
    s_add_u32 s55, s55, 1
    s_cmp_eq_u32 s55, 10
    s_cselect_b32 s55, 0, s55
    buffer_load_dwordx4 v6, s[8:11], s50 offen offset:0 lds
    buffer_load_dwordx4 v7, s[8:11], s50 offen offset:1024 lds
    buffer_load_dwordx4 v8, s[8:11], s50 offen offset:2048 lds
    buffer_load_dwordx4 v9, s[8:11], s50 offen offset:3072 lds
    s_waitcnt vmcnt(16)
    s_barrier
    s_add_u32 m0, s48, 98304
    s_lshl_b32 s49, s55, 7
    buffer_load_dwordx4 v2, s[4:7], s49 offen offset:0 lds
    buffer_load_dwordx4 v3, s[4:7], s49 offen offset:1024 lds
    buffer_load_dwordx4 v4, s[4:7], s49 offen offset:2048 lds
    buffer_load_dwordx4 v5, s[4:7], s49 offen offset:3072 lds
    s_add_u32 m0, s48, 114688
    s_mul_i32 s50, s55, 245760
    s_add_u32 s55, s55, 1
    s_cmp_eq_u32 s55, 10
    s_cselect_b32 s55, 0, s55
    buffer_load_dwordx4 v6, s[8:11], s50 offen offset:0 lds
    buffer_load_dwordx4 v7, s[8:11], s50 offen offset:1024 lds
    buffer_load_dwordx4 v8, s[8:11], s50 offen offset:2048 lds
    buffer_load_dwordx4 v9, s[8:11], s50 offen offset:3072 lds
    s_waitcnt vmcnt(16)
    s_barrier
    s_add_u32 m0, s48, 0
    s_lshl_b32 s49, s55, 7
    buffer_load_dwordx4 v2, s[4:7], s49 offen offset:0 lds
    buffer_load_dwordx4 v3, s[4:7], s49 offen offset:1024 lds
    buffer_load_dwordx4 v4, s[4:7], s49 offen offset:2048 lds
    buffer_load_dwordx4 v5, s[4:7], s49 offen offset:3072 lds
    s_add_u32 m0, s48, 16384
    s_mul_i32 s50, s55, 245760
    s_add_u32 s55, s55, 1
    s_cmp_eq_u32 s55, 10
    s_cselect_b32 s55, 0, s55
    buffer_load_dwordx4 v6, s[8:11], s50 offen offset:0 lds
    buffer_load_dwordx4 v7, s[8:11], s50 offen offset:1024 lds
    buffer_load_dwordx4 v8, s[8:11], s50 offen offset:2048 lds
    buffer_load_dwordx4 v9, s[8:11], s50 offen offset:3072 lds
    s_waitcnt vmcnt(16)
    s_barrier
    s_add_u32 m0, s48, 32768
    s_lshl_b32 s49, s55, 7
    buffer_load_dwordx4 v2, s[4:7], s49 offen offset:0 lds
    buffer_load_dwordx4 v3, s[4:7], s49 offen offset:1024 lds
    buffer_load_dwordx4 v4, s[4:7], s49 offen offset:2048 lds
    buffer_load_dwordx4 v5, s[4:7], s49 offen offset:3072 lds
    s_add_u32 m0, s48, 49152
    s_mul_i32 s50, s55, 245760
    s_add_u32 s55, s55, 1
    s_cmp_eq_u32 s55, 10
    s_cselect_b32 s55, 0, s55
    buffer_load_dwordx4 v6, s[8:11], s50 offen offset:0 lds
    buffer_load_dwordx4 v7, s[8:11], s50 offen offset:1024 lds
    buffer_load_dwordx4 v8, s[8:11], s50 offen offset:2048 lds
    buffer_load_dwordx4 v9, s[8:11], s50 offen offset:3072 lds
    v_subrev_u32 v120, 0, v0
    v_cmp_gt_u32 vcc, 100, v120
    v_mul_u32_u24 v121, 13108, v120
    v_lshrrev_b32 v121, 16, v121
    v_mul_u32_u24 v121, 640, v121
    v_lshl_add_u32 v120, v120, 7, v121
    v_mov_b32 v121, 1073741824
    v_cndmask_b32 v120, v121, v120, vcc
    s_mul_i32 s60, s42, 25600
    s_lshr_b32 s61, s41, 2
    s_mul_i32 s61, s61, 640
    s_add_u32 s60, s60, s61
    buffer_load_dword v121, v120, s[12:15], s60 offen
    s_and_b32 s0, s41, 3
    s_lshl_b32 s0, s0, 3
    s_and_b32 s61, s42, 7
    s_add_u32 s61, s61, s0
    s_lshr_b32 s0, s41, 2
    s_lshl_b32 s0, s0, 2
    s_lshr_b32 s60, s42, 3
    s_add_u32 s60, s60, s0
    s_sub_u32 s36, s60, 5
    s_cmp_ge_u32 s60, 5
    s_cselect_b32 s36, s36, s60
    s_mul_i32 s60, s60, 160
    s_mul_i32 s1, s43, 204800
    s_add_u32 s60, s60, s1
    v_add_u32 v100, 0, v1
    v_mul_u32_u24 v101, 6554, v100
    v_lshrrev_b32 v101, 16, v101
    v_mul_u32_u24 v102, 10, v101
    v_sub_u32 v102, v100, v102
    v_bfe_u32 v103, v101, 3, 1
    v_lshlrev_b32 v103, 2, v103
    v_xor_b32 v101, v101, v103
    v_mul_u32_u24 v101, 1280, v101
    v_lshl_add_u32 v232, v102, 4, v101
    v_add_u32 v232, s60, v232
    v_add_u32 v100, 64, v1
    v_mul_u32_u24 v101, 6554, v100
    v_lshrrev_b32 v101, 16, v101
    v_mul_u32_u24 v102, 10, v101
    v_sub_u32 v102, v100, v102
    v_bfe_u32 v103, v101, 3, 1
    v_lshlrev_b32 v103, 2, v103
    v_xor_b32 v101, v101, v103
    v_mul_u32_u24 v101, 1280, v101
    v_lshl_add_u32 v233, v102, 4, v101
    v_add_u32 v233, s60, v233
    v_subrev_u32 v233, 1024, v233
    v_add_u32 v100, 128, v1
    v_mul_u32_u24 v101, 6554, v100
    v_lshrrev_b32 v101, 16, v101
    v_mul_u32_u24 v102, 10, v101
    v_sub_u32 v102, v100, v102
    v_bfe_u32 v103, v101, 3, 1
    v_lshlrev_b32 v103, 2, v103
    v_xor_b32 v101, v101, v103
    v_mul_u32_u24 v101, 1280, v101
    v_lshl_add_u32 v234, v102, 4, v101
    v_add_u32 v234, s60, v234
    v_subrev_u32 v234, 2048, v234
    v_add_u32 v100, 192, v1
    v_mul_u32_u24 v101, 6554, v100
    v_lshrrev_b32 v101, 16, v101
    v_mul_u32_u24 v102, 10, v101
    v_sub_u32 v102, v100, v102
    v_bfe_u32 v103, v101, 3, 1
    v_lshlrev_b32 v103, 2, v103
    v_xor_b32 v101, v101, v103
    v_mul_u32_u24 v101, 1280, v101
    v_lshl_add_u32 v235, v102, 4, v101
    v_add_u32 v235, s60, v235
    v_subrev_u32 v235, 3072, v235
    v_add_u32 v100, 256, v1
    v_mul_u32_u24 v101, 6554, v100
    v_lshrrev_b32 v101, 16, v101
    v_mul_u32_u24 v102, 10, v101
    v_sub_u32 v102, v100, v102
    v_bfe_u32 v103, v101, 3, 1
    v_lshlrev_b32 v103, 2, v103
    v_xor_b32 v101, v101, v103
    v_mul_u32_u24 v101, 1280, v101
    v_lshl_add_u32 v236, v102, 4, v101
    v_add_u32 v236, s60, v236
    s_mul_i32 s0, s43, 5120
    s_and_b32 s45, s42, 3
    s_lshl_b32 s44, s41, 2
    s_add_u32 s45, s45, s44
    s_lshr_b32 s44, s42, 2
    s_lshl_b32 s46, s44, 8
    s_sub_u32 s47, s46, 256
    s_max_i32 s47, s47, 0
    s_cmp_lt_u32 s43, 2
    s_cselect_b32 s48, s47, s46
    s_mov_b32 s50, s48
    s_and_b32 s49, s43, 1
    s_lshl_b32 s49, s49, 7
    s_add_u32 s48, s48, s49
    s_lshl_b32 s48, s48, 3
    s_mul_i32 s49, s45, 81920
    s_add_u32 s48, s48, s49
    s_add_u32 s48, s48, 2621440
    v_lshlrev_b32 v2, 4, v1
    s_lshr_b32 s50, s50, 3
    s_mul_i32 s50, s50, 10240
    s_mul_i32 s49, s45, 320
    s_add_u32 s50, s50, s49
    s_add_u32 s50, s50, 5242880
    s_cmp_lt_u32 s40, 4
    s_cselect_b32 s48, s48, s50
    s_cselect_b64 s[96:97], -1, 0
    s_lshl_b32 s49, s43, 10
    s_add_u32 s49, s49, 102400
    s_mul_i32 s50, s43, 5120
    s_add_u32 s50, s50, 122880
    s_cmp_lt_u32 s40, 4
    s_cselect_b32 s50, s49, s50
    s_waitcnt vmcnt(17)
    s_barrier
    s_movk_i32 s56, 1024
    s_cselect_b32 s56, 4096, s56
    s_and_b32 s49, s43, 1
    s_mul_i32 s49, s49, 320
    v_add_u32 v3, 0, v1
    v_add_u32 v3, s49, v3
    v_mul_u32_u24 v4, 3277, v3
    v_lshrrev_b32 v4, 16, v4
    v_mul_u32_u24 v5, 20, v4
    v_sub_u32 v5, v3, v5
    v_mul_u32_u24 v4, 10240, v4
    v_lshl_add_u32 v4, v5, 4, v4
    v_add_u32 v5, 0, v2
    v_cndmask_b32 v6, v4, v5, s[96:97]
    v_add_u32 v3, 64, v1
    v_add_u32 v3, s49, v3
    v_mul_u32_u24 v4, 3277, v3
    v_lshrrev_b32 v4, 16, v4
    v_mul_u32_u24 v5, 20, v4
    v_sub_u32 v5, v3, v5
    v_mul_u32_u24 v4, 10240, v4
    v_lshl_add_u32 v4, v5, 4, v4
    v_add_u32 v5, 16384, v2
    v_cndmask_b32 v7, v4, v5, s[96:97]
    v_add_u32 v3, 128, v1
    v_add_u32 v3, s49, v3
    v_mul_u32_u24 v4, 3277, v3
    v_lshrrev_b32 v4, 16, v4
    v_mul_u32_u24 v5, 20, v4
    v_sub_u32 v5, v3, v5
    v_mul_u32_u24 v4, 10240, v4
    v_lshl_add_u32 v4, v5, 4, v4
    v_add_u32 v5, 32768, v2
    v_cndmask_b32 v8, v4, v5, s[96:97]
    v_add_u32 v3, 192, v1
    v_add_u32 v3, s49, v3
    v_mul_u32_u24 v4, 3277, v3
    v_lshrrev_b32 v4, 16, v4
    v_mul_u32_u24 v5, 20, v4
    v_sub_u32 v5, v3, v5
    v_mul_u32_u24 v4, 10240, v4
    v_lshl_add_u32 v4, v5, 4, v4
    v_add_u32 v5, 49152, v2
    v_cndmask_b32 v9, v4, v5, s[96:97]
    v_add_u32 v3, 256, v1
    v_add_u32 v3, s49, v3
    v_mul_u32_u24 v4, 3277, v3
    v_lshrrev_b32 v4, 16, v4
    v_mul_u32_u24 v5, 20, v4
    v_sub_u32 v5, v3, v5
    v_mul_u32_u24 v4, 10240, v4
    v_lshl_add_u32 v4, v5, 4, v4
    v_add_u32 v5, 65536, v2
    v_cndmask_b32 v10, v4, v5, s[96:97]
    v_and_b32 v12, 31, v1
    v_lshrrev_b32 v13, 5, v1
    v_lshlrev_b32 v14, 3, v12
    v_lshl_add_u32 v15, v13, 15, v14
    s_lshl_b32 s51, s40, 5
    s_add_u32 s51, s51, s46
    s_lshl_b32 s52, s51, 3
    s_mul_i32 s49, s45, 81920
    s_add_u32 s52, s52, s49
    s_add_u32 s52, s52, 0
    s_add_u32 s53, s52, 16384
    s_add_u32 s54, s52, 65536
    v_lshlrev_b32 v3, 2, v13
    v_add_u32 v4, 0, v3
    v_cmp_le_u32 s[64:65], v4, v12
    v_add_u32 v4, 1, v3
    v_cmp_le_u32 s[66:67], v4, v12
    v_add_u32 v4, 2, v3
    v_cmp_le_u32 s[68:69], v4, v12
    v_add_u32 v4, 3, v3
    v_cmp_le_u32 s[70:71], v4, v12
    v_add_u32 v4, 8, v3
    v_cmp_le_u32 s[72:73], v4, v12
    v_add_u32 v4, 9, v3
    v_cmp_le_u32 s[74:75], v4, v12
    v_add_u32 v4, 10, v3
    v_cmp_le_u32 s[76:77], v4, v12
    v_add_u32 v4, 11, v3
    v_cmp_le_u32 s[78:79], v4, v12
    v_add_u32 v4, 16, v3
    v_cmp_le_u32 s[80:81], v4, v12
    v_add_u32 v4, 17, v3
    v_cmp_le_u32 s[82:83], v4, v12
    v_add_u32 v4, 18, v3
    v_cmp_le_u32 s[84:85], v4, v12
    v_add_u32 v4, 19, v3
    v_cmp_le_u32 s[86:87], v4, v12
    v_add_u32 v4, 24, v3
    v_cmp_le_u32 s[88:89], v4, v12
    v_add_u32 v4, 25, v3
    v_cmp_le_u32 s[90:91], v4, v12
    v_add_u32 v4, 26, v3
    v_cmp_le_u32 s[92:93], v4, v12
    v_add_u32 v4, 27, v3
    v_cmp_le_u32 s[94:95], v4, v12
    v_mov_b32 v5, 0xffff
    v_mov_b32 v11, 0xffff0000
    v_cndmask_b32 v3, 0, v5, s[64:65]
    v_cndmask_b32 v4, 0, v11, s[66:67]
    v_or_b32 v24, v3, v4
    v_cndmask_b32 v3, 0, v5, s[68:69]
    s_waitcnt vmcnt(9)
    s_barrier
    v_cndmask_b32 v4, 0, v11, s[70:71]
    v_or_b32 v25, v3, v4
    v_cndmask_b32 v3, 0, v5, s[72:73]
    v_cndmask_b32 v4, 0, v11, s[74:75]
    v_or_b32 v26, v3, v4
    v_cndmask_b32 v3, 0, v5, s[76:77]
    v_cndmask_b32 v4, 0, v11, s[78:79]
    v_or_b32 v27, v3, v4
    v_cndmask_b32 v3, 0, v5, s[80:81]
    v_cndmask_b32 v4, 0, v11, s[82:83]
    v_or_b32 v28, v3, v4
    v_cndmask_b32 v3, 0, v5, s[84:85]
    v_cndmask_b32 v4, 0, v11, s[86:87]
    v_or_b32 v29, v3, v4
    v_cndmask_b32 v3, 0, v5, s[88:89]
    v_cndmask_b32 v4, 0, v11, s[90:91]
    v_or_b32 v30, v3, v4
    v_cndmask_b32 v3, 0, v5, s[92:93]
    v_cndmask_b32 v4, 0, v11, s[94:95]
    v_or_b32 v31, v3, v4
    v_cmp_eq_u32 s[96:97], 1, v13
    v_cmp_gt_u32 s[98:99], 20, v12
    v_cmp_eq_u32 s[100:101], 0, v13
    s_lshl_b32 s49, s40, 8
    s_add_u32 s49, s49, 102400
    v_lshl_add_u32 v16, v13, 13, v14
    v_add_u32 v16, s49, v16
    v_add_u32 v17, s49, v14
    s_and_b32 s55, s45, 1
    v_bfe_u32 v3, v12, 3, 1
    v_bfe_u32 v4, v12, 2, 1
    v_and_b32 v5, 3, v12
    v_lshl_add_u32 v18, v3, 2, v5
    v_lshl_add_u32 v18, v4, 3, v18
    s_lshl_b32 s49, s55, 2
    v_add_u32 v18, s49, v18
    s_lshl_b32 s49, s55, 4
    s_sub_u32 s49, 16, s49
    v_add_u32 v19, s49, v5
    v_cmp_gt_u32 vcc, 16, v12
    s_nop 1
    v_cndmask_b32 v18, v19, v18, vcc
    v_mul_u32_u24 v19, 320, v13
    v_lshl_add_u32 v18, v18, 4, v19
    s_mul_i32 s49, s40, 1280
    s_add_u32 s49, s49, 122880
    v_add_u32 v18, s49, v18
    v_mov_b32 v19, 0
    v_mov_b32 v4, 0x3f803f80
    v_cmp_eq_u32 vcc, 20, v12
    s_nop 1
    v_cndmask_b32 v19, v19, v4, vcc
    v_cmp_eq_u32 vcc, 24, v12
    s_nop 1
    v_cndmask_b32 v19, v19, v4, vcc
    v_mov_b32 v54, 0
    v_mov_b32 v55, 0
    v_mov_b32 v62, 0
    v_mov_b32 v63, 0
    v_mov_b32 v70, 0
    v_mov_b32 v71, 0
    v_mov_b32 v46, 0
    v_mov_b32 v47, 0
    v_cndmask_b32 v36, v4, 0, s[96:97]
    v_mov_b32 v37, 0
    v_mov_b32 v33, 0
    v_mov_b32 v38, 0
    v_mov_b32 v34, 0
    v_mov_b32 v39, 0
    v_mov_b32 v35, 0
    v_and_b32 v3, 15, v1
    s_mul_i32 s49, s45, 20
    s_mov_b64 s[46:47], 0
    s_add_u32 s60, s49, 0
    s_lshr_b32 s60, s60, 7
    v_cmp_eq_u32 vcc, s60, v3
    s_nop 0
    s_and_b64 vcc, vcc, s[96:97]
    s_or_b64 s[46:47], s[46:47], vcc
    s_add_u32 s60, s49, 19
    s_lshr_b32 s60, s60, 7
    v_cmp_eq_u32 vcc, s60, v3
    s_nop 0
    s_and_b64 vcc, vcc, s[96:97]
    s_or_b64 s[46:47], s[46:47], vcc
    s_add_u32 s60, s49, 640
    s_lshr_b32 s60, s60, 7
    v_cmp_eq_u32 vcc, s60, v3
    s_nop 0
    s_or_b64 s[46:47], s[46:47], vcc
    s_add_u32 s60, s49, 659
    s_lshr_b32 s60, s60, 7
    v_cmp_eq_u32 vcc, s60, v3
    s_nop 0
    s_or_b64 s[46:47], s[46:47], vcc
    s_add_u32 s60, s49, 1280
    s_lshr_b32 s60, s60, 7
    v_cmp_eq_u32 vcc, s60, v3
    s_nop 0
    s_or_b64 s[46:47], s[46:47], vcc
    s_add_u32 s60, s49, 1299
    s_lshr_b32 s60, s60, 7
    v_cmp_eq_u32 vcc, s60, v3
    s_nop 0
    s_or_b64 s[46:47], s[46:47], vcc
    s_cmp_eq_u32 s44, 0
    s_cselect_b32 s46, 0, s46
    s_lshl_b32 s49, s44, 7
    s_lshl_b32 s60, s41, 10
    s_add_u32 s49, s49, s60
    s_add_u32 s49, s49, 19431296
    v_lshlrev_b32 v3, 2, v1
    s_waitcnt vmcnt(1)
    s_barrier
    s_branch L_P1E_116
L_HELP_115:
    s_mov_b32 s12, s68
    s_and_b32 s13, s69, 0xffff
    s_mov_b32 s14, 819200
    s_mov_b32 s15, 0x00020000
    s_mov_b32 s16, s72
    s_and_b32 s17, s73, 0xffff
    s_mov_b32 s18, 1966080
    s_mov_b32 s19, 0x00020000
    s_mov_b32 s20, s74
    s_and_b32 s21, s75, 0xffff
    s_mov_b32 s22, 1966080
    s_mov_b32 s23, 0x00020000
    s_mov_b32 s24, s76
    s_and_b32 s25, s77, 0xffff
    s_mov_b32 s26, 1966080
    s_mov_b32 s27, 0x00020000
    s_mov_b32 s28, s78
    s_and_b32 s29, s79, 0xffff
    s_mov_b32 s30, 2621440
    s_mov_b32 s31, 0x00020000
    s_mov_b32 s32, s82
    s_and_b32 s33, s83, 0xffff
    s_mov_b32 s34, 20971520
    s_mov_b32 s35, 0x00020000
    s_mov_b32 s36, s80
    s_and_b32 s37, s81, 0xffff
    s_mov_b32 s38, 256
    s_mov_b32 s39, 0x00020000
    s_barrier
    s_barrier
    s_barrier
    s_barrier
    s_barrier
    s_barrier
    s_barrier
    s_barrier
    s_barrier
    s_barrier
    v_subrev_u32 v120, 0, v0
    v_cmp_gt_u32 vcc, 100, v120
    v_mul_u32_u24 v121, 13108, v120
    v_lshrrev_b32 v121, 16, v121
    v_mul_u32_u24 v121, 640, v121
    v_lshl_add_u32 v120, v120, 7, v121
    v_mov_b32 v121, 1073741824
    v_cndmask_b32 v120, v121, v120, vcc
    s_mul_i32 s60, s42, 25600
    s_lshr_b32 s61, s41, 2
    s_mul_i32 s61, s61, 640
    s_add_u32 s60, s60, s61
    buffer_load_dword v121, v120, s[12:15], s60 offen
    s_and_b32 s0, s41, 3
    s_lshl_b32 s0, s0, 3
    s_and_b32 s61, s42, 7
    s_add_u32 s61, s61, s0
    s_lshr_b32 s0, s41, 2
    s_lshl_b32 s0, s0, 2
    s_lshr_b32 s60, s42, 3
    s_add_u32 s60, s60, s0
    s_sub_u32 s36, s60, 5
    s_cmp_ge_u32 s60, 5
    s_cselect_b32 s36, s36, s60
    s_mul_i32 s60, s60, 160
    s_mul_i32 s1, s43, 204800
    s_add_u32 s60, s60, s1
    v_add_u32 v100, 0, v1
    v_mul_u32_u24 v101, 6554, v100
    v_lshrrev_b32 v101, 16, v101
    v_mul_u32_u24 v102, 10, v101
    v_sub_u32 v102, v100, v102
    v_bfe_u32 v103, v101, 3, 1
    v_lshlrev_b32 v103, 2, v103
    v_xor_b32 v101, v101, v103
    v_mul_u32_u24 v101, 1280, v101
    v_lshl_add_u32 v232, v102, 4, v101
    v_add_u32 v232, s60, v232
    v_add_u32 v100, 64, v1
    v_mul_u32_u24 v101, 6554, v100
    v_lshrrev_b32 v101, 16, v101
    v_mul_u32_u24 v102, 10, v101
    v_sub_u32 v102, v100, v102
    v_bfe_u32 v103, v101, 3, 1
    v_lshlrev_b32 v103, 2, v103
    v_xor_b32 v101, v101, v103
    v_mul_u32_u24 v101, 1280, v101
    v_lshl_add_u32 v233, v102, 4, v101
    v_add_u32 v233, s60, v233
    v_subrev_u32 v233, 1024, v233
    v_add_u32 v100, 128, v1
    v_mul_u32_u24 v101, 6554, v100
    v_lshrrev_b32 v101, 16, v101
    v_mul_u32_u24 v102, 10, v101
    v_sub_u32 v102, v100, v102
    v_bfe_u32 v103, v101, 3, 1
    v_lshlrev_b32 v103, 2, v103
    v_xor_b32 v101, v101, v103
    v_mul_u32_u24 v101, 1280, v101
    v_lshl_add_u32 v234, v102, 4, v101
    v_add_u32 v234, s60, v234
    v_subrev_u32 v234, 2048, v234
    v_add_u32 v100, 192, v1
    v_mul_u32_u24 v101, 6554, v100
    v_lshrrev_b32 v101, 16, v101
    v_mul_u32_u24 v102, 10, v101
    v_sub_u32 v102, v100, v102
    v_bfe_u32 v103, v101, 3, 1
    v_lshlrev_b32 v103, 2, v103
    v_xor_b32 v101, v101, v103
    v_mul_u32_u24 v101, 1280, v101
    v_lshl_add_u32 v235, v102, 4, v101
    v_add_u32 v235, s60, v235
    v_subrev_u32 v235, 3072, v235
    v_add_u32 v100, 256, v1
    v_mul_u32_u24 v101, 6554, v100
    v_lshrrev_b32 v101, 16, v101
    v_mul_u32_u24 v102, 10, v101
    v_sub_u32 v102, v100, v102
    v_bfe_u32 v103, v101, 3, 1
    v_lshlrev_b32 v103, 2, v103
    v_xor_b32 v101, v101, v103
    v_mul_u32_u24 v101, 1280, v101
    v_lshl_add_u32 v236, v102, 4, v101
    v_add_u32 v236, s60, v236
    s_mul_i32 s0, s43, 5120
    s_and_b32 s45, s42, 3
    s_lshl_b32 s44, s41, 2
    s_add_u32 s45, s45, s44
    s_lshr_b32 s44, s42, 2
    s_lshl_b32 s46, s44, 8
    s_sub_u32 s47, s46, 256
    s_max_i32 s47, s47, 0
    s_cmp_lt_u32 s43, 2
    s_cselect_b32 s48, s47, s46
    s_mov_b32 s50, s48
    s_and_b32 s49, s43, 1
    s_lshl_b32 s49, s49, 7
    s_add_u32 s48, s48, s49
    s_lshl_b32 s48, s48, 3
    s_mul_i32 s49, s45, 81920
    s_add_u32 s48, s48, s49
    s_add_u32 s48, s48, 2621440
    v_lshlrev_b32 v2, 4, v1
    s_lshr_b32 s50, s50, 3
    s_mul_i32 s50, s50, 10240
    s_mul_i32 s49, s45, 320
    s_add_u32 s50, s50, s49
    s_add_u32 s50, s50, 5242880
    s_cmp_lt_u32 s40, 4
    s_cselect_b32 s48, s48, s50
    s_cselect_b64 s[96:97], -1, 0
    s_lshl_b32 s49, s43, 10
    s_add_u32 s49, s49, 102400
    s_mul_i32 s50, s43, 5120
    s_add_u32 s50, s50, 122880
    s_cmp_lt_u32 s40, 4
    s_cselect_b32 s50, s49, s50
    s_movk_i32 s56, 1024
    s_cselect_b32 s56, 4096, s56
    s_and_b32 s49, s43, 1
    s_mul_i32 s49, s49, 320
    v_add_u32 v3, 0, v1
    v_add_u32 v3, s49, v3
    v_mul_u32_u24 v4, 3277, v3
    v_lshrrev_b32 v4, 16, v4
    v_mul_u32_u24 v5, 20, v4
    v_sub_u32 v5, v3, v5
    v_mul_u32_u24 v4, 10240, v4
    v_lshl_add_u32 v4, v5, 4, v4
    v_add_u32 v5, 0, v2
    v_cndmask_b32 v6, v4, v5, s[96:97]
    v_add_u32 v3, 64, v1
    v_add_u32 v3, s49, v3
    v_mul_u32_u24 v4, 3277, v3
    v_lshrrev_b32 v4, 16, v4
    v_mul_u32_u24 v5, 20, v4
    v_sub_u32 v5, v3, v5
    v_mul_u32_u24 v4, 10240, v4
    v_lshl_add_u32 v4, v5, 4, v4
    v_add_u32 v5, 16384, v2
    v_cndmask_b32 v7, v4, v5, s[96:97]
    v_add_u32 v3, 128, v1
    v_add_u32 v3, s49, v3
    v_mul_u32_u24 v4, 3277, v3
    v_lshrrev_b32 v4, 16, v4
    v_mul_u32_u24 v5, 20, v4
    v_sub_u32 v5, v3, v5
    v_mul_u32_u24 v4, 10240, v4
    v_lshl_add_u32 v4, v5, 4, v4
    v_add_u32 v5, 32768, v2
    v_cndmask_b32 v8, v4, v5, s[96:97]
    v_add_u32 v3, 192, v1
    v_add_u32 v3, s49, v3
    v_mul_u32_u24 v4, 3277, v3
    v_lshrrev_b32 v4, 16, v4
    v_mul_u32_u24 v5, 20, v4
    v_sub_u32 v5, v3, v5
    v_mul_u32_u24 v4, 10240, v4
    v_lshl_add_u32 v4, v5, 4, v4
    v_add_u32 v5, 49152, v2
    v_cndmask_b32 v9, v4, v5, s[96:97]
    v_add_u32 v3, 256, v1
    v_add_u32 v3, s49, v3
    v_mul_u32_u24 v4, 3277, v3
    v_lshrrev_b32 v4, 16, v4
    v_mul_u32_u24 v5, 20, v4
    v_sub_u32 v5, v3, v5
    v_mul_u32_u24 v4, 10240, v4
    v_lshl_add_u32 v4, v5, 4, v4
    v_add_u32 v5, 65536, v2
    v_cndmask_b32 v10, v4, v5, s[96:97]
    v_and_b32 v12, 31, v1
    v_lshrrev_b32 v13, 5, v1
    v_lshlrev_b32 v14, 3, v12
    v_lshl_add_u32 v15, v13, 15, v14
    s_lshl_b32 s51, s40, 5
    s_add_u32 s51, s51, s46
    s_lshl_b32 s52, s51, 3
    s_mul_i32 s49, s45, 81920
    s_add_u32 s52, s52, s49
    s_add_u32 s52, s52, 0
    s_add_u32 s53, s52, 16384
    s_add_u32 s54, s52, 65536
    v_lshlrev_b32 v3, 2, v13
    v_add_u32 v4, 0, v3
    v_cmp_le_u32 s[64:65], v4, v12
    v_add_u32 v4, 1, v3
    v_cmp_le_u32 s[66:67], v4, v12
    v_add_u32 v4, 2, v3
    v_cmp_le_u32 s[68:69], v4, v12
    v_add_u32 v4, 3, v3
    v_cmp_le_u32 s[70:71], v4, v12
    v_add_u32 v4, 8, v3
    v_cmp_le_u32 s[72:73], v4, v12
    v_add_u32 v4, 9, v3
    v_cmp_le_u32 s[74:75], v4, v12
    v_add_u32 v4, 10, v3
    v_cmp_le_u32 s[76:77], v4, v12
    v_add_u32 v4, 11, v3
    v_cmp_le_u32 s[78:79], v4, v12
    v_add_u32 v4, 16, v3
    v_cmp_le_u32 s[80:81], v4, v12
    v_add_u32 v4, 17, v3
    v_cmp_le_u32 s[82:83], v4, v12
    v_add_u32 v4, 18, v3
    v_cmp_le_u32 s[84:85], v4, v12
    v_add_u32 v4, 19, v3
    v_cmp_le_u32 s[86:87], v4, v12
    v_add_u32 v4, 24, v3
    v_cmp_le_u32 s[88:89], v4, v12
    v_add_u32 v4, 25, v3
    v_cmp_le_u32 s[90:91], v4, v12
    v_add_u32 v4, 26, v3
    v_cmp_le_u32 s[92:93], v4, v12
    v_add_u32 v4, 27, v3
    v_cmp_le_u32 s[94:95], v4, v12
    v_mov_b32 v5, 0xffff
    v_mov_b32 v11, 0xffff0000
    v_cndmask_b32 v3, 0, v5, s[64:65]
    v_cndmask_b32 v4, 0, v11, s[66:67]
    v_or_b32 v24, v3, v4
    v_cndmask_b32 v3, 0, v5, s[68:69]
    v_cndmask_b32 v4, 0, v11, s[70:71]
    v_or_b32 v25, v3, v4
    v_cndmask_b32 v3, 0, v5, s[72:73]
    v_cndmask_b32 v4, 0, v11, s[74:75]
    v_or_b32 v26, v3, v4
    v_cndmask_b32 v3, 0, v5, s[76:77]
    v_cndmask_b32 v4, 0, v11, s[78:79]
    v_or_b32 v27, v3, v4
    v_cndmask_b32 v3, 0, v5, s[80:81]
    v_cndmask_b32 v4, 0, v11, s[82:83]
    v_or_b32 v28, v3, v4
    v_cndmask_b32 v3, 0, v5, s[84:85]
    v_cndmask_b32 v4, 0, v11, s[86:87]
    v_or_b32 v29, v3, v4
    v_cndmask_b32 v3, 0, v5, s[88:89]
    v_cndmask_b32 v4, 0, v11, s[90:91]
    v_or_b32 v30, v3, v4
    v_cndmask_b32 v3, 0, v5, s[92:93]
    v_cndmask_b32 v4, 0, v11, s[94:95]
    v_or_b32 v31, v3, v4
    v_cmp_eq_u32 s[96:97], 1, v13
    v_cmp_gt_u32 s[98:99], 20, v12
    v_cmp_eq_u32 s[100:101], 0, v13
    s_lshl_b32 s49, s40, 8
    s_add_u32 s49, s49, 102400
    v_lshl_add_u32 v16, v13, 13, v14
    v_add_u32 v16, s49, v16
    v_add_u32 v17, s49, v14
    s_and_b32 s55, s45, 1
    v_bfe_u32 v3, v12, 3, 1
    v_bfe_u32 v4, v12, 2, 1
    v_and_b32 v5, 3, v12
    v_lshl_add_u32 v18, v3, 2, v5
    v_lshl_add_u32 v18, v4, 3, v18
    s_lshl_b32 s49, s55, 2
    v_add_u32 v18, s49, v18
    s_lshl_b32 s49, s55, 4
    s_sub_u32 s49, 16, s49
    v_add_u32 v19, s49, v5
    v_cmp_gt_u32 vcc, 16, v12
    s_nop 1
    v_cndmask_b32 v18, v19, v18, vcc
    v_mul_u32_u24 v19, 320, v13
    v_lshl_add_u32 v18, v18, 4, v19
    s_mul_i32 s49, s40, 1280
    s_add_u32 s49, s49, 122880
    v_add_u32 v18, s49, v18
    v_mov_b32 v19, 0
    v_mov_b32 v4, 0x3f803f80
    v_cmp_eq_u32 vcc, 20, v12
    s_nop 1
    v_cndmask_b32 v19, v19, v4, vcc
    v_cmp_eq_u32 vcc, 24, v12
    s_nop 1
    v_cndmask_b32 v19, v19, v4, vcc
    v_mov_b32 v54, 0
    v_mov_b32 v55, 0
    v_mov_b32 v62, 0
    v_mov_b32 v63, 0
    v_mov_b32 v70, 0
    v_mov_b32 v71, 0
    v_mov_b32 v46, 0
    v_mov_b32 v47, 0
    v_cndmask_b32 v36, v4, 0, s[96:97]
    v_mov_b32 v37, 0
    v_mov_b32 v33, 0
    v_mov_b32 v38, 0
    v_mov_b32 v34, 0
    v_mov_b32 v39, 0
    v_mov_b32 v35, 0
    v_and_b32 v3, 15, v1
    s_mul_i32 s49, s45, 20
    s_mov_b64 s[46:47], 0
    s_add_u32 s60, s49, 0
    s_lshr_b32 s60, s60, 7
    v_cmp_eq_u32 vcc, s60, v3
    s_nop 0
    s_and_b64 vcc, vcc, s[96:97]
    s_or_b64 s[46:47], s[46:47], vcc
    s_add_u32 s60, s49, 19
    s_lshr_b32 s60, s60, 7
    v_cmp_eq_u32 vcc, s60, v3
    s_nop 0
    s_and_b64 vcc, vcc, s[96:97]
    s_or_b64 s[46:47], s[46:47], vcc
    s_add_u32 s60, s49, 640
    s_lshr_b32 s60, s60, 7
    v_cmp_eq_u32 vcc, s60, v3
    s_nop 0
    s_or_b64 s[46:47], s[46:47], vcc
    s_add_u32 s60, s49, 659
    s_lshr_b32 s60, s60, 7
    v_cmp_eq_u32 vcc, s60, v3
    s_nop 0
    s_or_b64 s[46:47], s[46:47], vcc
    s_add_u32 s60, s49, 1280
    s_lshr_b32 s60, s60, 7
    v_cmp_eq_u32 vcc, s60, v3
    s_nop 0
    s_or_b64 s[46:47], s[46:47], vcc
    s_add_u32 s60, s49, 1299
    s_lshr_b32 s60, s60, 7
    v_cmp_eq_u32 vcc, s60, v3
    s_nop 0
    s_or_b64 s[46:47], s[46:47], vcc
    s_cmp_eq_u32 s44, 0
    s_cselect_b32 s46, 0, s46
    s_lshl_b32 s49, s44, 7
    s_lshl_b32 s60, s41, 10
    s_add_u32 s49, s49, s60
    s_add_u32 s49, s49, 19431296
    v_lshlrev_b32 v3, 2, v1
L_P1E_116:
    v_mov_b32 v122, 162816
    ds_read_b32 v122, v122
    s_waitcnt lgkmcnt(0)
    v_readfirstlane_b32 s3, v122
    s_barrier
    v_mov_b32 v239, 162824
    s_mov_b32 s61, 2000
CW_117:
    ds_read_b32 v238, v239
    s_waitcnt lgkmcnt(0)
    v_readfirstlane_b32 s60, v238
    s_nop 0
    s_cmp_ge_u32 s60, 1
    s_nop 1
    s_cbranch_scc1 CD_118
    s_sub_u32 s61, s61, 1
    s_cmp_eq_u32 s61, 0
    s_cbranch_scc1 CD_118
    s_sleep 2
    s_branch CW_117
CD_118:
    s_add_u32 m0, s0, 0
    s_add_u32 s1, s36, 0
    s_sub_u32 s38, s1, 5
    s_cmp_ge_u32 s1, 5
    s_cselect_b32 s1, s38, s1
    s_mul_i32 s1, s1, 40960
    buffer_load_dwordx4 v232, s[12:15], s1 offen offset:0 lds
    buffer_load_dwordx4 v233, s[12:15], s1 offen offset:1024 lds
    buffer_load_dwordx4 v234, s[12:15], s1 offen offset:2048 lds
    buffer_load_dwordx4 v235, s[12:15], s1 offen offset:3072 lds
    s_add_u32 m0, s0, 4096
    s_nop 0
    buffer_load_dwordx4 v236, s[12:15], s1 offen lds
    s_add_u32 m0, s0, 20480
    s_add_u32 s1, s36, 1
    s_sub_u32 s38, s1, 5
    s_cmp_ge_u32 s1, 5
    s_cselect_b32 s1, s38, s1
    s_mul_i32 s1, s1, 40960
    buffer_load_dwordx4 v232, s[12:15], s1 offen offset:0 lds
    buffer_load_dwordx4 v233, s[12:15], s1 offen offset:1024 lds
    buffer_load_dwordx4 v234, s[12:15], s1 offen offset:2048 lds
    buffer_load_dwordx4 v235, s[12:15], s1 offen offset:3072 lds
    s_add_u32 m0, s0, 24576
    s_nop 0
    buffer_load_dwordx4 v236, s[12:15], s1 offen lds
    s_add_u32 m0, s0, 40960
    s_add_u32 s1, s36, 2
    s_sub_u32 s38, s1, 5
    s_cmp_ge_u32 s1, 5
    s_cselect_b32 s1, s38, s1
    s_mul_i32 s1, s1, 40960
    buffer_load_dwordx4 v232, s[12:15], s1 offen offset:0 lds
    buffer_load_dwordx4 v233, s[12:15], s1 offen offset:1024 lds
    buffer_load_dwordx4 v234, s[12:15], s1 offen offset:2048 lds
    buffer_load_dwordx4 v235, s[12:15], s1 offen offset:3072 lds
    s_add_u32 m0, s0, 45056
    s_nop 0
    buffer_load_dwordx4 v236, s[12:15], s1 offen lds
    s_add_u32 m0, s0, 61440
    s_add_u32 s1, s36, 3
    s_sub_u32 s38, s1, 5
    s_cmp_ge_u32 s1, 5
    s_cselect_b32 s1, s38, s1
    s_mul_i32 s1, s1, 40960
    buffer_load_dwordx4 v232, s[12:15], s1 offen offset:0 lds
    buffer_load_dwordx4 v233, s[12:15], s1 offen offset:1024 lds
    buffer_load_dwordx4 v234, s[12:15], s1 offen offset:2048 lds
    buffer_load_dwordx4 v235, s[12:15], s1 offen offset:3072 lds
    s_add_u32 m0, s0, 65536
    s_nop 0
    buffer_load_dwordx4 v236, s[12:15], s1 offen lds
P2_2:
    s_cmp_lg_u32 s40, 0
    s_cbranch_scc1 PDONE_120
POLL_119:
    buffer_load_dword v4, v3, s[32:35], s49 offen sc1
    s_waitcnt vmcnt(0)
    v_cmp_ne_u32 vcc, s3, v4
    s_nop 0
    s_and_b64 vcc, vcc, s[46:47]
    s_nop 1
    s_cbranch_scc0 PDONE_120
    s_cmp_eq_u32 s57, 0
    s_cbranch_scc1 PDONE_120
    s_sub_u32 s57, s57, 1
    s_sleep 1
    s_branch POLL_119
PDONE_120:
    s_barrier
    s_cmp_lt_u32 s40, 4
    s_cbranch_scc1 OUT_121
OBK_122:
    buffer_load_dwordx2 v[40:41], v15, s[32:35], s52 offen sc1
    buffer_load_dwordx2 v[42:43], v15, s[32:35], s53 offen sc1
    buffer_load_dwordx2 v[44:45], v14, s[32:35], s54 offen sc1
    s_waitcnt vmcnt(0)
    s_cmp_ge_u32 s40, 4
    s_cbranch_scc1 OUT_123
OBK_124:
    v_cndmask_b32 v44, v44, 0, s[96:97]
    v_cndmask_b32 v45, v45, 0, s[96:97]
    s_barrier
    ds_read_b64 v[48:49], v16 offset:0
    ds_read_b64 v[50:51], v16 offset:4096
    ds_read_b64 v[52:53], v17 offset:16384
    ds_read_b64 v[56:57], v16 offset:256
    ds_read_b64 v[58:59], v16 offset:4352
    ds_read_b64 v[60:61], v17 offset:16640
    s_waitcnt lgkmcnt(3)
    v_mfma_f32_32x32x16_bf16 v[88:103], v[48:51], v[40:43], 0
    ds_read_b64 v[64:65], v16 offset:512
    ds_read_b64 v[66:67], v16 offset:4608
    ds_read_b64 v[68:69], v17 offset:16896
    v_mfma_f32_32x32x16_bf16 v[88:103], v[52:55], v[44:47], v[88:103]
    v_mov_b32 v244, -1
    v_mov_b32 v245, -1
    v_mov_b32 v246, -1
    v_mov_b32 v247, -1
    s_and_b32 s56, s41, 1
    s_lshl_b32 s56, s56, 3
    s_and_b32 s60, s42, 7
    s_add_u32 s60, s60, s56
    s_lshr_b32 s56, s41, 1
    s_lshl_b32 s56, s56, 2
    s_lshr_b32 s61, s42, 3
    s_add_u32 s61, s61, s56
    s_mul_i32 s61, s61, 12
    s_lshl_b32 s61, s61, 15
    s_lshl_b32 s60, s60, 11
    s_add_u32 s56, s61, s60
    s_add_u32 s56, s56, 13107200
    s_waitcnt lgkmcnt(3)
    v_mfma_f32_32x32x16_bf16 v[104:119], v[56:59], v[40:43], 0
    ds_read_b64 v[48:49], v16 offset:768
    ds_read_b64 v[50:51], v16 offset:4864
    ds_read_b64 v[52:53], v17 offset:17152
    v_mfma_f32_32x32x16_bf16 v[104:119], v[60:63], v[44:47], v[104:119]
    s_mul_i32 s60, s40, 3
    s_add_u32 s60, s60, 0
    s_and_b32 s61, s60, 1
    s_lshl_b32 s61, s61, 10
    s_lshr_b32 s60, s60, 1
    s_lshl_b32 s60, s60, 15
    s_add_u32 s60, s60, s61
    s_add_u32 s60, s60, s56
    buffer_store_dwordx4 v[244:247], v2, s[32:35], s60 offen sc1
    s_waitcnt lgkmcnt(3)
    v_mfma_f32_32x32x16_bf16 v[120:135], v[64:67], v[40:43], 0
    ds_read_b64 v[56:57], v16 offset:1024
    ds_read_b64 v[58:59], v16 offset:5120
    ds_read_b64 v[60:61], v17 offset:17408
    v_mfma_f32_32x32x16_bf16 v[120:135], v[68:71], v[44:47], v[120:135]
    s_mul_i32 s60, s40, 3
    s_add_u32 s60, s60, 1
    s_and_b32 s61, s60, 1
    s_lshl_b32 s61, s61, 10
    s_lshr_b32 s60, s60, 1
    s_lshl_b32 s60, s60, 15
    s_add_u32 s60, s60, s61
    s_add_u32 s60, s60, s56
    buffer_store_dwordx4 v[244:247], v2, s[32:35], s60 offen sc1
    s_waitcnt lgkmcnt(3)
    v_mfma_f32_32x32x16_bf16 v[136:151], v[48:51], v[40:43], 0
    ds_read_b64 v[64:65], v16 offset:1280
    ds_read_b64 v[66:67], v16 offset:5376
    ds_read_b64 v[68:69], v17 offset:17664
    v_mfma_f32_32x32x16_bf16 v[136:151], v[52:55], v[44:47], v[136:151]
    s_mul_i32 s60, s40, 3
    s_add_u32 s60, s60, 2
    s_and_b32 s61, s60, 1
    s_lshl_b32 s61, s61, 10
    s_lshr_b32 s60, s60, 1
    s_lshl_b32 s60, s60, 15
    s_add_u32 s60, s60, s61
    s_add_u32 s60, s60, s56
    buffer_store_dwordx4 v[244:247], v2, s[32:35], s60 offen sc1
    s_waitcnt lgkmcnt(3)
    v_mfma_f32_32x32x16_bf16 v[152:167], v[56:59], v[40:43], 0
    ds_read_b64 v[48:49], v16 offset:1536
    ds_read_b64 v[50:51], v16 offset:5632
    ds_read_b64 v[52:53], v17 offset:17920
    v_mfma_f32_32x32x16_bf16 v[152:167], v[60:63], v[44:47], v[152:167]
    s_cmp_lt_u32 s40, 4
    s_cbranch_scc1 OUT_125
OBK_126:
    s_waitcnt lgkmcnt(3)
    v_mfma_f32_32x32x16_bf16 v[168:183], v[64:67], v[40:43], 0
    ds_read_b64 v[56:57], v16 offset:1792
    ds_read_b64 v[58:59], v16 offset:5888
    ds_read_b64 v[60:61], v17 offset:18176
    v_mfma_f32_32x32x16_bf16 v[168:183], v[68:71], v[44:47], v[168:183]
    s_waitcnt lgkmcnt(3)
    v_mfma_f32_32x32x16_bf16 v[184:199], v[48:51], v[40:43], 0
    ds_read_b64 v[64:65], v16 offset:2048
    ds_read_b64 v[66:67], v16 offset:6144
    ds_read_b64 v[68:69], v17 offset:18432
    v_mfma_f32_32x32x16_bf16 v[184:199], v[52:55], v[44:47], v[184:199]
    s_waitcnt lgkmcnt(3)
    v_mfma_f32_32x32x16_bf16 v[200:215], v[56:59], v[40:43], 0
    v_mfma_f32_32x32x16_bf16 v[200:215], v[60:63], v[44:47], v[200:215]
    s_waitcnt lgkmcnt(0)
    v_mfma_f32_32x32x16_bf16 v[216:231], v[64:67], v[40:43], 0
    v_mfma_f32_32x32x16_bf16 v[216:231], v[68:71], v[44:47], v[216:231]
    s_cmp_ge_u32 s40, 4
    s_cbranch_scc1 OUT_127
OBK_128:
    s_cmp_lg_u32 s44, 0
    s_nop 7
    s_cbranch_scc1 P2_FIX_129
    s_cmp_ge_u32 s40, 8
    s_cbranch_scc1 P2_FIX_129
    v_mov_b32 v88, 0xf149f2ca
    v_mov_b32 v89, 0xf149f2ca
    v_mov_b32 v90, 0xf149f2ca
    v_mov_b32 v91, 0xf149f2ca
    v_mov_b32 v92, 0xf149f2ca
    v_mov_b32 v93, 0xf149f2ca
    v_mov_b32 v94, 0xf149f2ca
    v_mov_b32 v95, 0xf149f2ca
    v_mov_b32 v96, 0xf149f2ca
    v_mov_b32 v97, 0xf149f2ca
    v_mov_b32 v98, 0xf149f2ca
    v_mov_b32 v99, 0xf149f2ca
    v_mov_b32 v100, 0xf149f2ca
    v_mov_b32 v101, 0xf149f2ca
    v_mov_b32 v102, 0xf149f2ca
    v_mov_b32 v103, 0xf149f2ca
    s_cmp_ge_u32 s40, 7
    s_nop 0
    s_cbranch_scc1 P2_FIX_129
    v_mov_b32 v104, 0xf149f2ca
    v_mov_b32 v105, 0xf149f2ca
    v_mov_b32 v106, 0xf149f2ca
    v_mov_b32 v107, 0xf149f2ca
    v_mov_b32 v108, 0xf149f2ca
    v_mov_b32 v109, 0xf149f2ca
    v_mov_b32 v110, 0xf149f2ca
    v_mov_b32 v111, 0xf149f2ca
    v_mov_b32 v112, 0xf149f2ca
    v_mov_b32 v113, 0xf149f2ca
    v_mov_b32 v114, 0xf149f2ca
    v_mov_b32 v115, 0xf149f2ca
    v_mov_b32 v116, 0xf149f2ca
    v_mov_b32 v117, 0xf149f2ca
    v_mov_b32 v118, 0xf149f2ca
    v_mov_b32 v119, 0xf149f2ca
    s_cmp_ge_u32 s40, 6
    s_nop 0
    s_cbranch_scc1 P2_FIX_129
    v_mov_b32 v120, 0xf149f2ca
    v_mov_b32 v121, 0xf149f2ca
    v_mov_b32 v122, 0xf149f2ca
    v_mov_b32 v123, 0xf149f2ca
    v_mov_b32 v124, 0xf149f2ca
    v_mov_b32 v125, 0xf149f2ca
    v_mov_b32 v126, 0xf149f2ca
    v_mov_b32 v127, 0xf149f2ca
    v_mov_b32 v128, 0xf149f2ca
    v_mov_b32 v129, 0xf149f2ca
    v_mov_b32 v130, 0xf149f2ca
    v_mov_b32 v131, 0xf149f2ca
    v_mov_b32 v132, 0xf149f2ca
    v_mov_b32 v133, 0xf149f2ca
    v_mov_b32 v134, 0xf149f2ca
    v_mov_b32 v135, 0xf149f2ca
    s_cmp_ge_u32 s40, 5
    s_nop 0
    s_cbranch_scc1 P2_FIX_129
    v_mov_b32 v136, 0xf149f2ca
    v_mov_b32 v137, 0xf149f2ca
    v_mov_b32 v138, 0xf149f2ca
    v_mov_b32 v139, 0xf149f2ca
    v_mov_b32 v140, 0xf149f2ca
    v_mov_b32 v141, 0xf149f2ca
    v_mov_b32 v142, 0xf149f2ca
    v_mov_b32 v143, 0xf149f2ca
    v_mov_b32 v144, 0xf149f2ca
    v_mov_b32 v145, 0xf149f2ca
    v_mov_b32 v146, 0xf149f2ca
    v_mov_b32 v147, 0xf149f2ca
    v_mov_b32 v148, 0xf149f2ca
    v_mov_b32 v149, 0xf149f2ca
    v_mov_b32 v150, 0xf149f2ca
    v_mov_b32 v151, 0xf149f2ca
    s_cmp_ge_u32 s40, 4
    s_nop 0
    s_cbranch_scc1 P2_FIX_129
    v_mov_b32 v152, 0xf149f2ca
    v_mov_b32 v153, 0xf149f2ca
    v_mov_b32 v154, 0xf149f2ca
    v_mov_b32 v155, 0xf149f2ca
    v_mov_b32 v156, 0xf149f2ca
    v_mov_b32 v157, 0xf149f2ca
    v_mov_b32 v158, 0xf149f2ca
    v_mov_b32 v159, 0xf149f2ca
    v_mov_b32 v160, 0xf149f2ca
    v_mov_b32 v161, 0xf149f2ca
    v_mov_b32 v162, 0xf149f2ca
    v_mov_b32 v163, 0xf149f2ca
    v_mov_b32 v164, 0xf149f2ca
    v_mov_b32 v165, 0xf149f2ca
    v_mov_b32 v166, 0xf149f2ca
    v_mov_b32 v167, 0xf149f2ca
    s_cmp_ge_u32 s40, 3
    s_nop 0
    s_cbranch_scc1 P2_FIX_129
    v_mov_b32 v168, 0xf149f2ca
    v_mov_b32 v169, 0xf149f2ca
    v_mov_b32 v170, 0xf149f2ca
    v_mov_b32 v171, 0xf149f2ca
    v_mov_b32 v172, 0xf149f2ca
    v_mov_b32 v173, 0xf149f2ca
    v_mov_b32 v174, 0xf149f2ca
    v_mov_b32 v175, 0xf149f2ca
    v_mov_b32 v176, 0xf149f2ca
    v_mov_b32 v177, 0xf149f2ca
    v_mov_b32 v178, 0xf149f2ca
    v_mov_b32 v179, 0xf149f2ca
    v_mov_b32 v180, 0xf149f2ca
    v_mov_b32 v181, 0xf149f2ca
    v_mov_b32 v182, 0xf149f2ca
    v_mov_b32 v183, 0xf149f2ca
    s_cmp_ge_u32 s40, 2
    s_nop 0
    s_cbranch_scc1 P2_FIX_129
    v_mov_b32 v184, 0xf149f2ca
    v_mov_b32 v185, 0xf149f2ca
    v_mov_b32 v186, 0xf149f2ca
    v_mov_b32 v187, 0xf149f2ca
    v_mov_b32 v188, 0xf149f2ca
    v_mov_b32 v189, 0xf149f2ca
    v_mov_b32 v190, 0xf149f2ca
    v_mov_b32 v191, 0xf149f2ca
    v_mov_b32 v192, 0xf149f2ca
    v_mov_b32 v193, 0xf149f2ca
    v_mov_b32 v194, 0xf149f2ca
    v_mov_b32 v195, 0xf149f2ca
    v_mov_b32 v196, 0xf149f2ca
    v_mov_b32 v197, 0xf149f2ca
    v_mov_b32 v198, 0xf149f2ca
    v_mov_b32 v199, 0xf149f2ca
    s_cmp_ge_u32 s40, 1
    s_nop 0
    s_cbranch_scc1 P2_FIX_129
    v_mov_b32 v200, 0xf149f2ca
    v_mov_b32 v201, 0xf149f2ca
    v_mov_b32 v202, 0xf149f2ca
    v_mov_b32 v203, 0xf149f2ca
    v_mov_b32 v204, 0xf149f2ca
    v_mov_b32 v205, 0xf149f2ca
    v_mov_b32 v206, 0xf149f2ca
    v_mov_b32 v207, 0xf149f2ca
    v_mov_b32 v208, 0xf149f2ca
    v_mov_b32 v209, 0xf149f2ca
    v_mov_b32 v210, 0xf149f2ca
    v_mov_b32 v211, 0xf149f2ca
    v_mov_b32 v212, 0xf149f2ca
    v_mov_b32 v213, 0xf149f2ca
    v_mov_b32 v214, 0xf149f2ca
    v_mov_b32 v215, 0xf149f2ca
P2_FIX_129:
    v_mov_b32 v48, v19
    v_mov_b32 v49, v19
    v_mov_b32 v50, v19
    v_mov_b32 v51, v19
    v_mov_b32 v52, v19
    v_mov_b32 v53, v19
    v_mov_b32 v54, v19
    v_mov_b32 v55, v19
    v_mov_b32 v56, v19
    v_mov_b32 v57, v19
    v_mov_b32 v58, v19
    v_mov_b32 v59, v19
    v_mov_b32 v60, v19
    v_mov_b32 v61, v19
    v_mov_b32 v62, v19
    v_mov_b32 v63, v19
    v_lshlrev_b32 v237, 4, v1
    s_lshl_b32 s60, s41, 10
    v_add_u32 v237, s60, v237
    s_mov_b32 s60, 19431424
    buffer_load_dwordx4 v[240:243], v237, s[32:35], s60 offen sc1
    v_cndmask_b32 v88, v88, v216, s[64:65]
    v_cndmask_b32 v89, v89, v217, s[66:67]
    v_cndmask_b32 v90, v90, v218, s[68:69]
    v_cndmask_b32 v91, v91, v219, s[70:71]
    v_cndmask_b32 v92, v92, v220, s[72:73]
    v_cndmask_b32 v93, v93, v221, s[74:75]
    v_cndmask_b32 v94, v94, v222, s[76:77]
    v_cndmask_b32 v95, v95, v223, s[78:79]
    v_cndmask_b32 v96, v96, v224, s[80:81]
    v_cndmask_b32 v97, v97, v225, s[82:83]
    v_cndmask_b32 v98, v98, v226, s[84:85]
    v_cndmask_b32 v99, v99, v227, s[86:87]
    v_cndmask_b32 v100, v100, v228, s[88:89]
    v_cndmask_b32 v101, v101, v229, s[90:91]
    v_cndmask_b32 v102, v102, v230, s[92:93]
    v_cndmask_b32 v103, v103, v231, s[94:95]
    v_max3_f32 v20, v104, v105, v106
    v_max3_f32 v21, v107, v108, v109
    v_max3_f32 v20, v20, v110, v111
    v_max3_f32 v21, v21, v112, v113
    v_max3_f32 v20, v20, v114, v115
    v_max3_f32 v21, v21, v116, v117
    v_max3_f32 v20, v20, v118, v119
    v_max3_f32 v21, v21, v120, v121
    v_max3_f32 v20, v20, v122, v123
    v_max3_f32 v21, v21, v124, v125
    v_max3_f32 v20, v20, v126, v127
    v_max3_f32 v21, v21, v128, v129
    v_max3_f32 v20, v20, v130, v131
    v_max3_f32 v21, v21, v132, v133
    v_max3_f32 v20, v20, v134, v135
    v_max3_f32 v21, v21, v136, v137
    v_max3_f32 v20, v20, v138, v139
    v_max3_f32 v21, v21, v140, v141
    v_max3_f32 v20, v20, v142, v143
    v_max3_f32 v21, v21, v144, v145
    v_max3_f32 v20, v20, v146, v147
    v_max3_f32 v21, v21, v148, v149
    v_max3_f32 v20, v20, v150, v151
    v_max3_f32 v21, v21, v152, v153
    v_max3_f32 v20, v20, v154, v155
    v_max3_f32 v21, v21, v156, v157
    v_max3_f32 v20, v20, v158, v159
    v_max3_f32 v21, v21, v160, v161
    v_max3_f32 v20, v20, v162, v163
    v_max3_f32 v21, v21, v164, v165
    v_max3_f32 v20, v20, v166, v167
    v_max3_f32 v21, v21, v168, v169
    v_max3_f32 v20, v20, v170, v171
    v_max3_f32 v21, v21, v172, v173
    v_max3_f32 v20, v20, v174, v175
    v_max3_f32 v21, v21, v176, v177
    v_max3_f32 v20, v20, v178, v179
    v_max3_f32 v21, v21, v180, v181
    v_max3_f32 v20, v20, v182, v183
    v_max3_f32 v21, v21, v184, v185
    v_max3_f32 v20, v20, v186, v187
    v_max3_f32 v21, v21, v188, v189
    v_max3_f32 v20, v20, v190, v191
    v_max3_f32 v21, v21, v192, v193
    v_max3_f32 v20, v20, v194, v195
    v_max3_f32 v21, v21, v196, v197
    v_max3_f32 v20, v20, v198, v199
    v_max3_f32 v21, v21, v200, v201
    v_max3_f32 v20, v20, v202, v203
    v_max3_f32 v21, v21, v204, v205
    v_max3_f32 v20, v20, v206, v207
    v_max3_f32 v21, v21, v208, v209
    v_max3_f32 v20, v20, v210, v211
    v_max3_f32 v21, v21, v212, v213
    v_max3_f32 v20, v20, v214, v215
    v_max3_f32 v21, v21, v88, v89
    v_max3_f32 v20, v20, v90, v91
    v_max3_f32 v21, v21, v92, v93
    v_max3_f32 v20, v20, v94, v95
    v_max3_f32 v21, v21, v96, v97
    v_max3_f32 v20, v20, v98, v99
    v_max3_f32 v21, v21, v100, v101
    v_max3_f32 v20, v20, v102, v103
    v_max_f32 v20, v20, v21
    v_mov_b32 v21, v20
    s_nop 1
    v_permlane32_swap_b32 v20, v21
    v_max_f32 v20, v20, v21
    v_sub_f32 v20, 0, v20
    v_cvt_pk_bf16_f32 v21, v20, v20
    v_lshlrev_b32 v21, 16, v21
    v_sub_f32 v21, v20, v21
    v_cvt_pk_bf16_f32 v32, v20, v21
    v_cndmask_b32 v32, v32, 0, s[96:97]
    s_cmp_lt_u32 s40, 4
    s_cbranch_scc1 OUT_130
OBK_131:
    v_mfma_f32_32x32x16_bf16 v[104:119], v[36:39], v[32:35], v[104:119]
    v_mfma_f32_32x32x16_bf16 v[120:135], v[36:39], v[32:35], v[120:135]
    s_mov_b64 exec, s[98:99]
    ds_read_b128 v[48:51], v18 offset:1280
    ds_read_b128 v[52:55], v18 offset:1920
    s_mov_b64 exec, -1
    s_mov_b64 exec, s[98:99]
    ds_read_b128 v[56:59], v18 offset:2560
    ds_read_b128 v[60:63], v18 offset:3200
    s_mov_b64 exec, -1
    s_nop 2
    v_exp_f32 v104, v104
    v_exp_f32 v105, v105
    v_exp_f32 v106, v106
    v_exp_f32 v107, v107
    v_exp_f32 v108, v108
    v_exp_f32 v109, v109
    v_exp_f32 v110, v110
    v_exp_f32 v111, v111
    v_exp_f32 v112, v112
    v_exp_f32 v113, v113
    v_exp_f32 v114, v114
    v_exp_f32 v115, v115
    v_mfma_f32_32x32x16_bf16 v[136:151], v[36:39], v[32:35], v[136:151]
    v_exp_f32 v116, v116
    v_exp_f32 v117, v117
    v_exp_f32 v118, v118
    v_exp_f32 v119, v119
    v_cvt_pk_bf16_f32 v104, v104, v105
    v_cvt_pk_bf16_f32 v105, v106, v107
    v_cvt_pk_bf16_f32 v106, v108, v109
    v_cvt_pk_bf16_f32 v107, v110, v111
    v_cvt_pk_bf16_f32 v108, v112, v113
    v_cvt_pk_bf16_f32 v109, v114, v115
    v_cvt_pk_bf16_f32 v110, v116, v117
    v_cvt_pk_bf16_f32 v111, v118, v119
    s_waitcnt lgkmcnt(3)
    v_mfma_f32_32x32x16_bf16 v[72:87], v[48:51], v[104:107], 0
    v_exp_f32 v120, v120
    v_exp_f32 v121, v121
    v_exp_f32 v122, v122
    v_exp_f32 v123, v123
    v_exp_f32 v124, v124
    v_exp_f32 v125, v125
    s_waitcnt lgkmcnt(2)
    v_mfma_f32_32x32x16_bf16 v[72:87], v[52:55], v[108:111], v[72:87]
    v_exp_f32 v126, v126
    v_exp_f32 v127, v127
    v_exp_f32 v128, v128
    v_exp_f32 v129, v129
    v_exp_f32 v130, v130
    v_exp_f32 v131, v131
    s_mov_b64 exec, s[98:99]
    ds_read_b128 v[48:51], v18 offset:3840
    ds_read_b128 v[52:55], v18 offset:4480
    s_mov_b64 exec, -1
    v_exp_f32 v132, v132
    v_exp_f32 v133, v133
    v_exp_f32 v134, v134
    v_exp_f32 v135, v135
    v_cvt_pk_bf16_f32 v120, v120, v121
    v_cvt_pk_bf16_f32 v121, v122, v123
    v_mfma_f32_32x32x16_bf16 v[152:167], v[36:39], v[32:35], v[152:167]
    v_cvt_pk_bf16_f32 v122, v124, v125
    v_cvt_pk_bf16_f32 v123, v126, v127
    v_cvt_pk_bf16_f32 v124, v128, v129
    v_cvt_pk_bf16_f32 v125, v130, v131
    v_cvt_pk_bf16_f32 v126, v132, v133
    v_cvt_pk_bf16_f32 v127, v134, v135
    s_waitcnt lgkmcnt(3)
    v_mfma_f32_32x32x16_bf16 v[72:87], v[56:59], v[120:123], v[72:87]
    v_exp_f32 v136, v136
    v_exp_f32 v137, v137
    v_exp_f32 v138, v138
    v_exp_f32 v139, v139
    v_exp_f32 v140, v140
    v_exp_f32 v141, v141
    s_waitcnt lgkmcnt(2)
    v_mfma_f32_32x32x16_bf16 v[72:87], v[60:63], v[124:127], v[72:87]
    v_exp_f32 v142, v142
    v_exp_f32 v143, v143
    v_exp_f32 v144, v144
    v_exp_f32 v145, v145
    v_exp_f32 v146, v146
    v_exp_f32 v147, v147
    s_mov_b64 exec, s[98:99]
    ds_read_b128 v[56:59], v18 offset:5120
    ds_read_b128 v[60:63], v18 offset:5760
    s_mov_b64 exec, -1
    v_exp_f32 v148, v148
    v_exp_f32 v149, v149
    v_exp_f32 v150, v150
    v_exp_f32 v151, v151
    v_cvt_pk_bf16_f32 v136, v136, v137
    v_cvt_pk_bf16_f32 v137, v138, v139
    v_mfma_f32_32x32x16_bf16 v[168:183], v[36:39], v[32:35], v[168:183]
    v_cvt_pk_bf16_f32 v138, v140, v141
    v_cvt_pk_bf16_f32 v139, v142, v143
    v_cvt_pk_bf16_f32 v140, v144, v145
    v_cvt_pk_bf16_f32 v141, v146, v147
    v_cvt_pk_bf16_f32 v142, v148, v149
    v_cvt_pk_bf16_f32 v143, v150, v151
    s_waitcnt lgkmcnt(3)
    v_mfma_f32_32x32x16_bf16 v[72:87], v[48:51], v[136:139], v[72:87]
    v_exp_f32 v152, v152
    v_exp_f32 v153, v153
    v_exp_f32 v154, v154
    v_exp_f32 v155, v155
    v_exp_f32 v156, v156
    v_exp_f32 v157, v157
    s_waitcnt lgkmcnt(2)
    v_mfma_f32_32x32x16_bf16 v[72:87], v[52:55], v[140:143], v[72:87]
    v_exp_f32 v158, v158
    v_exp_f32 v159, v159
    v_exp_f32 v160, v160
    v_exp_f32 v161, v161
    v_exp_f32 v162, v162
    v_exp_f32 v163, v163
    s_mov_b64 exec, s[98:99]
    ds_read_b128 v[48:51], v18 offset:6400
    ds_read_b128 v[52:55], v18 offset:7040
    s_mov_b64 exec, -1
    v_exp_f32 v164, v164
    v_exp_f32 v165, v165
    v_exp_f32 v166, v166
    v_exp_f32 v167, v167
    v_cvt_pk_bf16_f32 v152, v152, v153
    v_cvt_pk_bf16_f32 v153, v154, v155
    v_mfma_f32_32x32x16_bf16 v[184:199], v[36:39], v[32:35], v[184:199]
    v_cvt_pk_bf16_f32 v154, v156, v157
    v_cvt_pk_bf16_f32 v155, v158, v159
    v_cvt_pk_bf16_f32 v156, v160, v161
    v_cvt_pk_bf16_f32 v157, v162, v163
    v_cvt_pk_bf16_f32 v158, v164, v165
    v_cvt_pk_bf16_f32 v159, v166, v167
    s_waitcnt lgkmcnt(3)
    v_mfma_f32_32x32x16_bf16 v[72:87], v[56:59], v[152:155], v[72:87]
    v_exp_f32 v168, v168
    v_exp_f32 v169, v169
    v_exp_f32 v170, v170
    v_exp_f32 v171, v171
    v_exp_f32 v172, v172
    v_exp_f32 v173, v173
    s_waitcnt lgkmcnt(2)
    v_mfma_f32_32x32x16_bf16 v[72:87], v[60:63], v[156:159], v[72:87]
    v_exp_f32 v174, v174
    v_exp_f32 v175, v175
    v_exp_f32 v176, v176
    v_exp_f32 v177, v177
    v_exp_f32 v178, v178
    v_exp_f32 v179, v179
    s_mov_b64 exec, s[98:99]
    ds_read_b128 v[56:59], v18 offset:7680
    ds_read_b128 v[60:63], v18 offset:8320
    s_mov_b64 exec, -1
    v_exp_f32 v180, v180
    v_exp_f32 v181, v181
    v_exp_f32 v182, v182
    v_exp_f32 v183, v183
    v_cvt_pk_bf16_f32 v168, v168, v169
    v_cvt_pk_bf16_f32 v169, v170, v171
    v_mfma_f32_32x32x16_bf16 v[200:215], v[36:39], v[32:35], v[200:215]
    v_cvt_pk_bf16_f32 v170, v172, v173
    v_cvt_pk_bf16_f32 v171, v174, v175
    v_cvt_pk_bf16_f32 v172, v176, v177
    v_cvt_pk_bf16_f32 v173, v178, v179
    v_cvt_pk_bf16_f32 v174, v180, v181
    v_cvt_pk_bf16_f32 v175, v182, v183
    s_waitcnt lgkmcnt(3)
    v_mfma_f32_32x32x16_bf16 v[72:87], v[48:51], v[168:171], v[72:87]
    v_exp_f32 v184, v184
    v_exp_f32 v185, v185
    v_exp_f32 v186, v186
    v_exp_f32 v187, v187
    v_exp_f32 v188, v188
    v_exp_f32 v189, v189
    s_waitcnt lgkmcnt(2)
    v_mfma_f32_32x32x16_bf16 v[72:87], v[52:55], v[172:175], v[72:87]
    v_exp_f32 v190, v190
    v_exp_f32 v191, v191
    v_exp_f32 v192, v192
    v_exp_f32 v193, v193
    v_exp_f32 v194, v194
    v_exp_f32 v195, v195
    s_mov_b64 exec, s[98:99]
    ds_read_b128 v[48:51], v18 offset:8960
    ds_read_b128 v[52:55], v18 offset:9600
    s_mov_b64 exec, -1
    v_exp_f32 v196, v196
    v_exp_f32 v197, v197
    v_exp_f32 v198, v198
    v_exp_f32 v199, v199
    v_cvt_pk_bf16_f32 v184, v184, v185
    v_cvt_pk_bf16_f32 v185, v186, v187
    v_mfma_f32_32x32x16_bf16 v[88:103], v[36:39], v[32:35], v[88:103]
    v_cvt_pk_bf16_f32 v186, v188, v189
    v_cvt_pk_bf16_f32 v187, v190, v191
    v_cvt_pk_bf16_f32 v188, v192, v193
    v_cvt_pk_bf16_f32 v189, v194, v195
    v_cvt_pk_bf16_f32 v190, v196, v197
    v_cvt_pk_bf16_f32 v191, v198, v199
    s_waitcnt lgkmcnt(3)
    v_mfma_f32_32x32x16_bf16 v[72:87], v[56:59], v[184:187], v[72:87]
    v_exp_f32 v200, v200
    v_exp_f32 v201, v201
    v_exp_f32 v202, v202
    v_exp_f32 v203, v203
    v_exp_f32 v204, v204
    v_exp_f32 v205, v205
    v_exp_f32 v206, v206
    v_exp_f32 v207, v207
    s_waitcnt lgkmcnt(2)
    v_mfma_f32_32x32x16_bf16 v[72:87], v[60:63], v[188:191], v[72:87]
    v_exp_f32 v208, v208
    v_exp_f32 v209, v209
    v_exp_f32 v210, v210
    v_exp_f32 v211, v211
    v_exp_f32 v212, v212
    v_exp_f32 v213, v213
    v_exp_f32 v214, v214
    v_exp_f32 v215, v215
    s_mov_b64 exec, s[98:99]
    ds_read_b128 v[56:59], v18 offset:0
    ds_read_b128 v[60:63], v18 offset:640
    s_mov_b64 exec, -1
    v_cvt_pk_bf16_f32 v200, v200, v201
    v_cvt_pk_bf16_f32 v201, v202, v203
    v_cvt_pk_bf16_f32 v202, v204, v205
    v_cvt_pk_bf16_f32 v203, v206, v207
    v_cvt_pk_bf16_f32 v204, v208, v209
    v_cvt_pk_bf16_f32 v205, v210, v211
    v_cvt_pk_bf16_f32 v206, v212, v213
    v_cvt_pk_bf16_f32 v207, v214, v215
    s_waitcnt lgkmcnt(3)
    v_mfma_f32_32x32x16_bf16 v[72:87], v[48:51], v[200:203], v[72:87]
    v_exp_f32 v88, v88
    v_exp_f32 v89, v89
    v_exp_f32 v90, v90
    v_exp_f32 v91, v91
    v_exp_f32 v92, v92
    v_exp_f32 v93, v93
    v_exp_f32 v94, v94
    v_exp_f32 v95, v95
    v_exp_f32 v96, v96
    v_exp_f32 v97, v97
    v_exp_f32 v98, v98
    v_exp_f32 v99, v99
    v_exp_f32 v100, v100
    s_waitcnt lgkmcnt(2)
    v_mfma_f32_32x32x16_bf16 v[72:87], v[52:55], v[204:207], v[72:87]
    v_exp_f32 v101, v101
    v_exp_f32 v102, v102
    v_exp_f32 v103, v103
    v_cvt_pk_bf16_f32 v88, v88, v89
    v_cvt_pk_bf16_f32 v89, v90, v91
    v_cvt_pk_bf16_f32 v90, v92, v93
    v_cvt_pk_bf16_f32 v91, v94, v95
    v_cvt_pk_bf16_f32 v92, v96, v97
    v_cvt_pk_bf16_f32 v93, v98, v99
    v_cvt_pk_bf16_f32 v94, v100, v101
    v_cvt_pk_bf16_f32 v95, v102, v103
    v_and_b32 v96, v24, v88
    v_and_b32 v97, v25, v89
    s_mov_b64 exec, s[98:99]
    ds_read_b128 v[48:51], v18 offset:10240
    ds_read_b128 v[52:55], v18 offset:10880
    s_mov_b64 exec, -1
    v_and_b32 v98, v26, v90
    v_and_b32 v99, v27, v91
    v_and_b32 v100, v28, v92
    v_and_b32 v101, v29, v93
    v_and_b32 v102, v30, v94
    v_and_b32 v103, v31, v95
    v_bfi_b32 v88, v24, 0, v88
    v_bfi_b32 v89, v25, 0, v89
    v_bfi_b32 v90, v26, 0, v90
    v_bfi_b32 v91, v27, 0, v91
    v_bfi_b32 v92, v28, 0, v92
    v_bfi_b32 v93, v29, 0, v93
    v_bfi_b32 v94, v30, 0, v94
    v_bfi_b32 v95, v31, 0, v95
    s_waitcnt lgkmcnt(3)
    v_mfma_f32_32x32x16_bf16 v[72:87], v[56:59], v[88:91], v[72:87]
    s_lshr_b32 s49, s45, 1
    s_mul_i32 s49, s49, 5
    s_mul_i32 s52, s55, 3
    s_add_u32 s52, s52, s49
    s_waitcnt lgkmcnt(2)
    v_mfma_f32_32x32x16_bf16 v[72:87], v[60:63], v[92:95], v[72:87]
    s_lshl_b32 s52, s52, 15
    s_add_u32 s52, s52, 7864320
    s_lshl_b32 s53, s51, 4
    s_add_u32 s52, s52, s53
    s_waitcnt lgkmcnt(1)
    v_mfma_f32_32x32x16_bf16 v[72:87], v[48:51], v[96:99], v[72:87]
    s_add_u32 s54, s49, 2
    s_lshl_b32 s54, s54, 15
    s_add_u32 s54, s54, 7864320
    s_add_u32 s54, s54, s53
    s_waitcnt lgkmcnt(0)
    v_mfma_f32_32x32x16_bf16 v[72:87], v[52:55], v[100:103], v[72:87]
    s_lshl_b32 s49, s55, 3
    s_add_u32 s54, s54, s49
    v_lshlrev_b32 v22, 4, v12
    v_lshl_add_u32 v23, v13, 15, v22
    s_nop 7
    v_cndmask_b32 v85, v84, v80, s[96:97]
    v_rcp_f32 v86, v85
    s_nop 0
    v_pk_mul_f32 v[72:73], v[72:73], v[86:87] op_sel_hi:[1,0]
    v_pk_mul_f32 v[74:75], v[74:75], v[86:87] op_sel_hi:[1,0]
    v_pk_mul_f32 v[76:77], v[76:77], v[86:87] op_sel_hi:[1,0]
    v_pk_mul_f32 v[78:79], v[78:79], v[86:87] op_sel_hi:[1,0]
    v_pk_mul_f32 v[80:81], v[80:81], v[86:87] op_sel_hi:[1,0]
    v_pk_mul_f32 v[82:83], v[82:83], v[86:87] op_sel_hi:[1,0]
    v_cvt_pk_bf16_f32 v104, v72, v73
    v_cvt_pk_bf16_f32 v105, v74, v75
    v_cvt_pk_bf16_f32 v106, v76, v77
    v_cvt_pk_bf16_f32 v107, v78, v79
    v_cvt_pk_bf16_f32 v108, v80, v81
    v_cvt_pk_bf16_f32 v109, v82, v83
    buffer_store_dwordx4 v[104:107], v23, s[32:35], s52 offen sc1
    s_mov_b64 exec, s[100:101]
    buffer_store_dwordx2 v[108:109], v22, s[32:35], s54 offen sc1
    s_mov_b64 exec, -1
    s_waitcnt lgkmcnt(0)
    s_setprio 0
    s_waitcnt vmcnt(2)
    v_xor_b32 v240, s3, v240
    v_xor_b32 v241, s3, v241
    v_xor_b32 v242, s3, v242
    v_xor_b32 v243, s3, v243
    v_or3_b32 v240, v240, v241, v242
    v_or_b32 v240, v240, v243
    v_cmp_ne_u32 vcc, 0, v240
    s_cbranch_vccnz FSLOW_132
FBACK_133:
    s_cmp_ge_u32 s40, 4
    s_nop 1
    s_cbranch_scc1 L3_3
    s_add_u32 m0, s0, 81920
    s_add_u32 s1, s36, 4
    s_sub_u32 s38, s1, 5
    s_cmp_ge_u32 s1, 5
    s_cselect_b32 s1, s38, s1
    s_mul_i32 s1, s1, 40960
    buffer_load_dwordx4 v232, s[12:15], s1 offen offset:0 lds
    buffer_load_dwordx4 v233, s[12:15], s1 offen offset:1024 lds
    buffer_load_dwordx4 v234, s[12:15], s1 offen offset:2048 lds
    buffer_load_dwordx4 v235, s[12:15], s1 offen offset:3072 lds
    s_add_u32 m0, s0, 86016
    s_nop 0
    buffer_load_dwordx4 v236, s[12:15], s1 offen lds
    s_and_b32 s46, s41, 3
    s_lshl_b32 s46, s46, 3
    s_and_b32 s44, s42, 7
    s_add_u32 s44, s44, s46
    s_lshr_b32 s46, s41, 2
    s_lshl_b32 s46, s46, 2
    s_lshr_b32 s45, s42, 3
    s_add_u32 s45, s45, s46
    s_sub_u32 s36, s45, 5
    s_cmp_ge_u32 s45, 5
    s_cselect_b32 s36, s36, s45
    s_mov_b32 s50, 0
    s_mul_i32 s51, s43, 5120
    v_and_b32 v15, 15, v1
    v_lshrrev_b32 v16, 4, v1
    v_bfe_u32 v17, v1, 2, 2
    v_lshl_add_u32 v18, v16, 3, v17
    v_bfe_u32 v20, v1, 4, 1
    v_lshlrev_b32 v20, 2, v20
    v_xor_b32 v19, v18, v20
    v_xor_b32 v22, 4, v19
    v_and_b32 v21, 3, v1
    v_mul_u32_u24 v24, 160, v19
    v_lshl_add_u32 v24, v21, 3, v24
    v_add_u32 v24, s51, v24
    v_mul_u32_u24 v25, 160, v22
    v_lshl_add_u32 v25, v21, 3, v25
    v_add_u32 v25, s51, v25
    v_add_u32 v26, 61440, v24
    v_add_u32 v27, 61440, v25
    v_add_u32 v28, 122880, v24
    v_add_u32 v29, 122880, v25
    v_lshlrev_b32 v2, 4, v1
    v_lshlrev_b32 v3, 4, v15
    v_lshl_add_u32 v3, v16, 15, v3
    s_add_u32 s46, s43, 0
    s_and_b32 s46, s46, 3
    s_lshl_b32 s46, s46, 8
    v_add_u32 v4, s46, v3
    s_add_u32 s46, s43, 1
    s_and_b32 s46, s46, 3
    s_lshl_b32 s46, s46, 8
    v_add_u32 v5, s46, v3
    s_add_u32 s46, s43, 2
    s_and_b32 s46, s46, 3
    s_lshl_b32 s46, s46, 8
    v_add_u32 v6, s46, v3
    s_add_u32 s46, s43, 3
    s_and_b32 s46, s46, 3
    s_lshl_b32 s46, s46, 8
    v_add_u32 v7, s46, v3
    s_lshl_b32 s53, s44, 10
    s_mul_i32 s54, s43, 655360
    s_add_u32 s53, s53, s54
    s_add_u32 s53, s53, 7864320
    v_add_u32 v30, s51, v2
    s_sub_u32 s47, s43, 1
    s_and_b32 s47, s47, 3
    s_mul_i32 s47, s47, 5120
    v_add_u32 v31, s47, v2
    s_sub_u32 s47, s43, 2
    s_and_b32 s47, s47, 3
    s_mul_i32 s47, s47, 5120
    v_add_u32 v32, s47, v2
    s_sub_u32 s47, s43, 3
    s_and_b32 s47, s47, 3
    s_mul_i32 s47, s47, 5120
    v_add_u32 v33, s47, v2
    s_lshl_b32 s46, s44, 6
    s_lshl_b32 s47, s43, 4
    s_add_u32 s46, s46, s47
    v_add_u32 v12, s46, v15
    v_lshlrev_b32 v34, 4, v12
    v_lshrrev_b32 v14, 1, v16
    v_lshl_add_u32 v35, v14, 15, v34
    v_and_b32 v14, 1, v16
    v_lshl_add_u32 v36, v14, 16, v35
    v_lshl_add_u32 v34, v14, 3, v35
    v_lshlrev_b32 v37, 3, v12
    v_mov_b32 v38, 0x3f803f80
    v_mul_u32_u24 v13, 1280, v12
    v_lshl_add_u32 v13, v16, 3, v13
    s_mul_i32 s47, s45, 160
    s_lshl_b32 s48, s50, 5
    s_add_u32 s48, s48, s47
    s_lshl_b32 s49, s50, 7
    s_sub_u32 s49, 128, s49
    s_add_u32 s49, s49, s47
    buffer_load_dwordx2 v[244:245], v13, s[4:7], s48 offen offset:0
    buffer_load_dwordx2 v[246:247], v13, s[4:7], s48 offen offset:32
    buffer_load_dwordx2 v[248:249], v13, s[4:7], s48 offen offset:64
    buffer_load_dwordx2 v[250:251], v13, s[4:7], s48 offen offset:96
    buffer_load_dwordx2 v[252:253], v13, s[4:7], s49 offen
    v_bfe_u32 v10, v1, 1, 2
    v_mul_u32_u24 v10, 163840, v10
    v_and_b32 v11, 1, v1
    v_lshl_add_u32 v10, v11, 3, v10
    v_bfe_u32 v11, v1, 3, 1
    v_lshl_add_u32 v10, v11, 9, v10
    s_add_u32 s55, s53, 66032
    s_and_b32 s47, s41, 1
    s_lshl_b32 s47, s47, 3
    s_and_b32 s48, s42, 7
    s_add_u32 s48, s48, s47
    s_lshr_b32 s47, s41, 1
    s_lshl_b32 s47, s47, 2
    s_lshr_b32 s49, s42, 3
    s_add_u32 s49, s49, s47
    s_lshl_b32 s48, s48, 4
    s_add_u32 s49, s49, s48
    s_barrier
    v_mov_b32 v8, s3
    v_lshlrev_b32 v9, 10, v1
    s_lshl_b32 s60, s49, 2
    s_add_u32 s60, s60, 19439616
    s_mov_b32 s61, 1073741824
    s_cmp_eq_u32 s40, 0
    s_cselect_b32 s60, s60, s61
    s_mov_b64 exec, 0xff
    buffer_store_dword v8, v9, s[32:35], s60 offen sc1
    s_mov_b64 exec, -1
    s_add_u32 s54, s36, 0
    s_sub_u32 s38, s54, 5
    s_cmp_ge_u32 s54, 5
    s_cselect_b32 s54, s38, s54
    s_mul_i32 s54, s54, 131072
    s_add_u32 s54, s54, s53
    buffer_load_dwordx4 v[164:167], v4, s[32:35], s54 offen sc1
    buffer_load_dwordx4 v[168:171], v5, s[32:35], s54 offen sc1
    buffer_load_dwordx4 v[172:175], v6, s[32:35], s54 offen sc1
    buffer_load_dwordx4 v[176:179], v7, s[32:35], s54 offen sc1
    ds_read_b64_tr_b16 v[124:125], v24 offset:0
    ds_read_b64_tr_b16 v[126:127], v25 offset:0
    ds_read_b64_tr_b16 v[128:129], v24 offset:32
    ds_read_b64_tr_b16 v[130:131], v25 offset:32
    ds_read_b64_tr_b16 v[132:133], v24 offset:64
    ds_read_b64_tr_b16 v[134:135], v25 offset:64
    ds_read_b64_tr_b16 v[136:137], v24 offset:96
    ds_read_b64_tr_b16 v[138:139], v25 offset:96
    ds_read_b64_tr_b16 v[140:141], v24 offset:128
    ds_read_b64_tr_b16 v[142:143], v25 offset:128
    s_waitcnt vmcnt(5)
    v_lshlrev_b32 v44, 16, v244
    v_and_b32 v45, 0xffff0000, v244
    v_lshlrev_b32 v46, 16, v245
    v_and_b32 v47, 0xffff0000, v245
    v_lshlrev_b32 v48, 16, v246
    v_and_b32 v49, 0xffff0000, v246
    v_lshlrev_b32 v50, 16, v247
    v_and_b32 v51, 0xffff0000, v247
    v_lshlrev_b32 v52, 16, v248
    v_and_b32 v53, 0xffff0000, v248
    v_lshlrev_b32 v54, 16, v249
    v_and_b32 v55, 0xffff0000, v249
    v_lshlrev_b32 v56, 16, v250
    v_and_b32 v57, 0xffff0000, v250
    v_lshlrev_b32 v58, 16, v251
    v_and_b32 v59, 0xffff0000, v251
    v_lshlrev_b32 v60, 16, v252
    v_and_b32 v61, 0xffff0000, v252
    v_lshlrev_b32 v62, 16, v253
    v_and_b32 v63, 0xffff0000, v253
    s_waitcnt vmcnt(0)
    v_max3_u32 v14, v164, v165, v166
    v_max3_u32 v14, v14, v167, v168
    v_max3_u32 v14, v14, v169, v170
    v_max3_u32 v14, v14, v171, v172
    v_max3_u32 v14, v14, v173, v174
    v_max3_u32 v14, v14, v175, v176
    v_max3_u32 v14, v14, v177, v178
    v_max_u32 v14, v14, v179
    v_cmp_eq_u32 vcc, -1, v14
    s_cbranch_vccnz SLOW_134
BACK_135:
    s_waitcnt lgkmcnt(8)
    v_mfma_f32_16x16x32_bf16 v[44:47], v[124:127], v[164:167], v[44:47]
    s_add_u32 s54, s36, 1
    s_sub_u32 s38, s54, 5
    s_cmp_ge_u32 s54, 5
    s_cselect_b32 s54, s38, s54
    s_mul_i32 s54, s54, 131072
    s_add_u32 s54, s54, s53
    buffer_load_dwordx4 v[180:183], v4, s[32:35], s54 offen sc1
    s_waitcnt lgkmcnt(6)
    v_mfma_f32_16x16x32_bf16 v[48:51], v[128:131], v[164:167], v[48:51]
    s_waitcnt lgkmcnt(4)
    v_mfma_f32_16x16x32_bf16 v[52:55], v[132:135], v[164:167], v[52:55]
    buffer_load_dwordx4 v[184:187], v5, s[32:35], s54 offen sc1
    s_waitcnt lgkmcnt(2)
    v_mfma_f32_16x16x32_bf16 v[56:59], v[136:139], v[164:167], v[56:59]
    s_waitcnt lgkmcnt(0)
    v_mfma_f32_16x16x32_bf16 v[60:63], v[140:143], v[164:167], v[60:63]
    buffer_load_dwordx4 v[188:191], v6, s[32:35], s54 offen sc1
    v_mfma_f32_16x16x32_bf16 v[64:67], v[124:127], v[168:171], 0
    ds_read_b64_tr_b16 v[144:145], v24 offset:20480
    v_mfma_f32_16x16x32_bf16 v[68:71], v[128:131], v[168:171], 0
    buffer_load_dwordx4 v[192:195], v7, s[32:35], s54 offen sc1
    ds_read_b64_tr_b16 v[146:147], v25 offset:20480
    v_mfma_f32_16x16x32_bf16 v[72:75], v[132:135], v[168:171], 0
    ds_read_b64_tr_b16 v[148:149], v24 offset:20512
    v_mfma_f32_16x16x32_bf16 v[76:79], v[136:139], v[168:171], 0
    ds_read_b64_tr_b16 v[150:151], v25 offset:20512
    v_mfma_f32_16x16x32_bf16 v[80:83], v[140:143], v[168:171], 0
    ds_read_b64_tr_b16 v[152:153], v24 offset:20544
    v_mfma_f32_16x16x32_bf16 v[84:87], v[124:127], v[172:175], 0
    s_add_u32 s54, s36, 2
    s_sub_u32 s38, s54, 5
    s_cmp_ge_u32 s54, 5
    s_cselect_b32 s54, s38, s54
    s_mul_i32 s54, s54, 131072
    s_add_u32 s54, s54, s53
    buffer_load_dwordx4 v[196:199], v4, s[32:35], s54 offen sc1
    ds_read_b64_tr_b16 v[154:155], v25 offset:20544
    v_mfma_f32_16x16x32_bf16 v[88:91], v[128:131], v[172:175], 0
    ds_read_b64_tr_b16 v[156:157], v24 offset:20576
    v_mfma_f32_16x16x32_bf16 v[92:95], v[132:135], v[172:175], 0
    buffer_load_dwordx4 v[200:203], v5, s[32:35], s54 offen sc1
    ds_read_b64_tr_b16 v[158:159], v25 offset:20576
    v_mfma_f32_16x16x32_bf16 v[96:99], v[136:139], v[172:175], 0
    ds_read_b64_tr_b16 v[160:161], v24 offset:20608
    v_mfma_f32_16x16x32_bf16 v[100:103], v[140:143], v[172:175], 0
    buffer_load_dwordx4 v[204:207], v6, s[32:35], s54 offen sc1
    ds_read_b64_tr_b16 v[162:163], v25 offset:20608
    v_mfma_f32_16x16x32_bf16 v[104:107], v[124:127], v[176:179], 0
    v_mfma_f32_16x16x32_bf16 v[108:111], v[128:131], v[176:179], 0
    buffer_load_dwordx4 v[208:211], v7, s[32:35], s54 offen sc1
    v_mfma_f32_16x16x32_bf16 v[112:115], v[132:135], v[176:179], 0
    v_mfma_f32_16x16x32_bf16 v[116:119], v[136:139], v[176:179], 0
    v_mfma_f32_16x16x32_bf16 v[120:123], v[140:143], v[176:179], 0
    s_waitcnt vmcnt(4)
    v_max3_u32 v14, v180, v181, v182
    v_max3_u32 v14, v14, v183, v184
    v_max3_u32 v14, v14, v185, v186
    v_max3_u32 v14, v14, v187, v188
    v_max3_u32 v14, v14, v189, v190
    v_max3_u32 v14, v14, v191, v192
    v_max3_u32 v14, v14, v193, v194
    v_max_u32 v14, v14, v195
    v_cmp_eq_u32 vcc, -1, v14
    s_cbranch_vccnz SLOW_137
BACK_138:
    s_waitcnt lgkmcnt(8)
    v_mfma_f32_16x16x32_bf16 v[44:47], v[144:147], v[180:183], v[44:47]
    s_add_u32 s54, s36, 3
    s_sub_u32 s38, s54, 5
    s_cmp_ge_u32 s54, 5
    s_cselect_b32 s54, s38, s54
    s_mul_i32 s54, s54, 131072
    s_add_u32 s54, s54, s53
    buffer_load_dwordx4 v[212:215], v4, s[32:35], s54 offen sc1
    s_waitcnt lgkmcnt(6)
    v_mfma_f32_16x16x32_bf16 v[48:51], v[148:151], v[180:183], v[48:51]
    s_waitcnt lgkmcnt(4)
    v_mfma_f32_16x16x32_bf16 v[52:55], v[152:155], v[180:183], v[52:55]
    buffer_load_dwordx4 v[216:219], v5, s[32:35], s54 offen sc1
    s_waitcnt lgkmcnt(2)
    v_mfma_f32_16x16x32_bf16 v[56:59], v[156:159], v[180:183], v[56:59]
    s_waitcnt lgkmcnt(0)
    v_mfma_f32_16x16x32_bf16 v[60:63], v[160:163], v[180:183], v[60:63]
    buffer_load_dwordx4 v[220:223], v6, s[32:35], s54 offen sc1
    v_mfma_f32_16x16x32_bf16 v[64:67], v[144:147], v[184:187], v[64:67]
    ds_read_b64_tr_b16 v[124:125], v24 offset:40960
    v_mfma_f32_16x16x32_bf16 v[68:71], v[148:151], v[184:187], v[68:71]
    buffer_load_dwordx4 v[224:227], v7, s[32:35], s54 offen sc1
    ds_read_b64_tr_b16 v[126:127], v25 offset:40960
    v_mfma_f32_16x16x32_bf16 v[72:75], v[152:155], v[184:187], v[72:75]
    ds_read_b64_tr_b16 v[128:129], v24 offset:40992
    v_mfma_f32_16x16x32_bf16 v[76:79], v[156:159], v[184:187], v[76:79]
    ds_read_b64_tr_b16 v[130:131], v25 offset:40992
    v_mfma_f32_16x16x32_bf16 v[80:83], v[160:163], v[184:187], v[80:83]
    ds_read_b64_tr_b16 v[132:133], v24 offset:41024
    v_mfma_f32_16x16x32_bf16 v[84:87], v[144:147], v[188:191], v[84:87]
    s_add_u32 s54, s36, 4
    s_sub_u32 s38, s54, 5
    s_cmp_ge_u32 s54, 5
    s_cselect_b32 s54, s38, s54
    s_mul_i32 s54, s54, 131072
    s_add_u32 s54, s54, s53
    buffer_load_dwordx4 v[228:231], v4, s[32:35], s54 offen sc1
    ds_read_b64_tr_b16 v[134:135], v25 offset:41024
    v_mfma_f32_16x16x32_bf16 v[88:91], v[148:151], v[188:191], v[88:91]
    ds_read_b64_tr_b16 v[136:137], v24 offset:41056
    v_mfma_f32_16x16x32_bf16 v[92:95], v[152:155], v[188:191], v[92:95]
    buffer_load_dwordx4 v[232:235], v5, s[32:35], s54 offen sc1
    ds_read_b64_tr_b16 v[138:139], v25 offset:41056
    v_mfma_f32_16x16x32_bf16 v[96:99], v[156:159], v[188:191], v[96:99]
    ds_read_b64_tr_b16 v[140:141], v24 offset:41088
    v_mfma_f32_16x16x32_bf16 v[100:103], v[160:163], v[188:191], v[100:103]
    buffer_load_dwordx4 v[236:239], v6, s[32:35], s54 offen sc1
    ds_read_b64_tr_b16 v[142:143], v25 offset:41088
    v_mfma_f32_16x16x32_bf16 v[104:107], v[144:147], v[192:195], v[104:107]
    s_waitcnt vmcnt(7)
    v_max3_u32 v14, v196, v197, v198
    v_max3_u32 v14, v14, v199, v200
    v_mfma_f32_16x16x32_bf16 v[108:111], v[148:151], v[192:195], v[108:111]
    buffer_load_dwordx4 v[240:243], v7, s[32:35], s54 offen sc1
    v_max3_u32 v14, v14, v201, v202
    v_max3_u32 v14, v14, v203, v204
    v_mfma_f32_16x16x32_bf16 v[112:115], v[152:155], v[192:195], v[112:115]
    v_max3_u32 v14, v14, v205, v206
    v_max3_u32 v14, v14, v207, v208
    v_mfma_f32_16x16x32_bf16 v[116:119], v[156:159], v[192:195], v[116:119]
    v_max3_u32 v14, v14, v209, v210
    v_max_u32 v14, v14, v211
    v_mfma_f32_16x16x32_bf16 v[120:123], v[160:163], v[192:195], v[120:123]
    v_cmp_eq_u32 vcc, -1, v14
    s_cbranch_vccnz SLOW_140
BACK_141:
    s_waitcnt lgkmcnt(8)
    v_mfma_f32_16x16x32_bf16 v[44:47], v[124:127], v[196:199], v[44:47]
    s_waitcnt lgkmcnt(6)
    v_mfma_f32_16x16x32_bf16 v[48:51], v[128:131], v[196:199], v[48:51]
    s_waitcnt lgkmcnt(4)
    v_mfma_f32_16x16x32_bf16 v[52:55], v[132:135], v[196:199], v[52:55]
    s_waitcnt lgkmcnt(2)
    v_mfma_f32_16x16x32_bf16 v[56:59], v[136:139], v[196:199], v[56:59]
    s_waitcnt lgkmcnt(0)
    v_mfma_f32_16x16x32_bf16 v[60:63], v[140:143], v[196:199], v[60:63]
    v_mfma_f32_16x16x32_bf16 v[64:67], v[124:127], v[200:203], v[64:67]
    ds_read_b64_tr_b16 v[144:145], v26 offset:0
    v_mfma_f32_16x16x32_bf16 v[68:71], v[128:131], v[200:203], v[68:71]
    ds_read_b64_tr_b16 v[146:147], v27 offset:0
    v_mfma_f32_16x16x32_bf16 v[72:75], v[132:135], v[200:203], v[72:75]
    ds_read_b64_tr_b16 v[148:149], v26 offset:32
    v_mfma_f32_16x16x32_bf16 v[76:79], v[136:139], v[200:203], v[76:79]
    ds_read_b64_tr_b16 v[150:151], v27 offset:32
    v_mfma_f32_16x16x32_bf16 v[80:83], v[140:143], v[200:203], v[80:83]
    ds_read_b64_tr_b16 v[152:153], v26 offset:64
    v_mfma_f32_16x16x32_bf16 v[84:87], v[124:127], v[204:207], v[84:87]
    ds_read_b64_tr_b16 v[154:155], v27 offset:64
    v_mfma_f32_16x16x32_bf16 v[88:91], v[128:131], v[204:207], v[88:91]
    ds_read_b64_tr_b16 v[156:157], v26 offset:96
    v_mfma_f32_16x16x32_bf16 v[92:95], v[132:135], v[204:207], v[92:95]
    ds_read_b64_tr_b16 v[158:159], v27 offset:96
    v_mfma_f32_16x16x32_bf16 v[96:99], v[136:139], v[204:207], v[96:99]
    ds_read_b64_tr_b16 v[160:161], v26 offset:128
    v_mfma_f32_16x16x32_bf16 v[100:103], v[140:143], v[204:207], v[100:103]
    ds_read_b64_tr_b16 v[162:163], v27 offset:128
    v_mfma_f32_16x16x32_bf16 v[104:107], v[124:127], v[208:211], v[104:107]
    s_waitcnt vmcnt(4)
    v_max3_u32 v14, v212, v213, v214
    v_max3_u32 v14, v14, v215, v216
    v_mfma_f32_16x16x32_bf16 v[108:111], v[128:131], v[208:211], v[108:111]
    v_max3_u32 v14, v14, v217, v218
    v_max3_u32 v14, v14, v219, v220
    v_mfma_f32_16x16x32_bf16 v[112:115], v[132:135], v[208:211], v[112:115]
    v_max3_u32 v14, v14, v221, v222
    v_max3_u32 v14, v14, v223, v224
    v_mfma_f32_16x16x32_bf16 v[116:119], v[136:139], v[208:211], v[116:119]
    v_max3_u32 v14, v14, v225, v226
    v_max_u32 v14, v14, v227
    v_mfma_f32_16x16x32_bf16 v[120:123], v[140:143], v[208:211], v[120:123]
    v_cmp_eq_u32 vcc, -1, v14
    s_cbranch_vccnz SLOW_143
BACK_144:
    s_waitcnt lgkmcnt(8)
    v_mfma_f32_16x16x32_bf16 v[44:47], v[144:147], v[212:215], v[44:47]
    s_waitcnt lgkmcnt(6)
    v_mfma_f32_16x16x32_bf16 v[48:51], v[148:151], v[212:215], v[48:51]
    s_waitcnt lgkmcnt(4)
    v_mfma_f32_16x16x32_bf16 v[52:55], v[152:155], v[212:215], v[52:55]
    s_waitcnt lgkmcnt(2)
    v_mfma_f32_16x16x32_bf16 v[56:59], v[156:159], v[212:215], v[56:59]
    s_waitcnt lgkmcnt(0)
    v_mfma_f32_16x16x32_bf16 v[60:63], v[160:163], v[212:215], v[60:63]
    v_mfma_f32_16x16x32_bf16 v[64:67], v[144:147], v[216:219], v[64:67]
    ds_read_b64_tr_b16 v[124:125], v26 offset:20480
    v_mfma_f32_16x16x32_bf16 v[68:71], v[148:151], v[216:219], v[68:71]
    ds_read_b64_tr_b16 v[126:127], v27 offset:20480
    v_mfma_f32_16x16x32_bf16 v[72:75], v[152:155], v[216:219], v[72:75]
    ds_read_b64_tr_b16 v[128:129], v26 offset:20512
    v_mfma_f32_16x16x32_bf16 v[76:79], v[156:159], v[216:219], v[76:79]
    ds_read_b64_tr_b16 v[130:131], v27 offset:20512
    v_mfma_f32_16x16x32_bf16 v[80:83], v[160:163], v[216:219], v[80:83]
    ds_read_b64_tr_b16 v[132:133], v26 offset:20544
    v_mfma_f32_16x16x32_bf16 v[84:87], v[144:147], v[220:223], v[84:87]
    ds_read_b64_tr_b16 v[134:135], v27 offset:20544
    v_mfma_f32_16x16x32_bf16 v[88:91], v[148:151], v[220:223], v[88:91]
    ds_read_b64_tr_b16 v[136:137], v26 offset:20576
    v_mfma_f32_16x16x32_bf16 v[92:95], v[152:155], v[220:223], v[92:95]
    ds_read_b64_tr_b16 v[138:139], v27 offset:20576
    v_mfma_f32_16x16x32_bf16 v[96:99], v[156:159], v[220:223], v[96:99]
    ds_read_b64_tr_b16 v[140:141], v26 offset:20608
    v_mfma_f32_16x16x32_bf16 v[100:103], v[160:163], v[220:223], v[100:103]
    ds_read_b64_tr_b16 v[142:143], v27 offset:20608
    v_mfma_f32_16x16x32_bf16 v[104:107], v[144:147], v[224:227], v[104:107]
    s_waitcnt vmcnt(0)
    v_max3_u32 v14, v228, v229, v230
    v_max3_u32 v14, v14, v231, v232
    v_mfma_f32_16x16x32_bf16 v[108:111], v[148:151], v[224:227], v[108:111]
    v_max3_u32 v14, v14, v233, v234
    v_max3_u32 v14, v14, v235, v236
    v_mfma_f32_16x16x32_bf16 v[112:115], v[152:155], v[224:227], v[112:115]
    v_max3_u32 v14, v14, v237, v238
    v_max3_u32 v14, v14, v239, v240
    v_mfma_f32_16x16x32_bf16 v[116:119], v[156:159], v[224:227], v[116:119]
    v_max3_u32 v14, v14, v241, v242
    v_max_u32 v14, v14, v243
    v_mfma_f32_16x16x32_bf16 v[120:123], v[160:163], v[224:227], v[120:123]
    v_cmp_eq_u32 vcc, -1, v14
    s_cbranch_vccnz SLOW_146
BACK_147:
    s_waitcnt lgkmcnt(8)
    v_mfma_f32_16x16x32_bf16 v[64:67], v[124:127], v[232:235], v[64:67]
    s_waitcnt lgkmcnt(6)
    v_mfma_f32_16x16x32_bf16 v[68:71], v[128:131], v[232:235], v[68:71]
    s_waitcnt lgkmcnt(4)
    v_mfma_f32_16x16x32_bf16 v[72:75], v[132:135], v[232:235], v[72:75]
    s_waitcnt lgkmcnt(2)
    v_mfma_f32_16x16x32_bf16 v[76:79], v[136:139], v[232:235], v[76:79]
    s_waitcnt lgkmcnt(0)
    v_mfma_f32_16x16x32_bf16 v[80:83], v[140:143], v[232:235], v[80:83]
    v_mfma_f32_16x16x32_bf16 v[84:87], v[124:127], v[236:239], v[84:87]
    v_mfma_f32_16x16x32_bf16 v[88:91], v[128:131], v[236:239], v[88:91]
    v_mfma_f32_16x16x32_bf16 v[92:95], v[132:135], v[236:239], v[92:95]
    v_mfma_f32_16x16x32_bf16 v[96:99], v[136:139], v[236:239], v[96:99]
    v_mfma_f32_16x16x32_bf16 v[100:103], v[140:143], v[236:239], v[100:103]
    ds_write_b128 v30, v[64:67] offset:0
    v_mfma_f32_16x16x32_bf16 v[104:107], v[124:127], v[240:243], v[104:107]
    ds_write_b128 v30, v[68:71] offset:1024
    v_mfma_f32_16x16x32_bf16 v[108:111], v[128:131], v[240:243], v[108:111]
    ds_write_b128 v30, v[72:75] offset:2048
    v_mfma_f32_16x16x32_bf16 v[112:115], v[132:135], v[240:243], v[112:115]
    ds_write_b128 v30, v[76:79] offset:3072
    v_mfma_f32_16x16x32_bf16 v[116:119], v[136:139], v[240:243], v[116:119]
    ds_write_b128 v30, v[80:83] offset:4096
    v_mfma_f32_16x16x32_bf16 v[120:123], v[140:143], v[240:243], v[120:123]
    ds_write_b128 v30, v[84:87] offset:20480
    v_mfma_f32_16x16x32_bf16 v[44:47], v[124:127], v[228:231], v[44:47]
    ds_write_b128 v30, v[88:91] offset:21504
    v_mfma_f32_16x16x32_bf16 v[48:51], v[128:131], v[228:231], v[48:51]
    ds_write_b128 v30, v[92:95] offset:22528
    v_mfma_f32_16x16x32_bf16 v[52:55], v[132:135], v[228:231], v[52:55]
    ds_write_b128 v30, v[96:99] offset:23552
    v_mfma_f32_16x16x32_bf16 v[56:59], v[136:139], v[228:231], v[56:59]
    ds_write_b128 v30, v[100:103] offset:24576
    v_mfma_f32_16x16x32_bf16 v[60:63], v[140:143], v[228:231], v[60:63]
    ds_write_b128 v30, v[104:107] offset:40960
    ds_write_b128 v30, v[108:111] offset:41984
    ds_write_b128 v30, v[112:115] offset:43008
    ds_write_b128 v30, v[116:119] offset:44032
    ds_write_b128 v30, v[120:123] offset:45056
    s_mul_i32 s48, s45, 10
    s_lshl_b32 s48, s48, 15
    s_add_u32 s48, s48, 10485760
    s_lshl_b32 s49, s45, 14
    s_add_u32 s49, s49, 19726336
    v_mov_b32 v40, 0
    v_mov_b32 v41, 0
    s_waitcnt lgkmcnt(0)
    s_barrier
    ds_read_b128 v[124:127], v31 offset:0
    ds_read_b128 v[144:147], v32 offset:20480
    ds_read_b128 v[164:167], v33 offset:40960
    ds_read_b128 v[128:131], v31 offset:1024
    ds_read_b128 v[148:151], v32 offset:21504
    ds_read_b128 v[168:171], v33 offset:41984
    ds_read_b128 v[132:135], v31 offset:2048
    ds_read_b128 v[152:155], v32 offset:22528
    ds_read_b128 v[172:175], v33 offset:43008
    ds_read_b128 v[136:139], v31 offset:3072
    ds_read_b128 v[156:159], v32 offset:23552
    ds_read_b128 v[176:179], v33 offset:44032
    ds_read_b128 v[140:143], v31 offset:4096
    ds_read_b128 v[160:163], v32 offset:24576
    ds_read_b128 v[180:183], v33 offset:45056
    s_waitcnt lgkmcnt(12)
    v_pk_add_f32 v[124:125], v[124:125], v[144:145]
    v_pk_add_f32 v[44:45], v[44:45], v[164:165]
    v_pk_add_f32 v[126:127], v[126:127], v[146:147]
    v_pk_add_f32 v[46:47], v[46:47], v[166:167]
    v_pk_add_f32 v[44:45], v[44:45], v[124:125]
    v_pk_add_f32 v[46:47], v[46:47], v[126:127]
    v_cvt_pk_bf16_f32 v244, v44, v45
    v_cvt_pk_bf16_f32 v245, v46, v47
    v_mov_b32 v200, v244
    v_mov_b32 v201, v245
    s_waitcnt lgkmcnt(9)
    v_pk_add_f32 v[128:129], v[128:129], v[148:149]
    v_pk_add_f32 v[48:49], v[48:49], v[168:169]
    v_pk_add_f32 v[130:131], v[130:131], v[150:151]
    v_pk_add_f32 v[50:51], v[50:51], v[170:171]
    v_pk_add_f32 v[48:49], v[48:49], v[128:129]
    v_pk_add_f32 v[50:51], v[50:51], v[130:131]
    v_cvt_pk_bf16_f32 v246, v48, v49
    v_cvt_pk_bf16_f32 v247, v50, v51
    v_mov_b32 v202, v246
    v_mov_b32 v203, v247
    s_nop 0
    v_permlane16_swap_b32 v200, v202
    v_permlane16_swap_b32 v201, v203
    s_add_u32 s47, s48, 0
    buffer_store_dwordx4 v[200:203], v36, s[32:35], s47 offen sc1
    s_waitcnt lgkmcnt(6)
    v_pk_add_f32 v[132:133], v[132:133], v[152:153]
    v_pk_add_f32 v[52:53], v[52:53], v[172:173]
    v_pk_add_f32 v[134:135], v[134:135], v[154:155]
    v_pk_add_f32 v[54:55], v[54:55], v[174:175]
    v_pk_add_f32 v[52:53], v[52:53], v[132:133]
    v_pk_add_f32 v[54:55], v[54:55], v[134:135]
    v_cvt_pk_bf16_f32 v248, v52, v53
    v_cvt_pk_bf16_f32 v249, v54, v55
    v_mov_b32 v204, v248
    v_mov_b32 v205, v249
    s_waitcnt lgkmcnt(3)
    v_pk_add_f32 v[136:137], v[136:137], v[156:157]
    v_pk_add_f32 v[56:57], v[56:57], v[176:177]
    v_pk_add_f32 v[138:139], v[138:139], v[158:159]
    v_pk_add_f32 v[58:59], v[58:59], v[178:179]
    v_pk_add_f32 v[56:57], v[56:57], v[136:137]
    v_pk_add_f32 v[58:59], v[58:59], v[138:139]
    v_cvt_pk_bf16_f32 v250, v56, v57
    v_cvt_pk_bf16_f32 v251, v58, v59
    v_mov_b32 v206, v250
    v_mov_b32 v207, v251
    s_nop 0
    v_permlane16_swap_b32 v204, v206
    v_permlane16_swap_b32 v205, v207
    s_add_u32 s47, s48, 131072
    buffer_store_dwordx4 v[204:207], v36, s[32:35], s47 offen sc1
    s_waitcnt lgkmcnt(0)
    v_pk_add_f32 v[140:141], v[140:141], v[160:161]
    v_pk_add_f32 v[60:61], v[60:61], v[180:181]
    v_pk_add_f32 v[142:143], v[142:143], v[162:163]
    v_pk_add_f32 v[62:63], v[62:63], v[182:183]
    v_pk_add_f32 v[60:61], v[60:61], v[140:141]
    v_pk_add_f32 v[62:63], v[62:63], v[142:143]
    v_cvt_pk_bf16_f32 v252, v60, v61
    v_cvt_pk_bf16_f32 v253, v62, v63
    s_add_u32 s47, s48, 262144
    buffer_store_dwordx2 v[252:253], v34, s[32:35], s47 offen sc1
    v_dot2_f32_bf16 v40, v244, v38, v40
    v_dot2_f32_bf16 v41, v244, v244, v41
    v_dot2_f32_bf16 v40, v245, v38, v40
    v_dot2_f32_bf16 v41, v245, v245, v41
    v_dot2_f32_bf16 v40, v246, v38, v40
    v_dot2_f32_bf16 v41, v246, v246, v41
    v_dot2_f32_bf16 v40, v247, v38, v40
    v_dot2_f32_bf16 v41, v247, v247, v41
    v_dot2_f32_bf16 v40, v248, v38, v40
    v_dot2_f32_bf16 v41, v248, v248, v41
    v_dot2_f32_bf16 v40, v249, v38, v40
    v_dot2_f32_bf16 v41, v249, v249, v41
    v_dot2_f32_bf16 v40, v250, v38, v40
    v_dot2_f32_bf16 v41, v250, v250, v41
    v_dot2_f32_bf16 v40, v251, v38, v40
    v_dot2_f32_bf16 v41, v251, v251, v41
    v_dot2_f32_bf16 v40, v252, v38, v40
    v_dot2_f32_bf16 v41, v252, v252, v41
    v_dot2_f32_bf16 v40, v253, v38, v40
    v_dot2_f32_bf16 v41, v253, v253, v41
    s_nop 1
    v_mov_b32 v156, v40
    v_mov_b32 v157, v40
    s_nop 1
    v_permlane32_swap_b32 v156, v157
    v_add_f32 v40, v156, v157
    v_mov_b32 v156, v40
    v_mov_b32 v157, v40
    s_nop 1
    v_permlane16_swap_b32 v156, v157
    v_add_f32 v40, v156, v157
    v_mov_b32 v156, v41
    v_mov_b32 v157, v41
    s_nop 1
    v_permlane32_swap_b32 v156, v157
    v_add_f32 v41, v156, v157
    v_mov_b32 v156, v41
    v_mov_b32 v157, v41
    s_nop 1
    v_permlane16_swap_b32 v156, v157
    v_add_f32 v41, v156, v157
    s_mov_b64 exec, 0xffff
    buffer_store_dwordx2 v[40:41], v37, s[32:35], s49 offen sc1
    s_mov_b64 exec, -1
    s_barrier
    s_and_b32 s46, s41, 1
    s_lshl_b32 s46, s46, 3
    s_and_b32 s44, s42, 7
    s_add_u32 s44, s44, s46
    s_lshr_b32 s46, s41, 1
    s_lshl_b32 s46, s46, 2
    s_lshr_b32 s45, s42, 3
    s_add_u32 s45, s45, s46
    s_lshl_b32 s46, s44, 7
    s_lshl_b32 s47, s43, 5
    s_add_u32 s46, s46, s47
    v_and_b32 v13, 31, v1
    v_lshrrev_b32 v14, 5, v1
    v_lshlrev_b32 v5, 4, v13
    v_lshl_add_u32 v5, v14, 15, v5
    v_bfe_u32 v15, v1, 2, 2
    v_lshl_add_u32 v15, v14, 3, v15
    v_mul_u32_u24 v15, 192, v15
    v_bfe_u32 v16, v1, 4, 1
    v_lshl_add_u32 v15, v16, 5, v15
    v_and_b32 v16, 1, v1
    v_lshl_add_u32 v15, v16, 4, v15
    v_bfe_u32 v16, v1, 1, 1
    v_lshl_add_u32 v6, v16, 3, v15
    v_add_u32 v7, 49152, v6
    v_add_u32 v8, 102400, v6
    s_mul_i32 s76, s45, 3
    s_add_u32 s76, s76, s44
    s_mul_i32 s77, s76, 6554
    s_lshr_b32 s77, s77, 16
    s_mul_i32 s77, s77, 10
    s_sub_u32 s76, s76, s77
    s_lshl_b32 s50, s46, 4
    s_add_u32 s50, s50, 10485760
    v_lshlrev_b32 v9, 3, v13
    v_lshl_add_u32 v9, v14, 16, v9
    s_lshl_b32 s51, s46, 3
    s_add_u32 s51, s51, 19726336
    v_lshlrev_b32 v10, 5, v14
    v_add_u32 v10, 159744, v10
    s_waitcnt vmcnt(0)
    s_add_u32 s49, s76, 0
    s_sub_u32 s48, s49, 10
    s_cmp_ge_u32 s49, 10
    s_cselect_b32 s49, s48, s49
    s_lshl_b32 s49, s49, 18
    s_add_u32 s49, s49, s50
    buffer_load_dwordx4 v[180:183], v5, s[32:35], s49 offen sc1
    s_add_u32 s49, s49, 65536
    buffer_load_dwordx4 v[184:187], v5, s[32:35], s49 offen sc1
    s_add_u32 s49, s49, 65536
    buffer_load_dwordx4 v[188:191], v5, s[32:35], s49 offen sc1
    s_add_u32 s49, s49, 65536
    buffer_load_dwordx4 v[192:195], v5, s[32:35], s49 offen sc1
    s_barrier
    ds_read_b64_tr_b16 v[132:133], v8 offset:0
    ds_read_b64_tr_b16 v[134:135], v8 offset:768
    ds_read_b64_tr_b16 v[136:137], v8 offset:64
    ds_read_b64_tr_b16 v[138:139], v8 offset:832
    ds_read_b64_tr_b16 v[140:141], v8 offset:128
    ds_read_b64_tr_b16 v[142:143], v8 offset:896
    ds_read_b64_tr_b16 v[144:145], v8 offset:12288
    ds_read_b64_tr_b16 v[146:147], v8 offset:13056
    ds_read_b64_tr_b16 v[148:149], v8 offset:12352
    ds_read_b64_tr_b16 v[150:151], v8 offset:13120
    ds_read_b64_tr_b16 v[152:153], v8 offset:12416
    ds_read_b64_tr_b16 v[154:155], v8 offset:13184
    s_waitcnt vmcnt(0)
    v_max3_u32 v4, v180, v181, v182
    v_max3_u32 v4, v4, v183, v184
    v_max3_u32 v4, v4, v185, v186
    v_max3_u32 v4, v4, v187, v188
    v_max3_u32 v4, v4, v189, v190
    v_max3_u32 v4, v4, v191, v192
    v_max3_u32 v4, v4, v193, v194
    v_max_u32 v4, v4, v195
    v_cmp_eq_u32 vcc, -1, v4
    s_cbranch_vccnz SLOW_149
BACK_150:
    s_add_u32 s49, s76, 1
    s_sub_u32 s48, s49, 10
    s_cmp_ge_u32 s49, 10
    s_cselect_b32 s49, s48, s49
    s_lshl_b32 s49, s49, 18
    s_add_u32 s49, s49, s50
    buffer_load_dwordx4 v[196:199], v5, s[32:35], s49 offen sc1
    s_add_u32 s49, s49, 65536
    buffer_load_dwordx4 v[200:203], v5, s[32:35], s49 offen sc1
    s_add_u32 s49, s49, 65536
    buffer_load_dwordx4 v[204:207], v5, s[32:35], s49 offen sc1
    s_add_u32 s49, s49, 65536
    buffer_load_dwordx4 v[208:211], v5, s[32:35], s49 offen sc1
    s_add_u32 s49, s76, 2
    s_sub_u32 s48, s49, 10
    s_cmp_ge_u32 s49, 10
    s_cselect_b32 s49, s48, s49
    s_lshl_b32 s49, s49, 18
    s_add_u32 s49, s49, s50
    buffer_load_dwordx4 v[212:215], v5, s[32:35], s49 offen sc1
    s_add_u32 s49, s49, 65536
    buffer_load_dwordx4 v[216:219], v5, s[32:35], s49 offen sc1
    s_add_u32 s49, s49, 65536
    buffer_load_dwordx4 v[220:223], v5, s[32:35], s49 offen sc1
    s_add_u32 s49, s49, 65536
    buffer_load_dwordx4 v[224:227], v5, s[32:35], s49 offen sc1
    s_waitcnt lgkmcnt(10)
    v_mfma_f32_32x32x16_bf16 v[36:51], v[132:135], v[180:183], 0
    ds_read_b64_tr_b16 v[156:157], v8 offset:3072
    ds_read_b64_tr_b16 v[158:159], v8 offset:3840
    s_add_u32 s49, s76, 3
    s_sub_u32 s48, s49, 10
    s_cmp_ge_u32 s49, 10
    s_cselect_b32 s49, s48, s49
    s_lshl_b32 s49, s49, 18
    s_add_u32 s49, s49, s50
    buffer_load_dwordx4 v[228:231], v5, s[32:35], s49 offen sc1
    s_waitcnt lgkmcnt(10)
    v_mfma_f32_32x32x16_bf16 v[52:67], v[136:139], v[180:183], 0
    ds_read_b64_tr_b16 v[160:161], v8 offset:3136
    ds_read_b64_tr_b16 v[162:163], v8 offset:3904
    s_waitcnt lgkmcnt(10)
    v_mfma_f32_32x32x16_bf16 v[68:83], v[140:143], v[180:183], 0
    ds_read_b64_tr_b16 v[164:165], v8 offset:3200
    ds_read_b64_tr_b16 v[166:167], v8 offset:3968
    s_waitcnt lgkmcnt(10)
    v_mfma_f32_32x32x16_bf16 v[84:99], v[144:147], v[180:183], 0
    ds_read_b64_tr_b16 v[168:169], v8 offset:15360
    ds_read_b64_tr_b16 v[170:171], v8 offset:16128
    s_waitcnt lgkmcnt(10)
    v_mfma_f32_32x32x16_bf16 v[100:115], v[148:151], v[180:183], 0
    ds_read_b64_tr_b16 v[172:173], v8 offset:15424
    ds_read_b64_tr_b16 v[174:175], v8 offset:16192
    s_waitcnt lgkmcnt(10)
    v_mfma_f32_32x32x16_bf16 v[116:131], v[152:155], v[180:183], 0
    ds_read_b64_tr_b16 v[176:177], v8 offset:15488
    ds_read_b64_tr_b16 v[178:179], v8 offset:16256
    s_waitcnt lgkmcnt(10)
    v_mfma_f32_32x32x16_bf16 v[36:51], v[156:159], v[184:187], v[36:51]
    ds_read_b64_tr_b16 v[132:133], v8 offset:6144
    ds_read_b64_tr_b16 v[134:135], v8 offset:6912
    s_add_u32 s49, s49, 65536
    buffer_load_dwordx4 v[232:235], v5, s[32:35], s49 offen sc1
    s_waitcnt lgkmcnt(10)
    v_mfma_f32_32x32x16_bf16 v[52:67], v[160:163], v[184:187], v[52:67]
    ds_read_b64_tr_b16 v[136:137], v8 offset:6208
    ds_read_b64_tr_b16 v[138:139], v8 offset:6976
    s_waitcnt lgkmcnt(10)
    v_mfma_f32_32x32x16_bf16 v[68:83], v[164:167], v[184:187], v[68:83]
    ds_read_b64_tr_b16 v[140:141], v8 offset:6272
    ds_read_b64_tr_b16 v[142:143], v8 offset:7040
    s_waitcnt lgkmcnt(10)
    v_mfma_f32_32x32x16_bf16 v[84:99], v[168:171], v[184:187], v[84:99]
    ds_read_b64_tr_b16 v[144:145], v8 offset:18432
    ds_read_b64_tr_b16 v[146:147], v8 offset:19200
    s_waitcnt lgkmcnt(10)
    v_mfma_f32_32x32x16_bf16 v[100:115], v[172:175], v[184:187], v[100:115]
    ds_read_b64_tr_b16 v[148:149], v8 offset:18496
    ds_read_b64_tr_b16 v[150:151], v8 offset:19264
    s_waitcnt lgkmcnt(10)
    v_mfma_f32_32x32x16_bf16 v[116:131], v[176:179], v[184:187], v[116:131]
    ds_read_b64_tr_b16 v[152:153], v8 offset:18560
    ds_read_b64_tr_b16 v[154:155], v8 offset:19328
    s_waitcnt lgkmcnt(10)
    v_mfma_f32_32x32x16_bf16 v[36:51], v[132:135], v[188:191], v[36:51]
    ds_read_b64_tr_b16 v[156:157], v8 offset:9216
    ds_read_b64_tr_b16 v[158:159], v8 offset:9984
    s_add_u32 s49, s49, 65536
    buffer_load_dwordx4 v[236:239], v5, s[32:35], s49 offen sc1
    s_waitcnt lgkmcnt(10)
    v_mfma_f32_32x32x16_bf16 v[52:67], v[136:139], v[188:191], v[52:67]
    ds_read_b64_tr_b16 v[160:161], v8 offset:9280
    ds_read_b64_tr_b16 v[162:163], v8 offset:10048
    s_waitcnt lgkmcnt(10)
    v_mfma_f32_32x32x16_bf16 v[68:83], v[140:143], v[188:191], v[68:83]
    ds_read_b64_tr_b16 v[164:165], v8 offset:9344
    ds_read_b64_tr_b16 v[166:167], v8 offset:10112
    s_waitcnt lgkmcnt(10)
    v_mfma_f32_32x32x16_bf16 v[84:99], v[144:147], v[188:191], v[84:99]
    ds_read_b64_tr_b16 v[168:169], v8 offset:21504
    ds_read_b64_tr_b16 v[170:171], v8 offset:22272
    s_waitcnt lgkmcnt(10)
    v_mfma_f32_32x32x16_bf16 v[100:115], v[148:151], v[188:191], v[100:115]
    ds_read_b64_tr_b16 v[172:173], v8 offset:21568
    ds_read_b64_tr_b16 v[174:175], v8 offset:22336
    s_waitcnt lgkmcnt(10)
    v_mfma_f32_32x32x16_bf16 v[116:131], v[152:155], v[188:191], v[116:131]
    ds_read_b64_tr_b16 v[176:177], v8 offset:21632
    ds_read_b64_tr_b16 v[178:179], v8 offset:22400
    s_waitcnt lgkmcnt(0)
    s_barrier
    v_mfma_f32_32x32x16_bf16 v[36:51], v[156:159], v[192:195], v[36:51]
    ds_read_b64_tr_b16 v[132:133], v8 offset:24576
    ds_read_b64_tr_b16 v[134:135], v8 offset:25344
    s_add_u32 s49, s49, 65536
    buffer_load_dwordx4 v[240:243], v5, s[32:35], s49 offen sc1
    s_waitcnt vmcnt(8)
    v_mfma_f32_32x32x16_bf16 v[52:67], v[160:163], v[192:195], v[52:67]
    ds_read_b64_tr_b16 v[136:137], v8 offset:24640
    ds_read_b64_tr_b16 v[138:139], v8 offset:25408
    v_max3_u32 v4, v196, v197, v198
    v_max3_u32 v4, v4, v199, v200
    v_mfma_f32_32x32x16_bf16 v[68:83], v[164:167], v[192:195], v[68:83]
    ds_read_b64_tr_b16 v[140:141], v8 offset:24704
    ds_read_b64_tr_b16 v[142:143], v8 offset:25472
    v_max3_u32 v4, v4, v201, v202
    v_mfma_f32_32x32x16_bf16 v[84:99], v[168:171], v[192:195], v[84:99]
    ds_read_b64_tr_b16 v[144:145], v8 offset:36864
    ds_read_b64_tr_b16 v[146:147], v8 offset:37632
    v_max3_u32 v4, v4, v203, v204
    v_max3_u32 v4, v4, v205, v206
    v_mfma_f32_32x32x16_bf16 v[100:115], v[172:175], v[192:195], v[100:115]
    ds_read_b64_tr_b16 v[148:149], v8 offset:36928
    ds_read_b64_tr_b16 v[150:151], v8 offset:37696
    v_max3_u32 v4, v4, v207, v208
    v_max3_u32 v4, v4, v209, v210
    v_mfma_f32_32x32x16_bf16 v[116:131], v[176:179], v[192:195], v[116:131]
    ds_read_b64_tr_b16 v[152:153], v8 offset:36992
    ds_read_b64_tr_b16 v[154:155], v8 offset:37760
    v_max_u32 v4, v4, v211
    v_cmp_eq_u32 vcc, -1, v4
    s_cbranch_vccnz SLOW_152
BACK_153:
    s_waitcnt lgkmcnt(10)
    v_mfma_f32_32x32x16_bf16 v[36:51], v[132:135], v[196:199], v[36:51]
    ds_read_b64_tr_b16 v[156:157], v8 offset:27648
    ds_read_b64_tr_b16 v[158:159], v8 offset:28416
    s_add_u32 s49, s76, 4
    s_sub_u32 s48, s49, 10
    s_cmp_ge_u32 s49, 10
    s_cselect_b32 s49, s48, s49
    s_lshl_b32 s49, s49, 18
    s_add_u32 s49, s49, s50
    buffer_load_dwordx4 v[180:183], v5, s[32:35], s49 offen sc1
    s_waitcnt lgkmcnt(10)
    v_mfma_f32_32x32x16_bf16 v[52:67], v[136:139], v[196:199], v[52:67]
    ds_read_b64_tr_b16 v[160:161], v8 offset:27712
    ds_read_b64_tr_b16 v[162:163], v8 offset:28480
    s_waitcnt lgkmcnt(10)
    v_mfma_f32_32x32x16_bf16 v[68:83], v[140:143], v[196:199], v[68:83]
    ds_read_b64_tr_b16 v[164:165], v8 offset:27776
    ds_read_b64_tr_b16 v[166:167], v8 offset:28544
    s_waitcnt lgkmcnt(10)
    v_mfma_f32_32x32x16_bf16 v[84:99], v[144:147], v[196:199], v[84:99]
    ds_read_b64_tr_b16 v[168:169], v8 offset:39936
    ds_read_b64_tr_b16 v[170:171], v8 offset:40704
    s_waitcnt lgkmcnt(10)
    v_mfma_f32_32x32x16_bf16 v[100:115], v[148:151], v[196:199], v[100:115]
    ds_read_b64_tr_b16 v[172:173], v8 offset:40000
    ds_read_b64_tr_b16 v[174:175], v8 offset:40768
    s_waitcnt lgkmcnt(10)
    v_mfma_f32_32x32x16_bf16 v[116:131], v[152:155], v[196:199], v[116:131]
    ds_read_b64_tr_b16 v[176:177], v8 offset:40064
    ds_read_b64_tr_b16 v[178:179], v8 offset:40832
    s_waitcnt lgkmcnt(10)
    v_mfma_f32_32x32x16_bf16 v[36:51], v[156:159], v[200:203], v[36:51]
    ds_read_b64_tr_b16 v[132:133], v8 offset:30720
    ds_read_b64_tr_b16 v[134:135], v8 offset:31488
    s_add_u32 s49, s49, 65536
    buffer_load_dwordx4 v[184:187], v5, s[32:35], s49 offen sc1
    s_waitcnt lgkmcnt(10)
    v_mfma_f32_32x32x16_bf16 v[52:67], v[160:163], v[200:203], v[52:67]
    ds_read_b64_tr_b16 v[136:137], v8 offset:30784
    ds_read_b64_tr_b16 v[138:139], v8 offset:31552
    s_waitcnt lgkmcnt(10)
    v_mfma_f32_32x32x16_bf16 v[68:83], v[164:167], v[200:203], v[68:83]
    ds_read_b64_tr_b16 v[140:141], v8 offset:30848
    ds_read_b64_tr_b16 v[142:143], v8 offset:31616
    s_waitcnt lgkmcnt(10)
    v_mfma_f32_32x32x16_bf16 v[84:99], v[168:171], v[200:203], v[84:99]
    ds_read_b64_tr_b16 v[144:145], v8 offset:43008
    ds_read_b64_tr_b16 v[146:147], v8 offset:43776
    s_waitcnt lgkmcnt(10)
    v_mfma_f32_32x32x16_bf16 v[100:115], v[172:175], v[200:203], v[100:115]
    ds_read_b64_tr_b16 v[148:149], v8 offset:43072
    ds_read_b64_tr_b16 v[150:151], v8 offset:43840
    s_waitcnt lgkmcnt(10)
    v_mfma_f32_32x32x16_bf16 v[116:131], v[176:179], v[200:203], v[116:131]
    ds_read_b64_tr_b16 v[152:153], v8 offset:43136
    ds_read_b64_tr_b16 v[154:155], v8 offset:43904
    s_waitcnt lgkmcnt(10)
    v_mfma_f32_32x32x16_bf16 v[36:51], v[132:135], v[204:207], v[36:51]
    ds_read_b64_tr_b16 v[156:157], v8 offset:33792
    ds_read_b64_tr_b16 v[158:159], v8 offset:34560
    s_add_u32 s49, s49, 65536
    buffer_load_dwordx4 v[188:191], v5, s[32:35], s49 offen sc1
    s_waitcnt lgkmcnt(10)
    v_mfma_f32_32x32x16_bf16 v[52:67], v[136:139], v[204:207], v[52:67]
    ds_read_b64_tr_b16 v[160:161], v8 offset:33856
    ds_read_b64_tr_b16 v[162:163], v8 offset:34624
    s_waitcnt lgkmcnt(10)
    v_mfma_f32_32x32x16_bf16 v[68:83], v[140:143], v[204:207], v[68:83]
    ds_read_b64_tr_b16 v[164:165], v8 offset:33920
    ds_read_b64_tr_b16 v[166:167], v8 offset:34688
    s_waitcnt lgkmcnt(10)
    v_mfma_f32_32x32x16_bf16 v[84:99], v[144:147], v[204:207], v[84:99]
    ds_read_b64_tr_b16 v[168:169], v8 offset:46080
    ds_read_b64_tr_b16 v[170:171], v8 offset:46848
    s_waitcnt lgkmcnt(10)
    v_mfma_f32_32x32x16_bf16 v[100:115], v[148:151], v[204:207], v[100:115]
    ds_read_b64_tr_b16 v[172:173], v8 offset:46144
    ds_read_b64_tr_b16 v[174:175], v8 offset:46912
    s_waitcnt lgkmcnt(10)
    v_mfma_f32_32x32x16_bf16 v[116:131], v[152:155], v[204:207], v[116:131]
    ds_read_b64_tr_b16 v[176:177], v8 offset:46208
    ds_read_b64_tr_b16 v[178:179], v8 offset:46976
    s_waitcnt lgkmcnt(0)
    s_barrier
    v_mfma_f32_32x32x16_bf16 v[36:51], v[156:159], v[208:211], v[36:51]
    ds_read_b64_tr_b16 v[132:133], v6 offset:0
    ds_read_b64_tr_b16 v[134:135], v6 offset:768
    s_add_u32 s49, s49, 65536
    buffer_load_dwordx4 v[192:195], v5, s[32:35], s49 offen sc1
    s_waitcnt vmcnt(8)
    v_mfma_f32_32x32x16_bf16 v[52:67], v[160:163], v[208:211], v[52:67]
    ds_read_b64_tr_b16 v[136:137], v6 offset:64
    ds_read_b64_tr_b16 v[138:139], v6 offset:832
    v_max3_u32 v4, v212, v213, v214
    v_max3_u32 v4, v4, v215, v216
    v_mfma_f32_32x32x16_bf16 v[68:83], v[164:167], v[208:211], v[68:83]
    ds_read_b64_tr_b16 v[140:141], v6 offset:128
    ds_read_b64_tr_b16 v[142:143], v6 offset:896
    v_max3_u32 v4, v4, v217, v218
    v_mfma_f32_32x32x16_bf16 v[84:99], v[168:171], v[208:211], v[84:99]
    ds_read_b64_tr_b16 v[144:145], v6 offset:12288
    ds_read_b64_tr_b16 v[146:147], v6 offset:13056
    v_max3_u32 v4, v4, v219, v220
    v_max3_u32 v4, v4, v221, v222
    v_mfma_f32_32x32x16_bf16 v[100:115], v[172:175], v[208:211], v[100:115]
    ds_read_b64_tr_b16 v[148:149], v6 offset:12352
    ds_read_b64_tr_b16 v[150:151], v6 offset:13120
    v_max3_u32 v4, v4, v223, v224
    v_max3_u32 v4, v4, v225, v226
    v_mfma_f32_32x32x16_bf16 v[116:131], v[176:179], v[208:211], v[116:131]
    ds_read_b64_tr_b16 v[152:153], v6 offset:12416
    ds_read_b64_tr_b16 v[154:155], v6 offset:13184
    v_max_u32 v4, v4, v227
    v_cmp_eq_u32 vcc, -1, v4
    s_cbranch_vccnz SLOW_155
BACK_156:
    s_waitcnt lgkmcnt(10)
    v_mfma_f32_32x32x16_bf16 v[36:51], v[132:135], v[212:215], v[36:51]
    ds_read_b64_tr_b16 v[156:157], v6 offset:3072
    ds_read_b64_tr_b16 v[158:159], v6 offset:3840
    s_add_u32 s49, s76, 5
    s_sub_u32 s48, s49, 10
    s_cmp_ge_u32 s49, 10
    s_cselect_b32 s49, s48, s49
    s_lshl_b32 s49, s49, 18
    s_add_u32 s49, s49, s50
    buffer_load_dwordx4 v[196:199], v5, s[32:35], s49 offen sc1
    s_waitcnt lgkmcnt(10)
    v_mfma_f32_32x32x16_bf16 v[52:67], v[136:139], v[212:215], v[52:67]
    ds_read_b64_tr_b16 v[160:161], v6 offset:3136
    ds_read_b64_tr_b16 v[162:163], v6 offset:3904
    s_waitcnt lgkmcnt(10)
    v_mfma_f32_32x32x16_bf16 v[68:83], v[140:143], v[212:215], v[68:83]
    ds_read_b64_tr_b16 v[164:165], v6 offset:3200
    ds_read_b64_tr_b16 v[166:167], v6 offset:3968
    s_waitcnt lgkmcnt(10)
    v_mfma_f32_32x32x16_bf16 v[84:99], v[144:147], v[212:215], v[84:99]
    ds_read_b64_tr_b16 v[168:169], v6 offset:15360
    ds_read_b64_tr_b16 v[170:171], v6 offset:16128
    s_waitcnt lgkmcnt(10)
    v_mfma_f32_32x32x16_bf16 v[100:115], v[148:151], v[212:215], v[100:115]
    ds_read_b64_tr_b16 v[172:173], v6 offset:15424
    ds_read_b64_tr_b16 v[174:175], v6 offset:16192
    s_waitcnt lgkmcnt(10)
    v_mfma_f32_32x32x16_bf16 v[116:131], v[152:155], v[212:215], v[116:131]
    ds_read_b64_tr_b16 v[176:177], v6 offset:15488
    ds_read_b64_tr_b16 v[178:179], v6 offset:16256
    s_waitcnt lgkmcnt(10)
    v_mfma_f32_32x32x16_bf16 v[36:51], v[156:159], v[216:219], v[36:51]
    ds_read_b64_tr_b16 v[132:133], v6 offset:6144
    ds_read_b64_tr_b16 v[134:135], v6 offset:6912
    s_add_u32 s49, s49, 65536
    buffer_load_dwordx4 v[200:203], v5, s[32:35], s49 offen sc1
    s_waitcnt lgkmcnt(10)
    v_mfma_f32_32x32x16_bf16 v[52:67], v[160:163], v[216:219], v[52:67]
    ds_read_b64_tr_b16 v[136:137], v6 offset:6208
    ds_read_b64_tr_b16 v[138:139], v6 offset:6976
    s_waitcnt lgkmcnt(10)
    v_mfma_f32_32x32x16_bf16 v[68:83], v[164:167], v[216:219], v[68:83]
    ds_read_b64_tr_b16 v[140:141], v6 offset:6272
    ds_read_b64_tr_b16 v[142:143], v6 offset:7040
    s_waitcnt lgkmcnt(10)
    v_mfma_f32_32x32x16_bf16 v[84:99], v[168:171], v[216:219], v[84:99]
    ds_read_b64_tr_b16 v[144:145], v6 offset:18432
    ds_read_b64_tr_b16 v[146:147], v6 offset:19200
    s_waitcnt lgkmcnt(10)
    v_mfma_f32_32x32x16_bf16 v[100:115], v[172:175], v[216:219], v[100:115]
    ds_read_b64_tr_b16 v[148:149], v6 offset:18496
    ds_read_b64_tr_b16 v[150:151], v6 offset:19264
    s_waitcnt lgkmcnt(10)
    v_mfma_f32_32x32x16_bf16 v[116:131], v[176:179], v[216:219], v[116:131]
    ds_read_b64_tr_b16 v[152:153], v6 offset:18560
    ds_read_b64_tr_b16 v[154:155], v6 offset:19328
    s_waitcnt lgkmcnt(10)
    v_mfma_f32_32x32x16_bf16 v[36:51], v[132:135], v[220:223], v[36:51]
    ds_read_b64_tr_b16 v[156:157], v6 offset:9216
    ds_read_b64_tr_b16 v[158:159], v6 offset:9984
    s_add_u32 s49, s49, 65536
    buffer_load_dwordx4 v[204:207], v5, s[32:35], s49 offen sc1
    s_waitcnt lgkmcnt(10)
    v_mfma_f32_32x32x16_bf16 v[52:67], v[136:139], v[220:223], v[52:67]
    ds_read_b64_tr_b16 v[160:161], v6 offset:9280
    ds_read_b64_tr_b16 v[162:163], v6 offset:10048
    s_waitcnt lgkmcnt(10)
    v_mfma_f32_32x32x16_bf16 v[68:83], v[140:143], v[220:223], v[68:83]
    ds_read_b64_tr_b16 v[164:165], v6 offset:9344
    ds_read_b64_tr_b16 v[166:167], v6 offset:10112
    s_waitcnt lgkmcnt(10)
    v_mfma_f32_32x32x16_bf16 v[84:99], v[144:147], v[220:223], v[84:99]
    ds_read_b64_tr_b16 v[168:169], v6 offset:21504
    ds_read_b64_tr_b16 v[170:171], v6 offset:22272
    s_waitcnt lgkmcnt(10)
    v_mfma_f32_32x32x16_bf16 v[100:115], v[148:151], v[220:223], v[100:115]
    ds_read_b64_tr_b16 v[172:173], v6 offset:21568
    ds_read_b64_tr_b16 v[174:175], v6 offset:22336
    s_waitcnt lgkmcnt(10)
    v_mfma_f32_32x32x16_bf16 v[116:131], v[152:155], v[220:223], v[116:131]
    ds_read_b64_tr_b16 v[176:177], v6 offset:21632
    ds_read_b64_tr_b16 v[178:179], v6 offset:22400
    s_waitcnt lgkmcnt(0)
    s_barrier
    v_mfma_f32_32x32x16_bf16 v[36:51], v[156:159], v[224:227], v[36:51]
    ds_read_b64_tr_b16 v[132:133], v6 offset:24576
    ds_read_b64_tr_b16 v[134:135], v6 offset:25344
    s_add_u32 s49, s49, 65536
    buffer_load_dwordx4 v[208:211], v5, s[32:35], s49 offen sc1
    s_waitcnt vmcnt(8)
    v_mfma_f32_32x32x16_bf16 v[52:67], v[160:163], v[224:227], v[52:67]
    ds_read_b64_tr_b16 v[136:137], v6 offset:24640
    ds_read_b64_tr_b16 v[138:139], v6 offset:25408
    v_max3_u32 v4, v228, v229, v230
    v_max3_u32 v4, v4, v231, v232
    v_mfma_f32_32x32x16_bf16 v[68:83], v[164:167], v[224:227], v[68:83]
    ds_read_b64_tr_b16 v[140:141], v6 offset:24704
    ds_read_b64_tr_b16 v[142:143], v6 offset:25472
    v_max3_u32 v4, v4, v233, v234
    v_mfma_f32_32x32x16_bf16 v[84:99], v[168:171], v[224:227], v[84:99]
    ds_read_b64_tr_b16 v[144:145], v6 offset:36864
    ds_read_b64_tr_b16 v[146:147], v6 offset:37632
    v_max3_u32 v4, v4, v235, v236
    v_max3_u32 v4, v4, v237, v238
    v_mfma_f32_32x32x16_bf16 v[100:115], v[172:175], v[224:227], v[100:115]
    ds_read_b64_tr_b16 v[148:149], v6 offset:36928
    ds_read_b64_tr_b16 v[150:151], v6 offset:37696
    v_max3_u32 v4, v4, v239, v240
    v_max3_u32 v4, v4, v241, v242
    v_mfma_f32_32x32x16_bf16 v[116:131], v[176:179], v[224:227], v[116:131]
    ds_read_b64_tr_b16 v[152:153], v6 offset:36992
    ds_read_b64_tr_b16 v[154:155], v6 offset:37760
    v_max_u32 v4, v4, v243
    v_cmp_eq_u32 vcc, -1, v4
    s_cbranch_vccnz SLOW_158
BACK_159:
    s_waitcnt lgkmcnt(10)
    v_mfma_f32_32x32x16_bf16 v[36:51], v[132:135], v[228:231], v[36:51]
    ds_read_b64_tr_b16 v[156:157], v6 offset:27648
    ds_read_b64_tr_b16 v[158:159], v6 offset:28416
    s_add_u32 s49, s76, 6
    s_sub_u32 s48, s49, 10
    s_cmp_ge_u32 s49, 10
    s_cselect_b32 s49, s48, s49
    s_lshl_b32 s49, s49, 18
    s_add_u32 s49, s49, s50
    buffer_load_dwordx4 v[212:215], v5, s[32:35], s49 offen sc1
    s_waitcnt lgkmcnt(10)
    v_mfma_f32_32x32x16_bf16 v[52:67], v[136:139], v[228:231], v[52:67]
    ds_read_b64_tr_b16 v[160:161], v6 offset:27712
    ds_read_b64_tr_b16 v[162:163], v6 offset:28480
    s_waitcnt lgkmcnt(10)
    v_mfma_f32_32x32x16_bf16 v[68:83], v[140:143], v[228:231], v[68:83]
    ds_read_b64_tr_b16 v[164:165], v6 offset:27776
    ds_read_b64_tr_b16 v[166:167], v6 offset:28544
    s_waitcnt lgkmcnt(10)
    v_mfma_f32_32x32x16_bf16 v[84:99], v[144:147], v[228:231], v[84:99]
    ds_read_b64_tr_b16 v[168:169], v6 offset:39936
    ds_read_b64_tr_b16 v[170:171], v6 offset:40704
    s_waitcnt lgkmcnt(10)
    v_mfma_f32_32x32x16_bf16 v[100:115], v[148:151], v[228:231], v[100:115]
    ds_read_b64_tr_b16 v[172:173], v6 offset:40000
    ds_read_b64_tr_b16 v[174:175], v6 offset:40768
    s_waitcnt lgkmcnt(10)
    v_mfma_f32_32x32x16_bf16 v[116:131], v[152:155], v[228:231], v[116:131]
    ds_read_b64_tr_b16 v[176:177], v6 offset:40064
    ds_read_b64_tr_b16 v[178:179], v6 offset:40832
    s_waitcnt lgkmcnt(10)
    v_mfma_f32_32x32x16_bf16 v[36:51], v[156:159], v[232:235], v[36:51]
    ds_read_b64_tr_b16 v[132:133], v6 offset:30720
    ds_read_b64_tr_b16 v[134:135], v6 offset:31488
    s_add_u32 s49, s49, 65536
    buffer_load_dwordx4 v[216:219], v5, s[32:35], s49 offen sc1
    s_waitcnt lgkmcnt(10)
    v_mfma_f32_32x32x16_bf16 v[52:67], v[160:163], v[232:235], v[52:67]
    ds_read_b64_tr_b16 v[136:137], v6 offset:30784
    ds_read_b64_tr_b16 v[138:139], v6 offset:31552
    s_waitcnt lgkmcnt(10)
    v_mfma_f32_32x32x16_bf16 v[68:83], v[164:167], v[232:235], v[68:83]
    ds_read_b64_tr_b16 v[140:141], v6 offset:30848
    ds_read_b64_tr_b16 v[142:143], v6 offset:31616
    s_waitcnt lgkmcnt(10)
    v_mfma_f32_32x32x16_bf16 v[84:99], v[168:171], v[232:235], v[84:99]
    ds_read_b64_tr_b16 v[144:145], v6 offset:43008
    ds_read_b64_tr_b16 v[146:147], v6 offset:43776
    s_waitcnt lgkmcnt(10)
    v_mfma_f32_32x32x16_bf16 v[100:115], v[172:175], v[232:235], v[100:115]
    ds_read_b64_tr_b16 v[148:149], v6 offset:43072
    ds_read_b64_tr_b16 v[150:151], v6 offset:43840
    s_waitcnt lgkmcnt(10)
    v_mfma_f32_32x32x16_bf16 v[116:131], v[176:179], v[232:235], v[116:131]
    ds_read_b64_tr_b16 v[152:153], v6 offset:43136
    ds_read_b64_tr_b16 v[154:155], v6 offset:43904
    s_waitcnt lgkmcnt(10)
    v_mfma_f32_32x32x16_bf16 v[36:51], v[132:135], v[236:239], v[36:51]
    ds_read_b64_tr_b16 v[156:157], v6 offset:33792
    ds_read_b64_tr_b16 v[158:159], v6 offset:34560
    s_add_u32 s49, s49, 65536
    buffer_load_dwordx4 v[220:223], v5, s[32:35], s49 offen sc1
    s_waitcnt lgkmcnt(10)
    v_mfma_f32_32x32x16_bf16 v[52:67], v[136:139], v[236:239], v[52:67]
    ds_read_b64_tr_b16 v[160:161], v6 offset:33856
    ds_read_b64_tr_b16 v[162:163], v6 offset:34624
    s_waitcnt lgkmcnt(10)
    v_mfma_f32_32x32x16_bf16 v[68:83], v[140:143], v[236:239], v[68:83]
    ds_read_b64_tr_b16 v[164:165], v6 offset:33920
    ds_read_b64_tr_b16 v[166:167], v6 offset:34688
    s_waitcnt lgkmcnt(10)
    v_mfma_f32_32x32x16_bf16 v[84:99], v[144:147], v[236:239], v[84:99]
    ds_read_b64_tr_b16 v[168:169], v6 offset:46080
    ds_read_b64_tr_b16 v[170:171], v6 offset:46848
    s_waitcnt lgkmcnt(10)
    v_mfma_f32_32x32x16_bf16 v[100:115], v[148:151], v[236:239], v[100:115]
    ds_read_b64_tr_b16 v[172:173], v6 offset:46144
    ds_read_b64_tr_b16 v[174:175], v6 offset:46912
    s_waitcnt lgkmcnt(10)
    v_mfma_f32_32x32x16_bf16 v[116:131], v[152:155], v[236:239], v[116:131]
    ds_read_b64_tr_b16 v[176:177], v6 offset:46208
    ds_read_b64_tr_b16 v[178:179], v6 offset:46976
    s_waitcnt lgkmcnt(0)
    s_barrier
    v_mfma_f32_32x32x16_bf16 v[36:51], v[156:159], v[240:243], v[36:51]
    ds_read_b64_tr_b16 v[132:133], v7 offset:0
    ds_read_b64_tr_b16 v[134:135], v7 offset:768
    s_add_u32 s49, s49, 65536
    buffer_load_dwordx4 v[224:227], v5, s[32:35], s49 offen sc1
    s_waitcnt vmcnt(8)
    v_mfma_f32_32x32x16_bf16 v[52:67], v[160:163], v[240:243], v[52:67]
    ds_read_b64_tr_b16 v[136:137], v7 offset:64
    ds_read_b64_tr_b16 v[138:139], v7 offset:832
    v_max3_u32 v4, v180, v181, v182
    v_max3_u32 v4, v4, v183, v184
    v_mfma_f32_32x32x16_bf16 v[68:83], v[164:167], v[240:243], v[68:83]
    ds_read_b64_tr_b16 v[140:141], v7 offset:128
    ds_read_b64_tr_b16 v[142:143], v7 offset:896
    v_max3_u32 v4, v4, v185, v186
    v_mfma_f32_32x32x16_bf16 v[84:99], v[168:171], v[240:243], v[84:99]
    ds_read_b64_tr_b16 v[144:145], v7 offset:12288
    ds_read_b64_tr_b16 v[146:147], v7 offset:13056
    v_max3_u32 v4, v4, v187, v188
    v_max3_u32 v4, v4, v189, v190
    v_mfma_f32_32x32x16_bf16 v[100:115], v[172:175], v[240:243], v[100:115]
    ds_read_b64_tr_b16 v[148:149], v7 offset:12352
    ds_read_b64_tr_b16 v[150:151], v7 offset:13120
    v_max3_u32 v4, v4, v191, v192
    v_max3_u32 v4, v4, v193, v194
    v_mfma_f32_32x32x16_bf16 v[116:131], v[176:179], v[240:243], v[116:131]
    ds_read_b64_tr_b16 v[152:153], v7 offset:12416
    ds_read_b64_tr_b16 v[154:155], v7 offset:13184
    v_max_u32 v4, v4, v195
    v_cmp_eq_u32 vcc, -1, v4
    s_cbranch_vccnz SLOW_161
BACK_162:
    s_waitcnt lgkmcnt(10)
    v_mfma_f32_32x32x16_bf16 v[36:51], v[132:135], v[180:183], v[36:51]
    ds_read_b64_tr_b16 v[156:157], v7 offset:3072
    ds_read_b64_tr_b16 v[158:159], v7 offset:3840
    s_add_u32 s49, s76, 7
    s_sub_u32 s48, s49, 10
    s_cmp_ge_u32 s49, 10
    s_cselect_b32 s49, s48, s49
    s_lshl_b32 s49, s49, 18
    s_add_u32 s49, s49, s50
    buffer_load_dwordx4 v[228:231], v5, s[32:35], s49 offen sc1
    s_waitcnt lgkmcnt(10)
    v_mfma_f32_32x32x16_bf16 v[52:67], v[136:139], v[180:183], v[52:67]
    ds_read_b64_tr_b16 v[160:161], v7 offset:3136
    ds_read_b64_tr_b16 v[162:163], v7 offset:3904
    s_waitcnt lgkmcnt(10)
    v_mfma_f32_32x32x16_bf16 v[68:83], v[140:143], v[180:183], v[68:83]
    ds_read_b64_tr_b16 v[164:165], v7 offset:3200
    ds_read_b64_tr_b16 v[166:167], v7 offset:3968
    s_waitcnt lgkmcnt(10)
    v_mfma_f32_32x32x16_bf16 v[84:99], v[144:147], v[180:183], v[84:99]
    ds_read_b64_tr_b16 v[168:169], v7 offset:15360
    ds_read_b64_tr_b16 v[170:171], v7 offset:16128
    s_waitcnt lgkmcnt(10)
    v_mfma_f32_32x32x16_bf16 v[100:115], v[148:151], v[180:183], v[100:115]
    ds_read_b64_tr_b16 v[172:173], v7 offset:15424
    ds_read_b64_tr_b16 v[174:175], v7 offset:16192
    s_waitcnt lgkmcnt(10)
    v_mfma_f32_32x32x16_bf16 v[116:131], v[152:155], v[180:183], v[116:131]
    ds_read_b64_tr_b16 v[176:177], v7 offset:15488
    ds_read_b64_tr_b16 v[178:179], v7 offset:16256
    s_waitcnt lgkmcnt(10)
    v_mfma_f32_32x32x16_bf16 v[36:51], v[156:159], v[184:187], v[36:51]
    ds_read_b64_tr_b16 v[132:133], v7 offset:6144
    ds_read_b64_tr_b16 v[134:135], v7 offset:6912
    s_add_u32 s49, s49, 65536
    buffer_load_dwordx4 v[232:235], v5, s[32:35], s49 offen sc1
    s_waitcnt lgkmcnt(10)
    v_mfma_f32_32x32x16_bf16 v[52:67], v[160:163], v[184:187], v[52:67]
    ds_read_b64_tr_b16 v[136:137], v7 offset:6208
    ds_read_b64_tr_b16 v[138:139], v7 offset:6976
    s_waitcnt lgkmcnt(10)
    v_mfma_f32_32x32x16_bf16 v[68:83], v[164:167], v[184:187], v[68:83]
    ds_read_b64_tr_b16 v[140:141], v7 offset:6272
    ds_read_b64_tr_b16 v[142:143], v7 offset:7040
    s_waitcnt lgkmcnt(10)
    v_mfma_f32_32x32x16_bf16 v[84:99], v[168:171], v[184:187], v[84:99]
    ds_read_b64_tr_b16 v[144:145], v7 offset:18432
    ds_read_b64_tr_b16 v[146:147], v7 offset:19200
    s_waitcnt lgkmcnt(10)
    v_mfma_f32_32x32x16_bf16 v[100:115], v[172:175], v[184:187], v[100:115]
    ds_read_b64_tr_b16 v[148:149], v7 offset:18496
    ds_read_b64_tr_b16 v[150:151], v7 offset:19264
    s_waitcnt lgkmcnt(10)
    v_mfma_f32_32x32x16_bf16 v[116:131], v[176:179], v[184:187], v[116:131]
    ds_read_b64_tr_b16 v[152:153], v7 offset:18560
    ds_read_b64_tr_b16 v[154:155], v7 offset:19328
    s_waitcnt lgkmcnt(10)
    v_mfma_f32_32x32x16_bf16 v[36:51], v[132:135], v[188:191], v[36:51]
    ds_read_b64_tr_b16 v[156:157], v7 offset:9216
    ds_read_b64_tr_b16 v[158:159], v7 offset:9984
    s_add_u32 s49, s49, 65536
    buffer_load_dwordx4 v[236:239], v5, s[32:35], s49 offen sc1
    s_waitcnt lgkmcnt(10)
    v_mfma_f32_32x32x16_bf16 v[52:67], v[136:139], v[188:191], v[52:67]
    ds_read_b64_tr_b16 v[160:161], v7 offset:9280
    ds_read_b64_tr_b16 v[162:163], v7 offset:10048
    s_waitcnt lgkmcnt(10)
    v_mfma_f32_32x32x16_bf16 v[68:83], v[140:143], v[188:191], v[68:83]
    ds_read_b64_tr_b16 v[164:165], v7 offset:9344
    ds_read_b64_tr_b16 v[166:167], v7 offset:10112
    s_waitcnt lgkmcnt(10)
    v_mfma_f32_32x32x16_bf16 v[84:99], v[144:147], v[188:191], v[84:99]
    ds_read_b64_tr_b16 v[168:169], v7 offset:21504
    ds_read_b64_tr_b16 v[170:171], v7 offset:22272
    s_waitcnt lgkmcnt(10)
    v_mfma_f32_32x32x16_bf16 v[100:115], v[148:151], v[188:191], v[100:115]
    ds_read_b64_tr_b16 v[172:173], v7 offset:21568
    ds_read_b64_tr_b16 v[174:175], v7 offset:22336
    s_waitcnt lgkmcnt(10)
    v_mfma_f32_32x32x16_bf16 v[116:131], v[152:155], v[188:191], v[116:131]
    ds_read_b64_tr_b16 v[176:177], v7 offset:21632
    ds_read_b64_tr_b16 v[178:179], v7 offset:22400
    s_waitcnt lgkmcnt(0)
    s_barrier
    v_mfma_f32_32x32x16_bf16 v[36:51], v[156:159], v[192:195], v[36:51]
    ds_read_b64_tr_b16 v[132:133], v7 offset:24576
    ds_read_b64_tr_b16 v[134:135], v7 offset:25344
    s_add_u32 s49, s49, 65536
    buffer_load_dwordx4 v[240:243], v5, s[32:35], s49 offen sc1
    s_waitcnt vmcnt(8)
    v_mfma_f32_32x32x16_bf16 v[52:67], v[160:163], v[192:195], v[52:67]
    ds_read_b64_tr_b16 v[136:137], v7 offset:24640
    ds_read_b64_tr_b16 v[138:139], v7 offset:25408
    v_max3_u32 v4, v196, v197, v198
    v_max3_u32 v4, v4, v199, v200
    v_mfma_f32_32x32x16_bf16 v[68:83], v[164:167], v[192:195], v[68:83]
    ds_read_b64_tr_b16 v[140:141], v7 offset:24704
    ds_read_b64_tr_b16 v[142:143], v7 offset:25472
    v_max3_u32 v4, v4, v201, v202
    v_mfma_f32_32x32x16_bf16 v[84:99], v[168:171], v[192:195], v[84:99]
    ds_read_b64_tr_b16 v[144:145], v7 offset:36864
    ds_read_b64_tr_b16 v[146:147], v7 offset:37632
    v_max3_u32 v4, v4, v203, v204
    v_max3_u32 v4, v4, v205, v206
    v_mfma_f32_32x32x16_bf16 v[100:115], v[172:175], v[192:195], v[100:115]
    ds_read_b64_tr_b16 v[148:149], v7 offset:36928
    ds_read_b64_tr_b16 v[150:151], v7 offset:37696
    v_max3_u32 v4, v4, v207, v208
    v_max3_u32 v4, v4, v209, v210
    v_mfma_f32_32x32x16_bf16 v[116:131], v[176:179], v[192:195], v[116:131]
    ds_read_b64_tr_b16 v[152:153], v7 offset:36992
    ds_read_b64_tr_b16 v[154:155], v7 offset:37760
    v_max_u32 v4, v4, v211
    v_cmp_eq_u32 vcc, -1, v4
    s_cbranch_vccnz SLOW_164
BACK_165:
    s_waitcnt lgkmcnt(10)
    v_mfma_f32_32x32x16_bf16 v[36:51], v[132:135], v[196:199], v[36:51]
    ds_read_b64_tr_b16 v[156:157], v7 offset:27648
    ds_read_b64_tr_b16 v[158:159], v7 offset:28416
    s_add_u32 s49, s76, 8
    s_sub_u32 s48, s49, 10
    s_cmp_ge_u32 s49, 10
    s_cselect_b32 s49, s48, s49
    s_lshl_b32 s49, s49, 18
    s_add_u32 s49, s49, s50
    buffer_load_dwordx4 v[180:183], v5, s[32:35], s49 offen sc1
    s_waitcnt lgkmcnt(10)
    v_mfma_f32_32x32x16_bf16 v[52:67], v[136:139], v[196:199], v[52:67]
    ds_read_b64_tr_b16 v[160:161], v7 offset:27712
    ds_read_b64_tr_b16 v[162:163], v7 offset:28480
    s_waitcnt lgkmcnt(10)
    v_mfma_f32_32x32x16_bf16 v[68:83], v[140:143], v[196:199], v[68:83]
    ds_read_b64_tr_b16 v[164:165], v7 offset:27776
    ds_read_b64_tr_b16 v[166:167], v7 offset:28544
    s_waitcnt lgkmcnt(10)
    v_mfma_f32_32x32x16_bf16 v[84:99], v[144:147], v[196:199], v[84:99]
    ds_read_b64_tr_b16 v[168:169], v7 offset:39936
    ds_read_b64_tr_b16 v[170:171], v7 offset:40704
    s_waitcnt lgkmcnt(10)
    v_mfma_f32_32x32x16_bf16 v[100:115], v[148:151], v[196:199], v[100:115]
    ds_read_b64_tr_b16 v[172:173], v7 offset:40000
    ds_read_b64_tr_b16 v[174:175], v7 offset:40768
    s_waitcnt lgkmcnt(10)
    v_mfma_f32_32x32x16_bf16 v[116:131], v[152:155], v[196:199], v[116:131]
    ds_read_b64_tr_b16 v[176:177], v7 offset:40064
    ds_read_b64_tr_b16 v[178:179], v7 offset:40832
    s_waitcnt lgkmcnt(10)
    v_mfma_f32_32x32x16_bf16 v[36:51], v[156:159], v[200:203], v[36:51]
    ds_read_b64_tr_b16 v[132:133], v7 offset:30720
    ds_read_b64_tr_b16 v[134:135], v7 offset:31488
    s_add_u32 s49, s49, 65536
    buffer_load_dwordx4 v[184:187], v5, s[32:35], s49 offen sc1
    s_waitcnt lgkmcnt(10)
    v_mfma_f32_32x32x16_bf16 v[52:67], v[160:163], v[200:203], v[52:67]
    ds_read_b64_tr_b16 v[136:137], v7 offset:30784
    ds_read_b64_tr_b16 v[138:139], v7 offset:31552
    s_waitcnt lgkmcnt(10)
    v_mfma_f32_32x32x16_bf16 v[68:83], v[164:167], v[200:203], v[68:83]
    ds_read_b64_tr_b16 v[140:141], v7 offset:30848
    ds_read_b64_tr_b16 v[142:143], v7 offset:31616
    s_waitcnt lgkmcnt(10)
    v_mfma_f32_32x32x16_bf16 v[84:99], v[168:171], v[200:203], v[84:99]
    ds_read_b64_tr_b16 v[144:145], v7 offset:43008
    ds_read_b64_tr_b16 v[146:147], v7 offset:43776
    s_waitcnt lgkmcnt(10)
    v_mfma_f32_32x32x16_bf16 v[100:115], v[172:175], v[200:203], v[100:115]
    ds_read_b64_tr_b16 v[148:149], v7 offset:43072
    ds_read_b64_tr_b16 v[150:151], v7 offset:43840
    s_waitcnt lgkmcnt(10)
    v_mfma_f32_32x32x16_bf16 v[116:131], v[176:179], v[200:203], v[116:131]
    ds_read_b64_tr_b16 v[152:153], v7 offset:43136
    ds_read_b64_tr_b16 v[154:155], v7 offset:43904
    s_waitcnt lgkmcnt(10)
    v_mfma_f32_32x32x16_bf16 v[36:51], v[132:135], v[204:207], v[36:51]
    ds_read_b64_tr_b16 v[156:157], v7 offset:33792
    ds_read_b64_tr_b16 v[158:159], v7 offset:34560
    s_add_u32 s49, s49, 65536
    buffer_load_dwordx4 v[188:191], v5, s[32:35], s49 offen sc1
    s_waitcnt lgkmcnt(10)
    v_mfma_f32_32x32x16_bf16 v[52:67], v[136:139], v[204:207], v[52:67]
    ds_read_b64_tr_b16 v[160:161], v7 offset:33856
    ds_read_b64_tr_b16 v[162:163], v7 offset:34624
    s_waitcnt lgkmcnt(10)
    v_mfma_f32_32x32x16_bf16 v[68:83], v[140:143], v[204:207], v[68:83]
    ds_read_b64_tr_b16 v[164:165], v7 offset:33920
    ds_read_b64_tr_b16 v[166:167], v7 offset:34688
    s_waitcnt lgkmcnt(10)
    v_mfma_f32_32x32x16_bf16 v[84:99], v[144:147], v[204:207], v[84:99]
    ds_read_b64_tr_b16 v[168:169], v7 offset:46080
    ds_read_b64_tr_b16 v[170:171], v7 offset:46848
    s_waitcnt lgkmcnt(10)
    v_mfma_f32_32x32x16_bf16 v[100:115], v[148:151], v[204:207], v[100:115]
    ds_read_b64_tr_b16 v[172:173], v7 offset:46144
    ds_read_b64_tr_b16 v[174:175], v7 offset:46912
    s_waitcnt lgkmcnt(10)
    v_mfma_f32_32x32x16_bf16 v[116:131], v[152:155], v[204:207], v[116:131]
    ds_read_b64_tr_b16 v[176:177], v7 offset:46208
    ds_read_b64_tr_b16 v[178:179], v7 offset:46976
    s_waitcnt lgkmcnt(0)
    s_barrier
    v_mfma_f32_32x32x16_bf16 v[36:51], v[156:159], v[208:211], v[36:51]
    ds_read_b64_tr_b16 v[132:133], v8 offset:0
    ds_read_b64_tr_b16 v[134:135], v8 offset:768
    s_add_u32 s49, s49, 65536
    buffer_load_dwordx4 v[192:195], v5, s[32:35], s49 offen sc1
    s_waitcnt vmcnt(8)
    v_mfma_f32_32x32x16_bf16 v[52:67], v[160:163], v[208:211], v[52:67]
    ds_read_b64_tr_b16 v[136:137], v8 offset:64
    ds_read_b64_tr_b16 v[138:139], v8 offset:832
    v_max3_u32 v4, v212, v213, v214
    v_max3_u32 v4, v4, v215, v216
    v_mfma_f32_32x32x16_bf16 v[68:83], v[164:167], v[208:211], v[68:83]
    ds_read_b64_tr_b16 v[140:141], v8 offset:128
    ds_read_b64_tr_b16 v[142:143], v8 offset:896
    v_max3_u32 v4, v4, v217, v218
    v_mfma_f32_32x32x16_bf16 v[84:99], v[168:171], v[208:211], v[84:99]
    ds_read_b64_tr_b16 v[144:145], v8 offset:12288
    ds_read_b64_tr_b16 v[146:147], v8 offset:13056
    v_max3_u32 v4, v4, v219, v220
    v_max3_u32 v4, v4, v221, v222
    v_mfma_f32_32x32x16_bf16 v[100:115], v[172:175], v[208:211], v[100:115]
    ds_read_b64_tr_b16 v[148:149], v8 offset:12352
    ds_read_b64_tr_b16 v[150:151], v8 offset:13120
    v_max3_u32 v4, v4, v223, v224
    v_max3_u32 v4, v4, v225, v226
    v_mfma_f32_32x32x16_bf16 v[116:131], v[176:179], v[208:211], v[116:131]
    ds_read_b64_tr_b16 v[152:153], v8 offset:12416
    ds_read_b64_tr_b16 v[154:155], v8 offset:13184
    v_max_u32 v4, v4, v227
    v_cmp_eq_u32 vcc, -1, v4
    s_cbranch_vccnz SLOW_167
BACK_168:
    s_waitcnt lgkmcnt(10)
    v_mfma_f32_32x32x16_bf16 v[36:51], v[132:135], v[212:215], v[36:51]
    ds_read_b64_tr_b16 v[156:157], v8 offset:3072
    ds_read_b64_tr_b16 v[158:159], v8 offset:3840
    s_add_u32 s49, s76, 9
    s_sub_u32 s48, s49, 10
    s_cmp_ge_u32 s49, 10
    s_cselect_b32 s49, s48, s49
    s_lshl_b32 s49, s49, 18
    s_add_u32 s49, s49, s50
    buffer_load_dwordx4 v[196:199], v5, s[32:35], s49 offen sc1
    s_waitcnt lgkmcnt(10)
    v_mfma_f32_32x32x16_bf16 v[52:67], v[136:139], v[212:215], v[52:67]
    ds_read_b64_tr_b16 v[160:161], v8 offset:3136
    ds_read_b64_tr_b16 v[162:163], v8 offset:3904
    s_waitcnt lgkmcnt(10)
    v_mfma_f32_32x32x16_bf16 v[68:83], v[140:143], v[212:215], v[68:83]
    ds_read_b64_tr_b16 v[164:165], v8 offset:3200
    ds_read_b64_tr_b16 v[166:167], v8 offset:3968
    s_waitcnt lgkmcnt(10)
    v_mfma_f32_32x32x16_bf16 v[84:99], v[144:147], v[212:215], v[84:99]
    ds_read_b64_tr_b16 v[168:169], v8 offset:15360
    ds_read_b64_tr_b16 v[170:171], v8 offset:16128
    s_waitcnt lgkmcnt(10)
    v_mfma_f32_32x32x16_bf16 v[100:115], v[148:151], v[212:215], v[100:115]
    ds_read_b64_tr_b16 v[172:173], v8 offset:15424
    ds_read_b64_tr_b16 v[174:175], v8 offset:16192
    s_waitcnt lgkmcnt(10)
    v_mfma_f32_32x32x16_bf16 v[116:131], v[152:155], v[212:215], v[116:131]
    ds_read_b64_tr_b16 v[176:177], v8 offset:15488
    ds_read_b64_tr_b16 v[178:179], v8 offset:16256
    s_waitcnt lgkmcnt(10)
    v_mfma_f32_32x32x16_bf16 v[36:51], v[156:159], v[216:219], v[36:51]
    ds_read_b64_tr_b16 v[132:133], v8 offset:6144
    ds_read_b64_tr_b16 v[134:135], v8 offset:6912
    s_add_u32 s49, s49, 65536
    buffer_load_dwordx4 v[200:203], v5, s[32:35], s49 offen sc1
    s_waitcnt lgkmcnt(10)
    v_mfma_f32_32x32x16_bf16 v[52:67], v[160:163], v[216:219], v[52:67]
    ds_read_b64_tr_b16 v[136:137], v8 offset:6208
    ds_read_b64_tr_b16 v[138:139], v8 offset:6976
    s_waitcnt lgkmcnt(10)
    v_mfma_f32_32x32x16_bf16 v[68:83], v[164:167], v[216:219], v[68:83]
    ds_read_b64_tr_b16 v[140:141], v8 offset:6272
    ds_read_b64_tr_b16 v[142:143], v8 offset:7040
    s_waitcnt lgkmcnt(10)
    v_mfma_f32_32x32x16_bf16 v[84:99], v[168:171], v[216:219], v[84:99]
    ds_read_b64_tr_b16 v[144:145], v8 offset:18432
    ds_read_b64_tr_b16 v[146:147], v8 offset:19200
    s_waitcnt lgkmcnt(10)
    v_mfma_f32_32x32x16_bf16 v[100:115], v[172:175], v[216:219], v[100:115]
    ds_read_b64_tr_b16 v[148:149], v8 offset:18496
    ds_read_b64_tr_b16 v[150:151], v8 offset:19264
    s_waitcnt lgkmcnt(10)
    v_mfma_f32_32x32x16_bf16 v[116:131], v[176:179], v[216:219], v[116:131]
    ds_read_b64_tr_b16 v[152:153], v8 offset:18560
    ds_read_b64_tr_b16 v[154:155], v8 offset:19328
    s_waitcnt lgkmcnt(10)
    v_mfma_f32_32x32x16_bf16 v[36:51], v[132:135], v[220:223], v[36:51]
    ds_read_b64_tr_b16 v[156:157], v8 offset:9216
    ds_read_b64_tr_b16 v[158:159], v8 offset:9984
    s_add_u32 s49, s49, 65536
    buffer_load_dwordx4 v[204:207], v5, s[32:35], s49 offen sc1
    s_waitcnt lgkmcnt(10)
    v_mfma_f32_32x32x16_bf16 v[52:67], v[136:139], v[220:223], v[52:67]
    ds_read_b64_tr_b16 v[160:161], v8 offset:9280
    ds_read_b64_tr_b16 v[162:163], v8 offset:10048
    s_waitcnt lgkmcnt(10)
    v_mfma_f32_32x32x16_bf16 v[68:83], v[140:143], v[220:223], v[68:83]
    ds_read_b64_tr_b16 v[164:165], v8 offset:9344
    ds_read_b64_tr_b16 v[166:167], v8 offset:10112
    s_waitcnt lgkmcnt(10)
    v_mfma_f32_32x32x16_bf16 v[84:99], v[144:147], v[220:223], v[84:99]
    ds_read_b64_tr_b16 v[168:169], v8 offset:21504
    ds_read_b64_tr_b16 v[170:171], v8 offset:22272
    s_waitcnt lgkmcnt(10)
    v_mfma_f32_32x32x16_bf16 v[100:115], v[148:151], v[220:223], v[100:115]
    ds_read_b64_tr_b16 v[172:173], v8 offset:21568
    ds_read_b64_tr_b16 v[174:175], v8 offset:22336
    s_waitcnt lgkmcnt(10)
    v_mfma_f32_32x32x16_bf16 v[116:131], v[152:155], v[220:223], v[116:131]
    ds_read_b64_tr_b16 v[176:177], v8 offset:21632
    ds_read_b64_tr_b16 v[178:179], v8 offset:22400
    s_waitcnt lgkmcnt(10)
    v_mfma_f32_32x32x16_bf16 v[36:51], v[156:159], v[224:227], v[36:51]
    ds_read_b64_tr_b16 v[132:133], v8 offset:24576
    ds_read_b64_tr_b16 v[134:135], v8 offset:25344
    s_add_u32 s49, s49, 65536
    buffer_load_dwordx4 v[208:211], v5, s[32:35], s49 offen sc1
    s_waitcnt vmcnt(8)
    s_waitcnt lgkmcnt(10)
    v_mfma_f32_32x32x16_bf16 v[52:67], v[160:163], v[224:227], v[52:67]
    ds_read_b64_tr_b16 v[136:137], v8 offset:24640
    ds_read_b64_tr_b16 v[138:139], v8 offset:25408
    v_max3_u32 v4, v228, v229, v230
    v_max3_u32 v4, v4, v231, v232
    s_waitcnt lgkmcnt(10)
    v_mfma_f32_32x32x16_bf16 v[68:83], v[164:167], v[224:227], v[68:83]
    ds_read_b64_tr_b16 v[140:141], v8 offset:24704
    ds_read_b64_tr_b16 v[142:143], v8 offset:25472
    v_max3_u32 v4, v4, v233, v234
    s_waitcnt lgkmcnt(10)
    v_mfma_f32_32x32x16_bf16 v[84:99], v[168:171], v[224:227], v[84:99]
    ds_read_b64_tr_b16 v[144:145], v8 offset:36864
    ds_read_b64_tr_b16 v[146:147], v8 offset:37632
    v_max3_u32 v4, v4, v235, v236
    v_max3_u32 v4, v4, v237, v238
    s_waitcnt lgkmcnt(10)
    v_mfma_f32_32x32x16_bf16 v[100:115], v[172:175], v[224:227], v[100:115]
    ds_read_b64_tr_b16 v[148:149], v8 offset:36928
    ds_read_b64_tr_b16 v[150:151], v8 offset:37696
    v_max3_u32 v4, v4, v239, v240
    v_max3_u32 v4, v4, v241, v242
    s_waitcnt lgkmcnt(10)
    v_mfma_f32_32x32x16_bf16 v[116:131], v[176:179], v[224:227], v[116:131]
    ds_read_b64_tr_b16 v[152:153], v8 offset:36992
    ds_read_b64_tr_b16 v[154:155], v8 offset:37760
    v_max_u32 v4, v4, v243
    v_cmp_eq_u32 vcc, -1, v4
    s_cbranch_vccnz SLOW_170
BACK_171:
    s_waitcnt lgkmcnt(10)
    v_mfma_f32_32x32x16_bf16 v[36:51], v[132:135], v[228:231], v[36:51]
    ds_read_b64_tr_b16 v[156:157], v8 offset:27648
    ds_read_b64_tr_b16 v[158:159], v8 offset:28416
    s_add_u32 s58, s51, 0
    buffer_load_dwordx2 v[20:21], v9, s[32:35], s58 offen sc1
    s_add_u32 s58, s51, 16384
    buffer_load_dwordx2 v[22:23], v9, s[32:35], s58 offen sc1
    s_add_u32 s58, s51, 32768
    buffer_load_dwordx2 v[24:25], v9, s[32:35], s58 offen sc1
    s_add_u32 s58, s51, 49152
    buffer_load_dwordx2 v[26:27], v9, s[32:35], s58 offen sc1
    s_waitcnt lgkmcnt(10)
    v_mfma_f32_32x32x16_bf16 v[52:67], v[136:139], v[228:231], v[52:67]
    ds_read_b64_tr_b16 v[160:161], v8 offset:27712
    ds_read_b64_tr_b16 v[162:163], v8 offset:28480
    s_waitcnt lgkmcnt(10)
    v_mfma_f32_32x32x16_bf16 v[68:83], v[140:143], v[228:231], v[68:83]
    ds_read_b64_tr_b16 v[164:165], v8 offset:27776
    ds_read_b64_tr_b16 v[166:167], v8 offset:28544
    s_waitcnt lgkmcnt(10)
    v_mfma_f32_32x32x16_bf16 v[84:99], v[144:147], v[228:231], v[84:99]
    ds_read_b64_tr_b16 v[168:169], v8 offset:39936
    ds_read_b64_tr_b16 v[170:171], v8 offset:40704
    s_waitcnt lgkmcnt(10)
    v_mfma_f32_32x32x16_bf16 v[100:115], v[148:151], v[228:231], v[100:115]
    ds_read_b64_tr_b16 v[172:173], v8 offset:40000
    ds_read_b64_tr_b16 v[174:175], v8 offset:40768
    s_waitcnt lgkmcnt(10)
    v_mfma_f32_32x32x16_bf16 v[116:131], v[152:155], v[228:231], v[116:131]
    ds_read_b64_tr_b16 v[176:177], v8 offset:40064
    ds_read_b64_tr_b16 v[178:179], v8 offset:40832
    s_waitcnt lgkmcnt(10)
    v_mfma_f32_32x32x16_bf16 v[36:51], v[156:159], v[232:235], v[36:51]
    ds_read_b64_tr_b16 v[132:133], v8 offset:30720
    ds_read_b64_tr_b16 v[134:135], v8 offset:31488
    s_waitcnt lgkmcnt(10)
    v_mfma_f32_32x32x16_bf16 v[52:67], v[160:163], v[232:235], v[52:67]
    ds_read_b64_tr_b16 v[136:137], v8 offset:30784
    ds_read_b64_tr_b16 v[138:139], v8 offset:31552
    s_waitcnt lgkmcnt(10)
    v_mfma_f32_32x32x16_bf16 v[68:83], v[164:167], v[232:235], v[68:83]
    ds_read_b64_tr_b16 v[140:141], v8 offset:30848
    ds_read_b64_tr_b16 v[142:143], v8 offset:31616
    s_waitcnt lgkmcnt(10)
    v_mfma_f32_32x32x16_bf16 v[84:99], v[168:171], v[232:235], v[84:99]
    ds_read_b64_tr_b16 v[144:145], v8 offset:43008
    ds_read_b64_tr_b16 v[146:147], v8 offset:43776
    s_waitcnt lgkmcnt(10)
    v_mfma_f32_32x32x16_bf16 v[100:115], v[172:175], v[232:235], v[100:115]
    ds_read_b64_tr_b16 v[148:149], v8 offset:43072
    ds_read_b64_tr_b16 v[150:151], v8 offset:43840
    s_waitcnt lgkmcnt(10)
    v_mfma_f32_32x32x16_bf16 v[116:131], v[176:179], v[232:235], v[116:131]
    ds_read_b64_tr_b16 v[152:153], v8 offset:43136
    ds_read_b64_tr_b16 v[154:155], v8 offset:43904
    s_waitcnt lgkmcnt(10)
    v_mfma_f32_32x32x16_bf16 v[36:51], v[132:135], v[236:239], v[36:51]
    ds_read_b64_tr_b16 v[156:157], v8 offset:33792
    ds_read_b64_tr_b16 v[158:159], v8 offset:34560
    s_waitcnt lgkmcnt(10)
    v_mfma_f32_32x32x16_bf16 v[52:67], v[136:139], v[236:239], v[52:67]
    ds_read_b64_tr_b16 v[160:161], v8 offset:33856
    ds_read_b64_tr_b16 v[162:163], v8 offset:34624
    s_waitcnt lgkmcnt(10)
    v_mfma_f32_32x32x16_bf16 v[68:83], v[140:143], v[236:239], v[68:83]
    ds_read_b64_tr_b16 v[164:165], v8 offset:33920
    ds_read_b64_tr_b16 v[166:167], v8 offset:34688
    s_waitcnt lgkmcnt(10)
    v_mfma_f32_32x32x16_bf16 v[84:99], v[144:147], v[236:239], v[84:99]
    ds_read_b64_tr_b16 v[168:169], v8 offset:46080
    ds_read_b64_tr_b16 v[170:171], v8 offset:46848
    s_waitcnt lgkmcnt(10)
    v_mfma_f32_32x32x16_bf16 v[100:115], v[148:151], v[236:239], v[100:115]
    ds_read_b64_tr_b16 v[172:173], v8 offset:46144
    ds_read_b64_tr_b16 v[174:175], v8 offset:46912
    s_waitcnt lgkmcnt(10)
    v_mfma_f32_32x32x16_bf16 v[116:131], v[152:155], v[236:239], v[116:131]
    ds_read_b64_tr_b16 v[176:177], v8 offset:46208
    ds_read_b64_tr_b16 v[178:179], v8 offset:46976
    s_waitcnt lgkmcnt(10)
    v_mfma_f32_32x32x16_bf16 v[36:51], v[156:159], v[240:243], v[36:51]
    ds_read_b64_tr_b16 v[132:133], v6 offset:0
    ds_read_b64_tr_b16 v[134:135], v6 offset:768
    s_waitcnt vmcnt(8)
    v_max3_u32 v4, v180, v181, v182
    s_waitcnt lgkmcnt(10)
    v_mfma_f32_32x32x16_bf16 v[52:67], v[160:163], v[240:243], v[52:67]
    ds_read_b64_tr_b16 v[136:137], v6 offset:64
    ds_read_b64_tr_b16 v[138:139], v6 offset:832
    v_max3_u32 v4, v4, v183, v184
    s_waitcnt lgkmcnt(10)
    v_mfma_f32_32x32x16_bf16 v[68:83], v[164:167], v[240:243], v[68:83]
    ds_read_b64_tr_b16 v[140:141], v6 offset:128
    ds_read_b64_tr_b16 v[142:143], v6 offset:896
    v_max3_u32 v4, v4, v185, v186
    v_max3_u32 v4, v4, v187, v188
    s_waitcnt lgkmcnt(10)
    v_mfma_f32_32x32x16_bf16 v[84:99], v[168:171], v[240:243], v[84:99]
    ds_read_b64_tr_b16 v[144:145], v6 offset:12288
    ds_read_b64_tr_b16 v[146:147], v6 offset:13056
    v_max3_u32 v4, v4, v189, v190
    s_waitcnt lgkmcnt(10)
    v_mfma_f32_32x32x16_bf16 v[100:115], v[172:175], v[240:243], v[100:115]
    ds_read_b64_tr_b16 v[148:149], v6 offset:12352
    ds_read_b64_tr_b16 v[150:151], v6 offset:13120
    v_max3_u32 v4, v4, v191, v192
    v_max3_u32 v4, v4, v193, v194
    s_waitcnt lgkmcnt(10)
    v_mfma_f32_32x32x16_bf16 v[116:131], v[176:179], v[240:243], v[116:131]
    ds_read_b64_tr_b16 v[152:153], v6 offset:12416
    ds_read_b64_tr_b16 v[154:155], v6 offset:13184
    v_max_u32 v4, v4, v195
    v_cmp_eq_u32 vcc, -1, v4
    s_cbranch_vccnz SLOW_173
BACK_174:
    s_waitcnt lgkmcnt(10)
    v_mfma_f32_32x32x16_bf16 v[36:51], v[132:135], v[180:183], v[36:51]
    ds_read_b64_tr_b16 v[156:157], v6 offset:3072
    ds_read_b64_tr_b16 v[158:159], v6 offset:3840
    s_waitcnt lgkmcnt(10)
    v_mfma_f32_32x32x16_bf16 v[52:67], v[136:139], v[180:183], v[52:67]
    ds_read_b64_tr_b16 v[160:161], v6 offset:3136
    ds_read_b64_tr_b16 v[162:163], v6 offset:3904
    s_waitcnt lgkmcnt(10)
    v_mfma_f32_32x32x16_bf16 v[68:83], v[140:143], v[180:183], v[68:83]
    ds_read_b64_tr_b16 v[164:165], v6 offset:3200
    ds_read_b64_tr_b16 v[166:167], v6 offset:3968
    s_waitcnt lgkmcnt(10)
    v_mfma_f32_32x32x16_bf16 v[84:99], v[144:147], v[180:183], v[84:99]
    ds_read_b64_tr_b16 v[168:169], v6 offset:15360
    ds_read_b64_tr_b16 v[170:171], v6 offset:16128
    s_waitcnt lgkmcnt(10)
    v_mfma_f32_32x32x16_bf16 v[100:115], v[148:151], v[180:183], v[100:115]
    ds_read_b64_tr_b16 v[172:173], v6 offset:15424
    ds_read_b64_tr_b16 v[174:175], v6 offset:16192
    s_waitcnt lgkmcnt(10)
    v_mfma_f32_32x32x16_bf16 v[116:131], v[152:155], v[180:183], v[116:131]
    ds_read_b64_tr_b16 v[176:177], v6 offset:15488
    ds_read_b64_tr_b16 v[178:179], v6 offset:16256
    s_waitcnt lgkmcnt(10)
    v_mfma_f32_32x32x16_bf16 v[36:51], v[156:159], v[184:187], v[36:51]
    ds_read_b64_tr_b16 v[132:133], v6 offset:6144
    ds_read_b64_tr_b16 v[134:135], v6 offset:6912
    s_waitcnt lgkmcnt(10)
    v_mfma_f32_32x32x16_bf16 v[52:67], v[160:163], v[184:187], v[52:67]
    ds_read_b64_tr_b16 v[136:137], v6 offset:6208
    ds_read_b64_tr_b16 v[138:139], v6 offset:6976
    s_waitcnt lgkmcnt(10)
    v_mfma_f32_32x32x16_bf16 v[68:83], v[164:167], v[184:187], v[68:83]
    ds_read_b64_tr_b16 v[140:141], v6 offset:6272
    ds_read_b64_tr_b16 v[142:143], v6 offset:7040
    s_waitcnt lgkmcnt(10)
    v_mfma_f32_32x32x16_bf16 v[84:99], v[168:171], v[184:187], v[84:99]
    ds_read_b64_tr_b16 v[144:145], v6 offset:18432
    ds_read_b64_tr_b16 v[146:147], v6 offset:19200
    s_waitcnt lgkmcnt(10)
    v_mfma_f32_32x32x16_bf16 v[100:115], v[172:175], v[184:187], v[100:115]
    ds_read_b64_tr_b16 v[148:149], v6 offset:18496
    ds_read_b64_tr_b16 v[150:151], v6 offset:19264
    s_waitcnt lgkmcnt(10)
    v_mfma_f32_32x32x16_bf16 v[116:131], v[176:179], v[184:187], v[116:131]
    ds_read_b64_tr_b16 v[152:153], v6 offset:18560
    ds_read_b64_tr_b16 v[154:155], v6 offset:19328
    s_waitcnt lgkmcnt(10)
    v_mfma_f32_32x32x16_bf16 v[36:51], v[132:135], v[188:191], v[36:51]
    ds_read_b64_tr_b16 v[156:157], v6 offset:9216
    ds_read_b64_tr_b16 v[158:159], v6 offset:9984
    s_waitcnt lgkmcnt(10)
    v_mfma_f32_32x32x16_bf16 v[52:67], v[136:139], v[188:191], v[52:67]
    ds_read_b64_tr_b16 v[160:161], v6 offset:9280
    ds_read_b64_tr_b16 v[162:163], v6 offset:10048
    s_waitcnt lgkmcnt(10)
    v_mfma_f32_32x32x16_bf16 v[68:83], v[140:143], v[188:191], v[68:83]
    ds_read_b64_tr_b16 v[164:165], v6 offset:9344
    ds_read_b64_tr_b16 v[166:167], v6 offset:10112
    s_waitcnt lgkmcnt(10)
    v_mfma_f32_32x32x16_bf16 v[84:99], v[144:147], v[188:191], v[84:99]
    ds_read_b64_tr_b16 v[168:169], v6 offset:21504
    ds_read_b64_tr_b16 v[170:171], v6 offset:22272
    s_waitcnt lgkmcnt(10)
    v_mfma_f32_32x32x16_bf16 v[100:115], v[148:151], v[188:191], v[100:115]
    ds_read_b64_tr_b16 v[172:173], v6 offset:21568
    ds_read_b64_tr_b16 v[174:175], v6 offset:22336
    s_waitcnt lgkmcnt(10)
    v_mfma_f32_32x32x16_bf16 v[116:131], v[152:155], v[188:191], v[116:131]
    ds_read_b64_tr_b16 v[176:177], v6 offset:21632
    ds_read_b64_tr_b16 v[178:179], v6 offset:22400
    s_waitcnt lgkmcnt(10)
    v_mfma_f32_32x32x16_bf16 v[36:51], v[156:159], v[192:195], v[36:51]
    ds_read_b64_tr_b16 v[132:133], v6 offset:24576
    ds_read_b64_tr_b16 v[134:135], v6 offset:25344
    s_waitcnt vmcnt(4)
    v_max3_u32 v4, v196, v197, v198
    s_waitcnt lgkmcnt(10)
    v_mfma_f32_32x32x16_bf16 v[52:67], v[160:163], v[192:195], v[52:67]
    ds_read_b64_tr_b16 v[136:137], v6 offset:24640
    ds_read_b64_tr_b16 v[138:139], v6 offset:25408
    v_max3_u32 v4, v4, v199, v200
    s_waitcnt lgkmcnt(10)
    v_mfma_f32_32x32x16_bf16 v[68:83], v[164:167], v[192:195], v[68:83]
    ds_read_b64_tr_b16 v[140:141], v6 offset:24704
    ds_read_b64_tr_b16 v[142:143], v6 offset:25472
    v_max3_u32 v4, v4, v201, v202
    v_max3_u32 v4, v4, v203, v204
    s_waitcnt lgkmcnt(10)
    v_mfma_f32_32x32x16_bf16 v[84:99], v[168:171], v[192:195], v[84:99]
    ds_read_b64_tr_b16 v[144:145], v6 offset:36864
    ds_read_b64_tr_b16 v[146:147], v6 offset:37632
    v_max3_u32 v4, v4, v205, v206
    s_waitcnt lgkmcnt(10)
    v_mfma_f32_32x32x16_bf16 v[100:115], v[172:175], v[192:195], v[100:115]
    ds_read_b64_tr_b16 v[148:149], v6 offset:36928
    ds_read_b64_tr_b16 v[150:151], v6 offset:37696
    v_max3_u32 v4, v4, v207, v208
    v_max3_u32 v4, v4, v209, v210
    s_waitcnt lgkmcnt(10)
    v_mfma_f32_32x32x16_bf16 v[116:131], v[176:179], v[192:195], v[116:131]
    ds_read_b64_tr_b16 v[152:153], v6 offset:36992
    ds_read_b64_tr_b16 v[154:155], v6 offset:37760
    v_max_u32 v4, v4, v211
    v_cmp_eq_u32 vcc, -1, v4
    s_cbranch_vccnz SLOW_176
BACK_177:
    s_waitcnt lgkmcnt(10)
    v_mfma_f32_32x32x16_bf16 v[36:51], v[132:135], v[196:199], v[36:51]
    ds_read_b64_tr_b16 v[156:157], v6 offset:27648
    ds_read_b64_tr_b16 v[158:159], v6 offset:28416
    s_waitcnt lgkmcnt(10)
    v_mfma_f32_32x32x16_bf16 v[52:67], v[136:139], v[196:199], v[52:67]
    ds_read_b64_tr_b16 v[160:161], v6 offset:27712
    ds_read_b64_tr_b16 v[162:163], v6 offset:28480
    s_waitcnt lgkmcnt(10)
    v_mfma_f32_32x32x16_bf16 v[68:83], v[140:143], v[196:199], v[68:83]
    ds_read_b64_tr_b16 v[164:165], v6 offset:27776
    ds_read_b64_tr_b16 v[166:167], v6 offset:28544
    s_waitcnt lgkmcnt(10)
    v_mfma_f32_32x32x16_bf16 v[84:99], v[144:147], v[196:199], v[84:99]
    ds_read_b64_tr_b16 v[168:169], v6 offset:39936
    ds_read_b64_tr_b16 v[170:171], v6 offset:40704
    s_waitcnt lgkmcnt(10)
    v_mfma_f32_32x32x16_bf16 v[100:115], v[148:151], v[196:199], v[100:115]
    ds_read_b64_tr_b16 v[172:173], v6 offset:40000
    ds_read_b64_tr_b16 v[174:175], v6 offset:40768
    s_waitcnt lgkmcnt(10)
    v_mfma_f32_32x32x16_bf16 v[116:131], v[152:155], v[196:199], v[116:131]
    ds_read_b64_tr_b16 v[176:177], v6 offset:40064
    ds_read_b64_tr_b16 v[178:179], v6 offset:40832
    s_waitcnt lgkmcnt(10)
    v_mfma_f32_32x32x16_bf16 v[36:51], v[156:159], v[200:203], v[36:51]
    ds_read_b64_tr_b16 v[132:133], v6 offset:30720
    ds_read_b64_tr_b16 v[134:135], v6 offset:31488
    s_waitcnt vmcnt(0)
    v_max3_u32 v11, v20, v21, v22
    v_max3_u32 v11, v11, v23, v24
    v_max3_u32 v11, v11, v25, v26
    v_max_u32 v11, v11, v27
    v_cmp_eq_u32 vcc, -1, v11
    s_cbranch_vccnz SLOW_179
BACK_180:
    v_pk_add_f32 v[20:21], v[20:21], v[22:23]
    v_pk_add_f32 v[20:21], v[20:21], v[24:25]
    v_pk_add_f32 v[20:21], v[20:21], v[26:27]
    v_mov_b32 v24, v20
    v_mov_b32 v25, v20
    s_nop 1
    v_permlane32_swap_b32 v24, v25
    v_add_f32 v20, v24, v25
    v_mov_b32 v24, v21
    v_mov_b32 v25, v21
    s_nop 1
    v_permlane32_swap_b32 v24, v25
    v_add_f32 v21, v24, v25
    v_mul_f32 v20, 0x3acccccd, v20
    v_mul_f32 v21, 0x3acccccd, v21
    v_fma_f32 v21, -v20, v20, v21
    v_max_f32 v21, 0, v21
    v_cvt_pk_bf16_f32 v24, v20, v20
    v_lshlrev_b32 v24, 16, v24
    v_sub_f32 v26, 0, v24
    v_cvt_pk_bf16_f32 v25, v21, v21
    v_lshlrev_b32 v25, 16, v25
    v_add_f32 v25, 0x3727c5ac, v25
    v_cvt_pk_bf16_f32 v25, v25, v25
    v_lshlrev_b32 v25, 16, v25
    v_sqrt_f32 v25, v25
    s_nop 0
    v_cvt_pk_bf16_f32 v25, v25, v25
    v_lshlrev_b32 v25, 16, v25
    v_rcp_f32 v28, v25
    v_mul_f32 v30, v25, v25
    s_waitcnt lgkmcnt(10)
    v_mfma_f32_32x32x16_bf16 v[52:67], v[160:163], v[200:203], v[52:67]
    ds_read_b64_tr_b16 v[136:137], v6 offset:30784
    ds_read_b64_tr_b16 v[138:139], v6 offset:31552
    s_waitcnt lgkmcnt(10)
    v_mfma_f32_32x32x16_bf16 v[68:83], v[164:167], v[200:203], v[68:83]
    ds_read_b64_tr_b16 v[140:141], v6 offset:30848
    ds_read_b64_tr_b16 v[142:143], v6 offset:31616
    s_waitcnt lgkmcnt(10)
    v_mfma_f32_32x32x16_bf16 v[84:99], v[168:171], v[200:203], v[84:99]
    ds_read_b64_tr_b16 v[144:145], v6 offset:43008
    ds_read_b64_tr_b16 v[146:147], v6 offset:43776
    s_waitcnt lgkmcnt(10)
    v_mfma_f32_32x32x16_bf16 v[100:115], v[172:175], v[200:203], v[100:115]
    ds_read_b64_tr_b16 v[148:149], v6 offset:43072
    ds_read_b64_tr_b16 v[150:151], v6 offset:43840
    s_waitcnt lgkmcnt(10)
    v_mfma_f32_32x32x16_bf16 v[116:131], v[176:179], v[200:203], v[116:131]
    ds_read_b64_tr_b16 v[152:153], v6 offset:43136
    ds_read_b64_tr_b16 v[154:155], v6 offset:43904
    s_waitcnt lgkmcnt(10)
    v_mfma_f32_32x32x16_bf16 v[36:51], v[132:135], v[204:207], v[36:51]
    ds_read_b64_tr_b16 v[156:157], v6 offset:33792
    ds_read_b64_tr_b16 v[158:159], v6 offset:34560
    s_waitcnt lgkmcnt(10)
    v_mfma_f32_32x32x16_bf16 v[52:67], v[136:139], v[204:207], v[52:67]
    ds_read_b64_tr_b16 v[160:161], v6 offset:33856
    ds_read_b64_tr_b16 v[162:163], v6 offset:34624
    s_waitcnt lgkmcnt(10)
    v_mfma_f32_32x32x16_bf16 v[68:83], v[140:143], v[204:207], v[68:83]
    ds_read_b64_tr_b16 v[164:165], v6 offset:33920
    ds_read_b64_tr_b16 v[166:167], v6 offset:34688
    s_waitcnt lgkmcnt(10)
    v_mfma_f32_32x32x16_bf16 v[84:99], v[144:147], v[204:207], v[84:99]
    ds_read_b64_tr_b16 v[168:169], v6 offset:46080
    ds_read_b64_tr_b16 v[170:171], v6 offset:46848
    s_waitcnt lgkmcnt(10)
    v_mfma_f32_32x32x16_bf16 v[100:115], v[148:151], v[204:207], v[100:115]
    ds_read_b64_tr_b16 v[172:173], v6 offset:46144
    ds_read_b64_tr_b16 v[174:175], v6 offset:46912
    s_waitcnt lgkmcnt(10)
    v_mfma_f32_32x32x16_bf16 v[116:131], v[152:155], v[204:207], v[116:131]
    ds_read_b64_tr_b16 v[176:177], v6 offset:46208
    ds_read_b64_tr_b16 v[178:179], v6 offset:46976
    s_waitcnt lgkmcnt(0)
    v_mov_b32 v2, 1
    v_mov_b32 v3, 162828
    s_mov_b64 exec, 1
    ds_add_u32 v3, v2
    s_mov_b64 exec, -1
    v_mfma_f32_32x32x16_bf16 v[36:51], v[156:159], v[208:211], v[36:51]
    v_lshlrev_b32 v12, 4, v1
    s_lshl_b32 s60, s41, 10
    v_add_u32 v12, s60, v12
    s_mov_b32 s60, 19439616
    buffer_load_dwordx4 v[16:19], v12, s[32:35], s60 offen sc1
    v_mfma_f32_32x32x16_bf16 v[52:67], v[160:163], v[208:211], v[52:67]
    v_mfma_f32_32x32x16_bf16 v[68:83], v[164:167], v[208:211], v[68:83]
    v_mfma_f32_32x32x16_bf16 v[84:99], v[168:171], v[208:211], v[84:99]
    ds_read_b128 v[212:215], v10 offset:0
    ds_read_b128 v[216:219], v10 offset:16
    ds_read_b128 v[220:223], v10 offset:64
    ds_read_b128 v[224:227], v10 offset:80
    ds_read_b128 v[228:231], v10 offset:384
    ds_read_b128 v[232:235], v10 offset:400
    ds_read_b128 v[236:239], v10 offset:448
    ds_read_b128 v[240:243], v10 offset:464
    v_mfma_f32_32x32x16_bf16 v[100:115], v[172:175], v[208:211], v[100:115]
    v_mfma_f32_32x32x16_bf16 v[116:131], v[176:179], v[208:211], v[116:131]
    ds_read_b128 v[132:135], v10 offset:128
    ds_read_b128 v[136:139], v10 offset:144
    ds_read_b128 v[140:143], v10 offset:192
    ds_read_b128 v[144:147], v10 offset:208
    ds_read_b128 v[148:151], v10 offset:512
    ds_read_b128 v[152:155], v10 offset:528
    ds_read_b128 v[156:159], v10 offset:576
    ds_read_b128 v[160:163], v10 offset:592
    v_mul_f32 v32, 0xc0135761, v28
    v_mul_f32 v34, v28, v28
    v_mul_f32 v34, v34, v28
    v_mul_f32 v34, 0xbdd2d3e8, v34
    s_mul_i32 s54, s45, 393216
    s_lshl_b32 s55, s46, 4
    s_add_u32 s54, s54, s55
    s_add_u32 s54, s54, 13107200
    s_waitcnt lgkmcnt(8)
    v_pk_fma_f32 v[36:37], v[212:213], v[26:27], v[36:37] op_sel_hi:[1,0,1]
    v_pk_fma_f32 v[84:85], v[228:229], v[26:27], v[84:85] op_sel_hi:[1,0,1]
    v_pk_fma_f32 v[38:39], v[214:215], v[26:27], v[38:39] op_sel_hi:[1,0,1]
    v_pk_fma_f32 v[86:87], v[230:231], v[26:27], v[86:87] op_sel_hi:[1,0,1]
    v_pk_fma_f32 v[40:41], v[216:217], v[26:27], v[40:41] op_sel_hi:[1,0,1]
    v_pk_fma_f32 v[88:89], v[232:233], v[26:27], v[88:89] op_sel_hi:[1,0,1]
    v_pk_fma_f32 v[42:43], v[218:219], v[26:27], v[42:43] op_sel_hi:[1,0,1]
    v_pk_fma_f32 v[90:91], v[234:235], v[26:27], v[90:91] op_sel_hi:[1,0,1]
    v_pk_fma_f32 v[44:45], v[220:221], v[26:27], v[44:45] op_sel_hi:[1,0,1]
    v_pk_fma_f32 v[92:93], v[236:237], v[26:27], v[92:93] op_sel_hi:[1,0,1]
    v_pk_fma_f32 v[46:47], v[222:223], v[26:27], v[46:47] op_sel_hi:[1,0,1]
    v_pk_fma_f32 v[94:95], v[238:239], v[26:27], v[94:95] op_sel_hi:[1,0,1]
    v_pk_fma_f32 v[48:49], v[224:225], v[26:27], v[48:49] op_sel_hi:[1,0,1]
    v_pk_fma_f32 v[96:97], v[240:241], v[26:27], v[96:97] op_sel_hi:[1,0,1]
    v_pk_fma_f32 v[50:51], v[226:227], v[26:27], v[50:51] op_sel_hi:[1,0,1]
    v_pk_fma_f32 v[98:99], v[242:243], v[26:27], v[98:99] op_sel_hi:[1,0,1]
    ds_read_b128 v[212:215], v10 offset:256
    ds_read_b128 v[216:219], v10 offset:272
    ds_read_b128 v[220:223], v10 offset:320
    ds_read_b128 v[224:227], v10 offset:336
    ds_read_b128 v[228:231], v10 offset:640
    ds_read_b128 v[232:235], v10 offset:656
    ds_read_b128 v[236:239], v10 offset:704
    ds_read_b128 v[240:243], v10 offset:720
    v_pk_mul_f32 v[84:85], v[84:85], v[36:37]
    v_pk_mul_f32 v[164:165], v[36:37], v[36:37]
    v_pk_fma_f32 v[164:165], v[164:165], v[34:35], v[32:33] op_sel_hi:[1,0,0]
    v_pk_mul_f32 v[164:165], v[164:165], v[36:37]
    v_pk_mul_f32 v[86:87], v[86:87], v[38:39]
    v_pk_mul_f32 v[166:167], v[38:39], v[38:39]
    v_pk_fma_f32 v[166:167], v[166:167], v[34:35], v[32:33] op_sel_hi:[1,0,0]
    v_pk_mul_f32 v[166:167], v[166:167], v[38:39]
    v_pk_mul_f32 v[88:89], v[88:89], v[40:41]
    v_pk_mul_f32 v[168:169], v[40:41], v[40:41]
    v_pk_fma_f32 v[168:169], v[168:169], v[34:35], v[32:33] op_sel_hi:[1,0,0]
    v_pk_mul_f32 v[168:169], v[168:169], v[40:41]
    v_pk_mul_f32 v[90:91], v[90:91], v[42:43]
    v_pk_mul_f32 v[170:171], v[42:43], v[42:43]
    v_pk_fma_f32 v[170:171], v[170:171], v[34:35], v[32:33] op_sel_hi:[1,0,0]
    v_pk_mul_f32 v[170:171], v[170:171], v[42:43]
    v_pk_mul_f32 v[92:93], v[92:93], v[44:45]
    v_pk_mul_f32 v[172:173], v[44:45], v[44:45]
    v_pk_fma_f32 v[172:173], v[172:173], v[34:35], v[32:33] op_sel_hi:[1,0,0]
    v_pk_mul_f32 v[172:173], v[172:173], v[44:45]
    v_pk_mul_f32 v[94:95], v[94:95], v[46:47]
    v_pk_mul_f32 v[174:175], v[46:47], v[46:47]
    v_pk_fma_f32 v[174:175], v[174:175], v[34:35], v[32:33] op_sel_hi:[1,0,0]
    v_pk_mul_f32 v[174:175], v[174:175], v[46:47]
    v_pk_mul_f32 v[96:97], v[96:97], v[48:49]
    v_pk_mul_f32 v[176:177], v[48:49], v[48:49]
    v_pk_fma_f32 v[176:177], v[176:177], v[34:35], v[32:33] op_sel_hi:[1,0,0]
    v_pk_mul_f32 v[176:177], v[176:177], v[48:49]
    v_pk_mul_f32 v[98:99], v[98:99], v[50:51]
    v_pk_mul_f32 v[178:179], v[50:51], v[50:51]
    v_pk_fma_f32 v[178:179], v[178:179], v[34:35], v[32:33] op_sel_hi:[1,0,0]
    v_pk_mul_f32 v[178:179], v[178:179], v[50:51]
    v_exp_f32 v164, v164
    v_exp_f32 v165, v165
    v_exp_f32 v166, v166
    v_exp_f32 v167, v167
    v_exp_f32 v168, v168
    v_exp_f32 v169, v169
    v_exp_f32 v170, v170
    v_exp_f32 v171, v171
    v_exp_f32 v172, v172
    v_exp_f32 v173, v173
    v_exp_f32 v174, v174
    v_exp_f32 v175, v175
    v_exp_f32 v176, v176
    v_exp_f32 v177, v177
    v_exp_f32 v178, v178
    v_exp_f32 v179, v179
    v_pk_fma_f32 v[164:165], v[164:165], v[30:31], v[30:31] op_sel_hi:[1,0,0]
    v_pk_fma_f32 v[166:167], v[166:167], v[30:31], v[30:31] op_sel_hi:[1,0,0]
    v_pk_fma_f32 v[168:169], v[168:169], v[30:31], v[30:31] op_sel_hi:[1,0,0]
    v_pk_fma_f32 v[170:171], v[170:171], v[30:31], v[30:31] op_sel_hi:[1,0,0]
    v_pk_fma_f32 v[172:173], v[172:173], v[30:31], v[30:31] op_sel_hi:[1,0,0]
    v_pk_fma_f32 v[174:175], v[174:175], v[30:31], v[30:31] op_sel_hi:[1,0,0]
    v_pk_fma_f32 v[176:177], v[176:177], v[30:31], v[30:31] op_sel_hi:[1,0,0]
    v_pk_fma_f32 v[178:179], v[178:179], v[30:31], v[30:31] op_sel_hi:[1,0,0]
    v_rcp_f32 v164, v164
    v_rcp_f32 v165, v165
    v_rcp_f32 v166, v166
    v_rcp_f32 v167, v167
    v_rcp_f32 v168, v168
    v_rcp_f32 v169, v169
    v_rcp_f32 v170, v170
    v_rcp_f32 v171, v171
    v_rcp_f32 v172, v172
    v_rcp_f32 v173, v173
    v_rcp_f32 v174, v174
    v_rcp_f32 v175, v175
    v_rcp_f32 v176, v176
    v_rcp_f32 v177, v177
    v_rcp_f32 v178, v178
    v_rcp_f32 v179, v179
    v_pk_mul_f32 v[84:85], v[84:85], v[164:165]
    v_pk_mul_f32 v[86:87], v[86:87], v[166:167]
    v_pk_mul_f32 v[88:89], v[88:89], v[168:169]
    v_pk_mul_f32 v[90:91], v[90:91], v[170:171]
    v_pk_mul_f32 v[92:93], v[92:93], v[172:173]
    v_pk_mul_f32 v[94:95], v[94:95], v[174:175]
    v_pk_mul_f32 v[96:97], v[96:97], v[176:177]
    v_pk_mul_f32 v[98:99], v[98:99], v[178:179]
    v_cvt_pk_bf16_f32 v180, v84, v85
    v_cvt_pk_bf16_f32 v181, v86, v87
    v_cvt_pk_bf16_f32 v182, v88, v89
    v_cvt_pk_bf16_f32 v183, v90, v91
    v_cvt_pk_bf16_f32 v184, v92, v93
    v_cvt_pk_bf16_f32 v185, v94, v95
    v_cvt_pk_bf16_f32 v186, v96, v97
    v_cvt_pk_bf16_f32 v187, v98, v99
    s_add_u32 s55, s54, 0
    buffer_store_dwordx4 v[180:183], v5, s[32:35], s55 offen sc1
    s_add_u32 s55, s54, 65536
    buffer_store_dwordx4 v[184:187], v5, s[32:35], s55 offen sc1
    s_waitcnt lgkmcnt(8)
    v_pk_fma_f32 v[52:53], v[132:133], v[26:27], v[52:53] op_sel_hi:[1,0,1]
    v_pk_fma_f32 v[100:101], v[148:149], v[26:27], v[100:101] op_sel_hi:[1,0,1]
    v_pk_fma_f32 v[54:55], v[134:135], v[26:27], v[54:55] op_sel_hi:[1,0,1]
    v_pk_fma_f32 v[102:103], v[150:151], v[26:27], v[102:103] op_sel_hi:[1,0,1]
    v_pk_fma_f32 v[56:57], v[136:137], v[26:27], v[56:57] op_sel_hi:[1,0,1]
    v_pk_fma_f32 v[104:105], v[152:153], v[26:27], v[104:105] op_sel_hi:[1,0,1]
    v_pk_fma_f32 v[58:59], v[138:139], v[26:27], v[58:59] op_sel_hi:[1,0,1]
    v_pk_fma_f32 v[106:107], v[154:155], v[26:27], v[106:107] op_sel_hi:[1,0,1]
    v_pk_fma_f32 v[60:61], v[140:141], v[26:27], v[60:61] op_sel_hi:[1,0,1]
    v_pk_fma_f32 v[108:109], v[156:157], v[26:27], v[108:109] op_sel_hi:[1,0,1]
    v_pk_fma_f32 v[62:63], v[142:143], v[26:27], v[62:63] op_sel_hi:[1,0,1]
    v_pk_fma_f32 v[110:111], v[158:159], v[26:27], v[110:111] op_sel_hi:[1,0,1]
    v_pk_fma_f32 v[64:65], v[144:145], v[26:27], v[64:65] op_sel_hi:[1,0,1]
    v_pk_fma_f32 v[112:113], v[160:161], v[26:27], v[112:113] op_sel_hi:[1,0,1]
    v_pk_fma_f32 v[66:67], v[146:147], v[26:27], v[66:67] op_sel_hi:[1,0,1]
    v_pk_fma_f32 v[114:115], v[162:163], v[26:27], v[114:115] op_sel_hi:[1,0,1]
    v_pk_mul_f32 v[100:101], v[100:101], v[52:53]
    v_pk_mul_f32 v[164:165], v[52:53], v[52:53]
    v_pk_fma_f32 v[164:165], v[164:165], v[34:35], v[32:33] op_sel_hi:[1,0,0]
    v_pk_mul_f32 v[164:165], v[164:165], v[52:53]
    v_pk_mul_f32 v[102:103], v[102:103], v[54:55]
    v_pk_mul_f32 v[166:167], v[54:55], v[54:55]
    v_pk_fma_f32 v[166:167], v[166:167], v[34:35], v[32:33] op_sel_hi:[1,0,0]
    v_pk_mul_f32 v[166:167], v[166:167], v[54:55]
    v_pk_mul_f32 v[104:105], v[104:105], v[56:57]
    v_pk_mul_f32 v[168:169], v[56:57], v[56:57]
    v_pk_fma_f32 v[168:169], v[168:169], v[34:35], v[32:33] op_sel_hi:[1,0,0]
    v_pk_mul_f32 v[168:169], v[168:169], v[56:57]
    v_pk_mul_f32 v[106:107], v[106:107], v[58:59]
    v_pk_mul_f32 v[170:171], v[58:59], v[58:59]
    v_pk_fma_f32 v[170:171], v[170:171], v[34:35], v[32:33] op_sel_hi:[1,0,0]
    v_pk_mul_f32 v[170:171], v[170:171], v[58:59]
    v_pk_mul_f32 v[108:109], v[108:109], v[60:61]
    v_pk_mul_f32 v[172:173], v[60:61], v[60:61]
    v_pk_fma_f32 v[172:173], v[172:173], v[34:35], v[32:33] op_sel_hi:[1,0,0]
    v_pk_mul_f32 v[172:173], v[172:173], v[60:61]
    v_pk_mul_f32 v[110:111], v[110:111], v[62:63]
    v_pk_mul_f32 v[174:175], v[62:63], v[62:63]
    v_pk_fma_f32 v[174:175], v[174:175], v[34:35], v[32:33] op_sel_hi:[1,0,0]
    v_pk_mul_f32 v[174:175], v[174:175], v[62:63]
    v_pk_mul_f32 v[112:113], v[112:113], v[64:65]
    v_pk_mul_f32 v[176:177], v[64:65], v[64:65]
    v_pk_fma_f32 v[176:177], v[176:177], v[34:35], v[32:33] op_sel_hi:[1,0,0]
    v_pk_mul_f32 v[176:177], v[176:177], v[64:65]
    v_pk_mul_f32 v[114:115], v[114:115], v[66:67]
    v_pk_mul_f32 v[178:179], v[66:67], v[66:67]
    v_pk_fma_f32 v[178:179], v[178:179], v[34:35], v[32:33] op_sel_hi:[1,0,0]
    v_pk_mul_f32 v[178:179], v[178:179], v[66:67]
    v_exp_f32 v164, v164
    v_exp_f32 v165, v165
    v_exp_f32 v166, v166
    v_exp_f32 v167, v167
    v_exp_f32 v168, v168
    v_exp_f32 v169, v169
    v_exp_f32 v170, v170
    v_exp_f32 v171, v171
    v_exp_f32 v172, v172
    v_exp_f32 v173, v173
    v_exp_f32 v174, v174
    v_exp_f32 v175, v175
    v_exp_f32 v176, v176
    v_exp_f32 v177, v177
    v_exp_f32 v178, v178
    v_exp_f32 v179, v179
    v_pk_fma_f32 v[164:165], v[164:165], v[30:31], v[30:31] op_sel_hi:[1,0,0]
    v_pk_fma_f32 v[166:167], v[166:167], v[30:31], v[30:31] op_sel_hi:[1,0,0]
    v_pk_fma_f32 v[168:169], v[168:169], v[30:31], v[30:31] op_sel_hi:[1,0,0]
    v_pk_fma_f32 v[170:171], v[170:171], v[30:31], v[30:31] op_sel_hi:[1,0,0]
    v_pk_fma_f32 v[172:173], v[172:173], v[30:31], v[30:31] op_sel_hi:[1,0,0]
    v_pk_fma_f32 v[174:175], v[174:175], v[30:31], v[30:31] op_sel_hi:[1,0,0]
    v_pk_fma_f32 v[176:177], v[176:177], v[30:31], v[30:31] op_sel_hi:[1,0,0]
    v_pk_fma_f32 v[178:179], v[178:179], v[30:31], v[30:31] op_sel_hi:[1,0,0]
    v_rcp_f32 v164, v164
    v_rcp_f32 v165, v165
    v_rcp_f32 v166, v166
    v_rcp_f32 v167, v167
    v_rcp_f32 v168, v168
    v_rcp_f32 v169, v169
    v_rcp_f32 v170, v170
    v_rcp_f32 v171, v171
    v_rcp_f32 v172, v172
    v_rcp_f32 v173, v173
    v_rcp_f32 v174, v174
    v_rcp_f32 v175, v175
    v_rcp_f32 v176, v176
    v_rcp_f32 v177, v177
    v_rcp_f32 v178, v178
    v_rcp_f32 v179, v179
    v_pk_mul_f32 v[100:101], v[100:101], v[164:165]
    v_pk_mul_f32 v[102:103], v[102:103], v[166:167]
    v_pk_mul_f32 v[104:105], v[104:105], v[168:169]
    v_pk_mul_f32 v[106:107], v[106:107], v[170:171]
    v_pk_mul_f32 v[108:109], v[108:109], v[172:173]
    v_pk_mul_f32 v[110:111], v[110:111], v[174:175]
    v_pk_mul_f32 v[112:113], v[112:113], v[176:177]
    v_pk_mul_f32 v[114:115], v[114:115], v[178:179]
    v_cvt_pk_bf16_f32 v188, v100, v101
    v_cvt_pk_bf16_f32 v189, v102, v103
    v_cvt_pk_bf16_f32 v190, v104, v105
    v_cvt_pk_bf16_f32 v191, v106, v107
    v_cvt_pk_bf16_f32 v192, v108, v109
    v_cvt_pk_bf16_f32 v193, v110, v111
    v_cvt_pk_bf16_f32 v194, v112, v113
    v_cvt_pk_bf16_f32 v195, v114, v115
    s_add_u32 s55, s54, 131072
    buffer_store_dwordx4 v[188:191], v5, s[32:35], s55 offen sc1
    s_add_u32 s55, s54, 196608
    buffer_store_dwordx4 v[192:195], v5, s[32:35], s55 offen sc1
    s_waitcnt lgkmcnt(0)
    v_pk_fma_f32 v[68:69], v[212:213], v[26:27], v[68:69] op_sel_hi:[1,0,1]
    v_pk_fma_f32 v[116:117], v[228:229], v[26:27], v[116:117] op_sel_hi:[1,0,1]
    v_pk_fma_f32 v[70:71], v[214:215], v[26:27], v[70:71] op_sel_hi:[1,0,1]
    v_pk_fma_f32 v[118:119], v[230:231], v[26:27], v[118:119] op_sel_hi:[1,0,1]
    v_pk_fma_f32 v[72:73], v[216:217], v[26:27], v[72:73] op_sel_hi:[1,0,1]
    v_pk_fma_f32 v[120:121], v[232:233], v[26:27], v[120:121] op_sel_hi:[1,0,1]
    v_pk_fma_f32 v[74:75], v[218:219], v[26:27], v[74:75] op_sel_hi:[1,0,1]
    v_pk_fma_f32 v[122:123], v[234:235], v[26:27], v[122:123] op_sel_hi:[1,0,1]
    v_pk_fma_f32 v[76:77], v[220:221], v[26:27], v[76:77] op_sel_hi:[1,0,1]
    v_pk_fma_f32 v[124:125], v[236:237], v[26:27], v[124:125] op_sel_hi:[1,0,1]
    v_pk_fma_f32 v[78:79], v[222:223], v[26:27], v[78:79] op_sel_hi:[1,0,1]
    v_pk_fma_f32 v[126:127], v[238:239], v[26:27], v[126:127] op_sel_hi:[1,0,1]
    v_pk_fma_f32 v[80:81], v[224:225], v[26:27], v[80:81] op_sel_hi:[1,0,1]
    v_pk_fma_f32 v[128:129], v[240:241], v[26:27], v[128:129] op_sel_hi:[1,0,1]
    v_pk_fma_f32 v[82:83], v[226:227], v[26:27], v[82:83] op_sel_hi:[1,0,1]
    v_pk_fma_f32 v[130:131], v[242:243], v[26:27], v[130:131] op_sel_hi:[1,0,1]
    v_pk_mul_f32 v[116:117], v[116:117], v[68:69]
    v_pk_mul_f32 v[164:165], v[68:69], v[68:69]
    v_pk_fma_f32 v[164:165], v[164:165], v[34:35], v[32:33] op_sel_hi:[1,0,0]
    v_pk_mul_f32 v[164:165], v[164:165], v[68:69]
    v_pk_mul_f32 v[118:119], v[118:119], v[70:71]
    v_pk_mul_f32 v[166:167], v[70:71], v[70:71]
    v_pk_fma_f32 v[166:167], v[166:167], v[34:35], v[32:33] op_sel_hi:[1,0,0]
    v_pk_mul_f32 v[166:167], v[166:167], v[70:71]
    v_pk_mul_f32 v[120:121], v[120:121], v[72:73]
    v_pk_mul_f32 v[168:169], v[72:73], v[72:73]
    v_pk_fma_f32 v[168:169], v[168:169], v[34:35], v[32:33] op_sel_hi:[1,0,0]
    v_pk_mul_f32 v[168:169], v[168:169], v[72:73]
    v_pk_mul_f32 v[122:123], v[122:123], v[74:75]
    v_pk_mul_f32 v[170:171], v[74:75], v[74:75]
    v_pk_fma_f32 v[170:171], v[170:171], v[34:35], v[32:33] op_sel_hi:[1,0,0]
    v_pk_mul_f32 v[170:171], v[170:171], v[74:75]
    v_pk_mul_f32 v[124:125], v[124:125], v[76:77]
    v_pk_mul_f32 v[172:173], v[76:77], v[76:77]
    v_pk_fma_f32 v[172:173], v[172:173], v[34:35], v[32:33] op_sel_hi:[1,0,0]
    v_pk_mul_f32 v[172:173], v[172:173], v[76:77]
    v_pk_mul_f32 v[126:127], v[126:127], v[78:79]
    v_pk_mul_f32 v[174:175], v[78:79], v[78:79]
    v_pk_fma_f32 v[174:175], v[174:175], v[34:35], v[32:33] op_sel_hi:[1,0,0]
    v_pk_mul_f32 v[174:175], v[174:175], v[78:79]
    v_pk_mul_f32 v[128:129], v[128:129], v[80:81]
    v_pk_mul_f32 v[176:177], v[80:81], v[80:81]
    v_pk_fma_f32 v[176:177], v[176:177], v[34:35], v[32:33] op_sel_hi:[1,0,0]
    v_pk_mul_f32 v[176:177], v[176:177], v[80:81]
    v_pk_mul_f32 v[130:131], v[130:131], v[82:83]
    v_pk_mul_f32 v[178:179], v[82:83], v[82:83]
    v_pk_fma_f32 v[178:179], v[178:179], v[34:35], v[32:33] op_sel_hi:[1,0,0]
    v_pk_mul_f32 v[178:179], v[178:179], v[82:83]
    v_exp_f32 v164, v164
    v_exp_f32 v165, v165
    v_exp_f32 v166, v166
    v_exp_f32 v167, v167
    v_exp_f32 v168, v168
    v_exp_f32 v169, v169
    v_exp_f32 v170, v170
    v_exp_f32 v171, v171
    v_exp_f32 v172, v172
    v_exp_f32 v173, v173
    v_exp_f32 v174, v174
    v_exp_f32 v175, v175
    v_exp_f32 v176, v176
    v_exp_f32 v177, v177
    v_exp_f32 v178, v178
    v_exp_f32 v179, v179
    v_pk_fma_f32 v[164:165], v[164:165], v[30:31], v[30:31] op_sel_hi:[1,0,0]
    v_pk_fma_f32 v[166:167], v[166:167], v[30:31], v[30:31] op_sel_hi:[1,0,0]
    v_pk_fma_f32 v[168:169], v[168:169], v[30:31], v[30:31] op_sel_hi:[1,0,0]
    v_pk_fma_f32 v[170:171], v[170:171], v[30:31], v[30:31] op_sel_hi:[1,0,0]
    v_pk_fma_f32 v[172:173], v[172:173], v[30:31], v[30:31] op_sel_hi:[1,0,0]
    v_pk_fma_f32 v[174:175], v[174:175], v[30:31], v[30:31] op_sel_hi:[1,0,0]
    v_pk_fma_f32 v[176:177], v[176:177], v[30:31], v[30:31] op_sel_hi:[1,0,0]
    v_pk_fma_f32 v[178:179], v[178:179], v[30:31], v[30:31] op_sel_hi:[1,0,0]
    v_rcp_f32 v164, v164
    v_rcp_f32 v165, v165
    v_rcp_f32 v166, v166
    v_rcp_f32 v167, v167
    v_rcp_f32 v168, v168
    v_rcp_f32 v169, v169
    v_rcp_f32 v170, v170
    v_rcp_f32 v171, v171
    v_rcp_f32 v172, v172
    v_rcp_f32 v173, v173
    v_rcp_f32 v174, v174
    v_rcp_f32 v175, v175
    v_rcp_f32 v176, v176
    v_rcp_f32 v177, v177
    v_rcp_f32 v178, v178
    v_rcp_f32 v179, v179
    v_pk_mul_f32 v[116:117], v[116:117], v[164:165]
    v_pk_mul_f32 v[118:119], v[118:119], v[166:167]
    v_pk_mul_f32 v[120:121], v[120:121], v[168:169]
    v_pk_mul_f32 v[122:123], v[122:123], v[170:171]
    v_pk_mul_f32 v[124:125], v[124:125], v[172:173]
    v_pk_mul_f32 v[126:127], v[126:127], v[174:175]
    v_pk_mul_f32 v[128:129], v[128:129], v[176:177]
    v_pk_mul_f32 v[130:131], v[130:131], v[178:179]
    v_cvt_pk_bf16_f32 v180, v116, v117
    v_cvt_pk_bf16_f32 v181, v118, v119
    v_cvt_pk_bf16_f32 v182, v120, v121
    v_cvt_pk_bf16_f32 v183, v122, v123
    v_cvt_pk_bf16_f32 v184, v124, v125
    v_cvt_pk_bf16_f32 v185, v126, v127
    v_cvt_pk_bf16_f32 v186, v128, v129
    v_cvt_pk_bf16_f32 v187, v130, v131
    s_add_u32 s55, s54, 262144
    buffer_store_dwordx4 v[180:183], v5, s[32:35], s55 offen sc1
    s_add_u32 s55, s54, 327680
    buffer_store_dwordx4 v[184:187], v5, s[32:35], s55 offen sc1
    s_waitcnt vmcnt(6)
    v_xor_b32 v16, s3, v16
    v_xor_b32 v17, s3, v17
    v_xor_b32 v18, s3, v18
    v_xor_b32 v19, s3, v19
    v_or3_b32 v16, v16, v17, v18
    v_or_b32 v16, v16, v19
    v_cmp_ne_u32 vcc, 0, v16
    s_cbranch_vccnz FSLOW_182
FBACK_183:
    s_and_b32 s46, s41, 3
    s_lshl_b32 s46, s46, 3
    s_and_b32 s44, s42, 7
    s_add_u32 s44, s44, s46
    s_lshr_b32 s46, s41, 2
    s_lshl_b32 s46, s46, 2
    s_lshr_b32 s45, s42, 3
    s_add_u32 s45, s45, s46
    s_mul_i32 s37, s45, 3
    s_lshr_b32 s37, s37, 1
    s_mov_b32 s50, 0
    s_mul_i32 s51, s43, 5120
    v_and_b32 v15, 15, v1
    v_lshrrev_b32 v16, 4, v1
    v_bfe_u32 v17, v1, 2, 2
    v_lshl_add_u32 v18, v16, 3, v17
    v_bfe_u32 v20, v1, 4, 1
    v_lshlrev_b32 v20, 2, v20
    v_xor_b32 v19, v18, v20
    v_xor_b32 v22, 4, v19
    v_and_b32 v21, 3, v1
    v_mul_u32_u24 v24, 160, v19
    v_lshl_add_u32 v24, v21, 3, v24
    v_add_u32 v24, s51, v24
    v_mul_u32_u24 v25, 160, v22
    v_lshl_add_u32 v25, v21, 3, v25
    v_add_u32 v25, s51, v25
    v_add_u32 v26, 61440, v24
    v_add_u32 v27, 61440, v25
    v_add_u32 v28, 122880, v24
    v_add_u32 v29, 122880, v25
    v_lshlrev_b32 v2, 4, v1
    v_lshlrev_b32 v3, 4, v15
    v_lshl_add_u32 v3, v16, 15, v3
    s_add_u32 s46, s43, 0
    s_and_b32 s46, s46, 3
    s_lshl_b32 s46, s46, 8
    v_add_u32 v4, s46, v3
    s_add_u32 s46, s43, 1
    s_and_b32 s46, s46, 3
    s_lshl_b32 s46, s46, 8
    v_add_u32 v5, s46, v3
    s_add_u32 s46, s43, 2
    s_and_b32 s46, s46, 3
    s_lshl_b32 s46, s46, 8
    v_add_u32 v6, s46, v3
    s_add_u32 s46, s43, 3
    s_and_b32 s46, s46, 3
    s_lshl_b32 s46, s46, 8
    v_add_u32 v7, s46, v3
    s_lshl_b32 s53, s44, 10
    s_mul_i32 s54, s43, 1572864
    s_add_u32 s53, s53, s54
    s_add_u32 s53, s53, 13107200
    v_add_u32 v30, s51, v2
    s_sub_u32 s47, s43, 1
    s_and_b32 s47, s47, 3
    s_mul_i32 s47, s47, 5120
    v_add_u32 v31, s47, v2
    s_sub_u32 s47, s43, 2
    s_and_b32 s47, s47, 3
    s_mul_i32 s47, s47, 5120
    v_add_u32 v32, s47, v2
    s_sub_u32 s47, s43, 3
    s_and_b32 s47, s47, 3
    s_mul_i32 s47, s47, 5120
    v_add_u32 v33, s47, v2
    s_lshl_b32 s46, s44, 6
    s_lshl_b32 s47, s43, 4
    s_add_u32 s46, s46, s47
    v_add_u32 v12, s46, v15
    v_mul_u32_u24 v34, 176, v15
    v_lshl_add_u32 v34, v16, 3, v34
    s_lshl_b32 s47, s43, 12
    s_add_u32 s47, s47, 90112
    v_add_u32 v34, s47, v34
    v_add_u32 v17, 0, v1
    v_mul_u32_u24 v18, 6554, v17
    v_lshrrev_b32 v18, 16, v18
    v_mul_u32_u24 v19, 10, v18
    v_sub_u32 v19, v17, v19
    v_mul_u32_u24 v20, 176, v18
    v_lshl_add_u32 v20, v19, 4, v20
    v_add_u32 v35, s47, v20
    v_mul_u32_u24 v20, 1280, v18
    v_lshl_add_u32 v38, v19, 4, v20
    v_add_u32 v17, 64, v1
    v_mul_u32_u24 v18, 6554, v17
    v_lshrrev_b32 v18, 16, v18
    v_mul_u32_u24 v19, 10, v18
    v_sub_u32 v19, v17, v19
    v_mul_u32_u24 v20, 176, v18
    v_lshl_add_u32 v20, v19, 4, v20
    v_add_u32 v36, s47, v20
    v_mul_u32_u24 v20, 1280, v18
    v_lshl_add_u32 v39, v19, 4, v20
    v_add_u32 v17, 128, v1
    v_mul_u32_u24 v18, 6554, v17
    v_lshrrev_b32 v18, 16, v18
    v_mul_u32_u24 v19, 10, v18
    v_sub_u32 v19, v17, v19
    v_mul_u32_u24 v20, 176, v18
    v_lshl_add_u32 v20, v19, 4, v20
    v_add_u32 v37, s47, v20
    v_mul_u32_u24 v20, 1280, v18
    v_lshl_add_u32 v40, v19, 4, v20
    s_waitcnt vmcnt(0)
    s_add_u32 s54, s37, 0
    s_sub_u32 s38, s54, 12
    s_cmp_ge_u32 s54, 12
    s_cselect_b32 s54, s38, s54
    s_mul_i32 s54, s54, 131072
    s_add_u32 s54, s54, s53
    buffer_load_dwordx4 v[164:167], v4, s[32:35], s54 offen sc1
    buffer_load_dwordx4 v[168:171], v5, s[32:35], s54 offen sc1
    buffer_load_dwordx4 v[172:175], v6, s[32:35], s54 offen sc1
    buffer_load_dwordx4 v[176:179], v7, s[32:35], s54 offen sc1
    s_barrier
    ds_read_b64_tr_b16 v[124:125], v24 offset:49152
    ds_read_b64_tr_b16 v[126:127], v25 offset:49152
    ds_read_b64_tr_b16 v[128:129], v24 offset:49184
    ds_read_b64_tr_b16 v[130:131], v25 offset:49184
    ds_read_b64_tr_b16 v[132:133], v24 offset:49216
    ds_read_b64_tr_b16 v[134:135], v25 offset:49216
    ds_read_b64_tr_b16 v[136:137], v24 offset:49248
    ds_read_b64_tr_b16 v[138:139], v25 offset:49248
    ds_read_b64_tr_b16 v[140:141], v24 offset:49280
    ds_read_b64_tr_b16 v[142:143], v25 offset:49280
    v_lshlrev_b32 v44, 16, v244
    v_and_b32 v45, 0xffff0000, v244
    v_lshlrev_b32 v46, 16, v245
    v_and_b32 v47, 0xffff0000, v245
    v_lshlrev_b32 v48, 16, v246
    v_and_b32 v49, 0xffff0000, v246
    v_lshlrev_b32 v50, 16, v247
    v_and_b32 v51, 0xffff0000, v247
    v_lshlrev_b32 v52, 16, v248
    v_and_b32 v53, 0xffff0000, v248
    v_lshlrev_b32 v54, 16, v249
    v_and_b32 v55, 0xffff0000, v249
    v_lshlrev_b32 v56, 16, v250
    v_and_b32 v57, 0xffff0000, v250
    v_lshlrev_b32 v58, 16, v251
    v_and_b32 v59, 0xffff0000, v251
    v_lshlrev_b32 v60, 16, v252
    v_and_b32 v61, 0xffff0000, v252
    v_lshlrev_b32 v62, 16, v253
    v_and_b32 v63, 0xffff0000, v253
    s_waitcnt vmcnt(0)
    v_max3_u32 v14, v164, v165, v166
    v_max3_u32 v14, v14, v167, v168
    v_max3_u32 v14, v14, v169, v170
    v_max3_u32 v14, v14, v171, v172
    v_max3_u32 v14, v14, v173, v174
    v_max3_u32 v14, v14, v175, v176
    v_max3_u32 v14, v14, v177, v178
    v_max_u32 v14, v14, v179
    v_cmp_eq_u32 vcc, -1, v14
    s_cbranch_vccnz SLOW_184
BACK_185:
    s_waitcnt lgkmcnt(8)
    v_mfma_f32_16x16x32_bf16 v[44:47], v[124:127], v[164:167], v[44:47]
    s_add_u32 s54, s37, 1
    s_sub_u32 s38, s54, 12
    s_cmp_ge_u32 s54, 12
    s_cselect_b32 s54, s38, s54
    s_mul_i32 s54, s54, 131072
    s_add_u32 s54, s54, s53
    buffer_load_dwordx4 v[180:183], v4, s[32:35], s54 offen sc1
    s_waitcnt lgkmcnt(6)
    v_mfma_f32_16x16x32_bf16 v[48:51], v[128:131], v[164:167], v[48:51]
    s_waitcnt lgkmcnt(4)
    v_mfma_f32_16x16x32_bf16 v[52:55], v[132:135], v[164:167], v[52:55]
    buffer_load_dwordx4 v[184:187], v5, s[32:35], s54 offen sc1
    s_waitcnt lgkmcnt(2)
    v_mfma_f32_16x16x32_bf16 v[56:59], v[136:139], v[164:167], v[56:59]
    s_waitcnt lgkmcnt(0)
    v_mfma_f32_16x16x32_bf16 v[60:63], v[140:143], v[164:167], v[60:63]
    buffer_load_dwordx4 v[188:191], v6, s[32:35], s54 offen sc1
    v_mfma_f32_16x16x32_bf16 v[64:67], v[124:127], v[168:171], 0
    ds_read_b64_tr_b16 v[144:145], v26 offset:8192
    v_mfma_f32_16x16x32_bf16 v[68:71], v[128:131], v[168:171], 0
    buffer_load_dwordx4 v[192:195], v7, s[32:35], s54 offen sc1
    ds_read_b64_tr_b16 v[146:147], v27 offset:8192
    v_mfma_f32_16x16x32_bf16 v[72:75], v[132:135], v[168:171], 0
    ds_read_b64_tr_b16 v[148:149], v26 offset:8224
    v_mfma_f32_16x16x32_bf16 v[76:79], v[136:139], v[168:171], 0
    ds_read_b64_tr_b16 v[150:151], v27 offset:8224
    v_mfma_f32_16x16x32_bf16 v[80:83], v[140:143], v[168:171], 0
    ds_read_b64_tr_b16 v[152:153], v26 offset:8256
    v_mfma_f32_16x16x32_bf16 v[84:87], v[124:127], v[172:175], 0
    s_add_u32 s54, s37, 2
    s_sub_u32 s38, s54, 12
    s_cmp_ge_u32 s54, 12
    s_cselect_b32 s54, s38, s54
    s_mul_i32 s54, s54, 131072
    s_add_u32 s54, s54, s53
    buffer_load_dwordx4 v[196:199], v4, s[32:35], s54 offen sc1
    ds_read_b64_tr_b16 v[154:155], v27 offset:8256
    v_mfma_f32_16x16x32_bf16 v[88:91], v[128:131], v[172:175], 0
    ds_read_b64_tr_b16 v[156:157], v26 offset:8288
    v_mfma_f32_16x16x32_bf16 v[92:95], v[132:135], v[172:175], 0
    buffer_load_dwordx4 v[200:203], v5, s[32:35], s54 offen sc1
    ds_read_b64_tr_b16 v[158:159], v27 offset:8288
    v_mfma_f32_16x16x32_bf16 v[96:99], v[136:139], v[172:175], 0
    ds_read_b64_tr_b16 v[160:161], v26 offset:8320
    v_mfma_f32_16x16x32_bf16 v[100:103], v[140:143], v[172:175], 0
    buffer_load_dwordx4 v[204:207], v6, s[32:35], s54 offen sc1
    ds_read_b64_tr_b16 v[162:163], v27 offset:8320
    v_mfma_f32_16x16x32_bf16 v[104:107], v[124:127], v[176:179], 0
    v_mfma_f32_16x16x32_bf16 v[108:111], v[128:131], v[176:179], 0
    buffer_load_dwordx4 v[208:211], v7, s[32:35], s54 offen sc1
    v_mfma_f32_16x16x32_bf16 v[112:115], v[132:135], v[176:179], 0
    v_mfma_f32_16x16x32_bf16 v[116:119], v[136:139], v[176:179], 0
    v_mfma_f32_16x16x32_bf16 v[120:123], v[140:143], v[176:179], 0
    s_waitcnt vmcnt(4)
    v_max3_u32 v14, v180, v181, v182
    v_max3_u32 v14, v14, v183, v184
    v_max3_u32 v14, v14, v185, v186
    v_max3_u32 v14, v14, v187, v188
    v_max3_u32 v14, v14, v189, v190
    v_max3_u32 v14, v14, v191, v192
    v_max3_u32 v14, v14, v193, v194
    v_max_u32 v14, v14, v195
    v_cmp_eq_u32 vcc, -1, v14
    s_cbranch_vccnz SLOW_187
BACK_188:
    s_waitcnt lgkmcnt(8)
    v_mfma_f32_16x16x32_bf16 v[44:47], v[144:147], v[180:183], v[44:47]
    s_add_u32 s54, s37, 3
    s_sub_u32 s38, s54, 12
    s_cmp_ge_u32 s54, 12
    s_cselect_b32 s54, s38, s54
    s_mul_i32 s54, s54, 131072
    s_add_u32 s54, s54, s53
    buffer_load_dwordx4 v[212:215], v4, s[32:35], s54 offen sc1
    s_waitcnt lgkmcnt(6)
    v_mfma_f32_16x16x32_bf16 v[48:51], v[148:151], v[180:183], v[48:51]
    s_waitcnt lgkmcnt(4)
    v_mfma_f32_16x16x32_bf16 v[52:55], v[152:155], v[180:183], v[52:55]
    buffer_load_dwordx4 v[216:219], v5, s[32:35], s54 offen sc1
    s_waitcnt lgkmcnt(2)
    v_mfma_f32_16x16x32_bf16 v[56:59], v[156:159], v[180:183], v[56:59]
    s_waitcnt lgkmcnt(0)
    v_mfma_f32_16x16x32_bf16 v[60:63], v[160:163], v[180:183], v[60:63]
    buffer_load_dwordx4 v[220:223], v6, s[32:35], s54 offen sc1
    v_mfma_f32_16x16x32_bf16 v[64:67], v[144:147], v[184:187], v[64:67]
    ds_read_b64_tr_b16 v[124:125], v26 offset:28672
    v_mfma_f32_16x16x32_bf16 v[68:71], v[148:151], v[184:187], v[68:71]
    buffer_load_dwordx4 v[224:227], v7, s[32:35], s54 offen sc1
    ds_read_b64_tr_b16 v[126:127], v27 offset:28672
    v_mfma_f32_16x16x32_bf16 v[72:75], v[152:155], v[184:187], v[72:75]
    ds_read_b64_tr_b16 v[128:129], v26 offset:28704
    v_mfma_f32_16x16x32_bf16 v[76:79], v[156:159], v[184:187], v[76:79]
    ds_read_b64_tr_b16 v[130:131], v27 offset:28704
    v_mfma_f32_16x16x32_bf16 v[80:83], v[160:163], v[184:187], v[80:83]
    ds_read_b64_tr_b16 v[132:133], v26 offset:28736
    v_mfma_f32_16x16x32_bf16 v[84:87], v[144:147], v[188:191], v[84:87]
    s_add_u32 s54, s37, 4
    s_sub_u32 s38, s54, 12
    s_cmp_ge_u32 s54, 12
    s_cselect_b32 s54, s38, s54
    s_mul_i32 s54, s54, 131072
    s_add_u32 s54, s54, s53
    buffer_load_dwordx4 v[228:231], v4, s[32:35], s54 offen sc1
    ds_read_b64_tr_b16 v[134:135], v27 offset:28736
    v_mfma_f32_16x16x32_bf16 v[88:91], v[148:151], v[188:191], v[88:91]
    ds_read_b64_tr_b16 v[136:137], v26 offset:28768
    v_mfma_f32_16x16x32_bf16 v[92:95], v[152:155], v[188:191], v[92:95]
    buffer_load_dwordx4 v[232:235], v5, s[32:35], s54 offen sc1
    ds_read_b64_tr_b16 v[138:139], v27 offset:28768
    v_mfma_f32_16x16x32_bf16 v[96:99], v[156:159], v[188:191], v[96:99]
    ds_read_b64_tr_b16 v[140:141], v26 offset:28800
    v_mfma_f32_16x16x32_bf16 v[100:103], v[160:163], v[188:191], v[100:103]
    buffer_load_dwordx4 v[236:239], v6, s[32:35], s54 offen sc1
    ds_read_b64_tr_b16 v[142:143], v27 offset:28800
    v_mfma_f32_16x16x32_bf16 v[104:107], v[144:147], v[192:195], v[104:107]
    s_waitcnt vmcnt(7)
    v_max3_u32 v14, v196, v197, v198
    v_max3_u32 v14, v14, v199, v200
    v_mfma_f32_16x16x32_bf16 v[108:111], v[148:151], v[192:195], v[108:111]
    buffer_load_dwordx4 v[240:243], v7, s[32:35], s54 offen sc1
    v_max3_u32 v14, v14, v201, v202
    v_max3_u32 v14, v14, v203, v204
    v_mfma_f32_16x16x32_bf16 v[112:115], v[152:155], v[192:195], v[112:115]
    v_max3_u32 v14, v14, v205, v206
    v_max3_u32 v14, v14, v207, v208
    v_mfma_f32_16x16x32_bf16 v[116:119], v[156:159], v[192:195], v[116:119]
    v_max3_u32 v14, v14, v209, v210
    v_max_u32 v14, v14, v211
    v_mfma_f32_16x16x32_bf16 v[120:123], v[160:163], v[192:195], v[120:123]
    v_cmp_eq_u32 vcc, -1, v14
    s_cbranch_vccnz SLOW_190
BACK_191:
    s_waitcnt lgkmcnt(8)
    v_mfma_f32_16x16x32_bf16 v[44:47], v[124:127], v[196:199], v[44:47]
    s_add_u32 s54, s37, 5
    s_sub_u32 s38, s54, 12
    s_cmp_ge_u32 s54, 12
    s_cselect_b32 s54, s38, s54
    s_mul_i32 s54, s54, 131072
    s_add_u32 s54, s54, s53
    buffer_load_dwordx4 v[164:167], v4, s[32:35], s54 offen sc1
    s_waitcnt lgkmcnt(6)
    v_mfma_f32_16x16x32_bf16 v[48:51], v[128:131], v[196:199], v[48:51]
    s_waitcnt lgkmcnt(4)
    v_mfma_f32_16x16x32_bf16 v[52:55], v[132:135], v[196:199], v[52:55]
    buffer_load_dwordx4 v[168:171], v5, s[32:35], s54 offen sc1
    s_waitcnt lgkmcnt(2)
    v_mfma_f32_16x16x32_bf16 v[56:59], v[136:139], v[196:199], v[56:59]
    s_waitcnt lgkmcnt(0)
    v_mfma_f32_16x16x32_bf16 v[60:63], v[140:143], v[196:199], v[60:63]
    buffer_load_dwordx4 v[172:175], v6, s[32:35], s54 offen sc1
    v_mfma_f32_16x16x32_bf16 v[64:67], v[124:127], v[200:203], v[64:67]
    s_waitcnt lgkmcnt(0)
    s_barrier
    ds_read_b64_tr_b16 v[144:145], v26 offset:49152
    v_mfma_f32_16x16x32_bf16 v[68:71], v[128:131], v[200:203], v[68:71]
    buffer_load_dwordx4 v[176:179], v7, s[32:35], s54 offen sc1
    ds_read_b64_tr_b16 v[146:147], v27 offset:49152
    v_mfma_f32_16x16x32_bf16 v[72:75], v[132:135], v[200:203], v[72:75]
    ds_read_b64_tr_b16 v[148:149], v26 offset:49184
    v_mfma_f32_16x16x32_bf16 v[76:79], v[136:139], v[200:203], v[76:79]
    ds_read_b64_tr_b16 v[150:151], v27 offset:49184
    v_mfma_f32_16x16x32_bf16 v[80:83], v[140:143], v[200:203], v[80:83]
    ds_read_b64_tr_b16 v[152:153], v26 offset:49216
    v_mfma_f32_16x16x32_bf16 v[84:87], v[124:127], v[204:207], v[84:87]
    s_add_u32 s54, s37, 6
    s_sub_u32 s38, s54, 12
    s_cmp_ge_u32 s54, 12
    s_cselect_b32 s54, s38, s54
    s_mul_i32 s54, s54, 131072
    s_add_u32 s54, s54, s53
    buffer_load_dwordx4 v[180:183], v4, s[32:35], s54 offen sc1
    ds_read_b64_tr_b16 v[154:155], v27 offset:49216
    v_mfma_f32_16x16x32_bf16 v[88:91], v[128:131], v[204:207], v[88:91]
    ds_read_b64_tr_b16 v[156:157], v26 offset:49248
    v_mfma_f32_16x16x32_bf16 v[92:95], v[132:135], v[204:207], v[92:95]
    buffer_load_dwordx4 v[184:187], v5, s[32:35], s54 offen sc1
    ds_read_b64_tr_b16 v[158:159], v27 offset:49248
    v_mfma_f32_16x16x32_bf16 v[96:99], v[136:139], v[204:207], v[96:99]
    ds_read_b64_tr_b16 v[160:161], v26 offset:49280
    v_mfma_f32_16x16x32_bf16 v[100:103], v[140:143], v[204:207], v[100:103]
    buffer_load_dwordx4 v[188:191], v6, s[32:35], s54 offen sc1
    ds_read_b64_tr_b16 v[162:163], v27 offset:49280
    v_mfma_f32_16x16x32_bf16 v[104:107], v[124:127], v[208:211], v[104:107]
    s_waitcnt vmcnt(11)
    v_max3_u32 v14, v212, v213, v214
    v_max3_u32 v14, v14, v215, v216
    v_mfma_f32_16x16x32_bf16 v[108:111], v[128:131], v[208:211], v[108:111]
    buffer_load_dwordx4 v[192:195], v7, s[32:35], s54 offen sc1
    v_max3_u32 v14, v14, v217, v218
    v_max3_u32 v14, v14, v219, v220
    v_mfma_f32_16x16x32_bf16 v[112:115], v[132:135], v[208:211], v[112:115]
    v_max3_u32 v14, v14, v221, v222
    v_max3_u32 v14, v14, v223, v224
    v_mfma_f32_16x16x32_bf16 v[116:119], v[136:139], v[208:211], v[116:119]
    v_max3_u32 v14, v14, v225, v226
    v_max_u32 v14, v14, v227
    v_mfma_f32_16x16x32_bf16 v[120:123], v[140:143], v[208:211], v[120:123]
    v_cmp_eq_u32 vcc, -1, v14
    s_cbranch_vccnz SLOW_193
BACK_194:
    s_waitcnt lgkmcnt(8)
    v_mfma_f32_16x16x32_bf16 v[44:47], v[144:147], v[212:215], v[44:47]
    s_add_u32 s54, s37, 7
    s_sub_u32 s38, s54, 12
    s_cmp_ge_u32 s54, 12
    s_cselect_b32 s54, s38, s54
    s_mul_i32 s54, s54, 131072
    s_add_u32 s54, s54, s53
    buffer_load_dwordx4 v[196:199], v4, s[32:35], s54 offen sc1
    s_waitcnt lgkmcnt(6)
    v_mfma_f32_16x16x32_bf16 v[48:51], v[148:151], v[212:215], v[48:51]
    s_waitcnt lgkmcnt(4)
    v_mfma_f32_16x16x32_bf16 v[52:55], v[152:155], v[212:215], v[52:55]
    buffer_load_dwordx4 v[200:203], v5, s[32:35], s54 offen sc1
    s_waitcnt lgkmcnt(2)
    v_mfma_f32_16x16x32_bf16 v[56:59], v[156:159], v[212:215], v[56:59]
    s_waitcnt lgkmcnt(0)
    v_mfma_f32_16x16x32_bf16 v[60:63], v[160:163], v[212:215], v[60:63]
    buffer_load_dwordx4 v[204:207], v6, s[32:35], s54 offen sc1
    v_mfma_f32_16x16x32_bf16 v[64:67], v[144:147], v[216:219], v[64:67]
    ds_read_b64_tr_b16 v[124:125], v28 offset:8192
    v_mfma_f32_16x16x32_bf16 v[68:71], v[148:151], v[216:219], v[68:71]
    buffer_load_dwordx4 v[208:211], v7, s[32:35], s54 offen sc1
    ds_read_b64_tr_b16 v[126:127], v29 offset:8192
    v_mfma_f32_16x16x32_bf16 v[72:75], v[152:155], v[216:219], v[72:75]
    ds_read_b64_tr_b16 v[128:129], v28 offset:8224
    v_mfma_f32_16x16x32_bf16 v[76:79], v[156:159], v[216:219], v[76:79]
    ds_read_b64_tr_b16 v[130:131], v29 offset:8224
    v_mfma_f32_16x16x32_bf16 v[80:83], v[160:163], v[216:219], v[80:83]
    ds_read_b64_tr_b16 v[132:133], v28 offset:8256
    v_mfma_f32_16x16x32_bf16 v[84:87], v[144:147], v[220:223], v[84:87]
    ds_read_b64_tr_b16 v[134:135], v29 offset:8256
    v_mfma_f32_16x16x32_bf16 v[88:91], v[148:151], v[220:223], v[88:91]
    ds_read_b64_tr_b16 v[136:137], v28 offset:8288
    v_mfma_f32_16x16x32_bf16 v[92:95], v[152:155], v[220:223], v[92:95]
    ds_read_b64_tr_b16 v[138:139], v29 offset:8288
    v_mfma_f32_16x16x32_bf16 v[96:99], v[156:159], v[220:223], v[96:99]
    ds_read_b64_tr_b16 v[140:141], v28 offset:8320
    v_mfma_f32_16x16x32_bf16 v[100:103], v[160:163], v[220:223], v[100:103]
    ds_read_b64_tr_b16 v[142:143], v29 offset:8320
    v_mfma_f32_16x16x32_bf16 v[104:107], v[144:147], v[224:227], v[104:107]
    s_waitcnt vmcnt(12)
    v_max3_u32 v14, v228, v229, v230
    v_max3_u32 v14, v14, v231, v232
    v_mfma_f32_16x16x32_bf16 v[108:111], v[148:151], v[224:227], v[108:111]
    v_max3_u32 v14, v14, v233, v234
    v_max3_u32 v14, v14, v235, v236
    v_mfma_f32_16x16x32_bf16 v[112:115], v[152:155], v[224:227], v[112:115]
    v_max3_u32 v14, v14, v237, v238
    v_max3_u32 v14, v14, v239, v240
    v_mfma_f32_16x16x32_bf16 v[116:119], v[156:159], v[224:227], v[116:119]
    v_max3_u32 v14, v14, v241, v242
    v_max_u32 v14, v14, v243
    v_mfma_f32_16x16x32_bf16 v[120:123], v[160:163], v[224:227], v[120:123]
    v_cmp_eq_u32 vcc, -1, v14
    s_cbranch_vccnz SLOW_196
BACK_197:
    s_waitcnt lgkmcnt(8)
    v_mfma_f32_16x16x32_bf16 v[44:47], v[124:127], v[228:231], v[44:47]
    s_add_u32 s54, s37, 8
    s_sub_u32 s38, s54, 12
    s_cmp_ge_u32 s54, 12
    s_cselect_b32 s54, s38, s54
    s_mul_i32 s54, s54, 131072
    s_add_u32 s54, s54, s53
    buffer_load_dwordx4 v[212:215], v4, s[32:35], s54 offen sc1
    s_waitcnt lgkmcnt(6)
    v_mfma_f32_16x16x32_bf16 v[48:51], v[128:131], v[228:231], v[48:51]
    s_waitcnt lgkmcnt(4)
    v_mfma_f32_16x16x32_bf16 v[52:55], v[132:135], v[228:231], v[52:55]
    buffer_load_dwordx4 v[216:219], v5, s[32:35], s54 offen sc1
    s_waitcnt lgkmcnt(2)
    v_mfma_f32_16x16x32_bf16 v[56:59], v[136:139], v[228:231], v[56:59]
    s_waitcnt lgkmcnt(0)
    v_mfma_f32_16x16x32_bf16 v[60:63], v[140:143], v[228:231], v[60:63]
    buffer_load_dwordx4 v[220:223], v6, s[32:35], s54 offen sc1
    v_mfma_f32_16x16x32_bf16 v[64:67], v[124:127], v[232:235], v[64:67]
    s_waitcnt lgkmcnt(0)
    s_barrier
    ds_read_b64_tr_b16 v[144:145], v24 offset:0
    v_mfma_f32_16x16x32_bf16 v[68:71], v[128:131], v[232:235], v[68:71]
    buffer_load_dwordx4 v[224:227], v7, s[32:35], s54 offen sc1
    ds_read_b64_tr_b16 v[146:147], v25 offset:0
    v_mfma_f32_16x16x32_bf16 v[72:75], v[132:135], v[232:235], v[72:75]
    ds_read_b64_tr_b16 v[148:149], v24 offset:32
    v_mfma_f32_16x16x32_bf16 v[76:79], v[136:139], v[232:235], v[76:79]
    ds_read_b64_tr_b16 v[150:151], v25 offset:32
    v_mfma_f32_16x16x32_bf16 v[80:83], v[140:143], v[232:235], v[80:83]
    ds_read_b64_tr_b16 v[152:153], v24 offset:64
    v_mfma_f32_16x16x32_bf16 v[84:87], v[124:127], v[236:239], v[84:87]
    ds_read_b64_tr_b16 v[154:155], v25 offset:64
    v_mfma_f32_16x16x32_bf16 v[88:91], v[128:131], v[236:239], v[88:91]
    ds_read_b64_tr_b16 v[156:157], v24 offset:96
    v_mfma_f32_16x16x32_bf16 v[92:95], v[132:135], v[236:239], v[92:95]
    ds_read_b64_tr_b16 v[158:159], v25 offset:96
    v_mfma_f32_16x16x32_bf16 v[96:99], v[136:139], v[236:239], v[96:99]
    ds_read_b64_tr_b16 v[160:161], v24 offset:128
    v_mfma_f32_16x16x32_bf16 v[100:103], v[140:143], v[236:239], v[100:103]
    ds_read_b64_tr_b16 v[162:163], v25 offset:128
    v_mfma_f32_16x16x32_bf16 v[104:107], v[124:127], v[240:243], v[104:107]
    s_waitcnt vmcnt(12)
    v_max3_u32 v14, v164, v165, v166
    v_max3_u32 v14, v14, v167, v168
    v_mfma_f32_16x16x32_bf16 v[108:111], v[128:131], v[240:243], v[108:111]
    v_max3_u32 v14, v14, v169, v170
    v_max3_u32 v14, v14, v171, v172
    v_mfma_f32_16x16x32_bf16 v[112:115], v[132:135], v[240:243], v[112:115]
    v_max3_u32 v14, v14, v173, v174
    v_max3_u32 v14, v14, v175, v176
    v_mfma_f32_16x16x32_bf16 v[116:119], v[136:139], v[240:243], v[116:119]
    v_max3_u32 v14, v14, v177, v178
    v_max_u32 v14, v14, v179
    v_mfma_f32_16x16x32_bf16 v[120:123], v[140:143], v[240:243], v[120:123]
    v_cmp_eq_u32 vcc, -1, v14
    s_cbranch_vccnz SLOW_199
BACK_200:
    s_waitcnt lgkmcnt(8)
    v_mfma_f32_16x16x32_bf16 v[44:47], v[144:147], v[164:167], v[44:47]
    s_add_u32 s54, s37, 9
    s_sub_u32 s38, s54, 12
    s_cmp_ge_u32 s54, 12
    s_cselect_b32 s54, s38, s54
    s_mul_i32 s54, s54, 131072
    s_add_u32 s54, s54, s53
    buffer_load_dwordx4 v[228:231], v4, s[32:35], s54 offen sc1
    s_waitcnt lgkmcnt(6)
    v_mfma_f32_16x16x32_bf16 v[48:51], v[148:151], v[164:167], v[48:51]
    s_waitcnt lgkmcnt(4)
    v_mfma_f32_16x16x32_bf16 v[52:55], v[152:155], v[164:167], v[52:55]
    buffer_load_dwordx4 v[232:235], v5, s[32:35], s54 offen sc1
    s_waitcnt lgkmcnt(2)
    v_mfma_f32_16x16x32_bf16 v[56:59], v[156:159], v[164:167], v[56:59]
    s_waitcnt lgkmcnt(0)
    v_mfma_f32_16x16x32_bf16 v[60:63], v[160:163], v[164:167], v[60:63]
    buffer_load_dwordx4 v[236:239], v6, s[32:35], s54 offen sc1
    v_mfma_f32_16x16x32_bf16 v[64:67], v[144:147], v[168:171], v[64:67]
    ds_read_b64_tr_b16 v[124:125], v24 offset:20480
    v_mfma_f32_16x16x32_bf16 v[68:71], v[148:151], v[168:171], v[68:71]
    buffer_load_dwordx4 v[240:243], v7, s[32:35], s54 offen sc1
    ds_read_b64_tr_b16 v[126:127], v25 offset:20480
    v_mfma_f32_16x16x32_bf16 v[72:75], v[152:155], v[168:171], v[72:75]
    ds_read_b64_tr_b16 v[128:129], v24 offset:20512
    v_mfma_f32_16x16x32_bf16 v[76:79], v[156:159], v[168:171], v[76:79]
    ds_read_b64_tr_b16 v[130:131], v25 offset:20512
    v_mfma_f32_16x16x32_bf16 v[80:83], v[160:163], v[168:171], v[80:83]
    ds_read_b64_tr_b16 v[132:133], v24 offset:20544
    v_mfma_f32_16x16x32_bf16 v[84:87], v[144:147], v[172:175], v[84:87]
    ds_read_b64_tr_b16 v[134:135], v25 offset:20544
    v_mfma_f32_16x16x32_bf16 v[88:91], v[148:151], v[172:175], v[88:91]
    ds_read_b64_tr_b16 v[136:137], v24 offset:20576
    v_mfma_f32_16x16x32_bf16 v[92:95], v[152:155], v[172:175], v[92:95]
    ds_read_b64_tr_b16 v[138:139], v25 offset:20576
    v_mfma_f32_16x16x32_bf16 v[96:99], v[156:159], v[172:175], v[96:99]
    ds_read_b64_tr_b16 v[140:141], v24 offset:20608
    v_mfma_f32_16x16x32_bf16 v[100:103], v[160:163], v[172:175], v[100:103]
    ds_read_b64_tr_b16 v[142:143], v25 offset:20608
    v_mfma_f32_16x16x32_bf16 v[104:107], v[144:147], v[176:179], v[104:107]
    s_waitcnt vmcnt(12)
    v_max3_u32 v14, v180, v181, v182
    v_max3_u32 v14, v14, v183, v184
    v_mfma_f32_16x16x32_bf16 v[108:111], v[148:151], v[176:179], v[108:111]
    v_max3_u32 v14, v14, v185, v186
    v_max3_u32 v14, v14, v187, v188
    v_mfma_f32_16x16x32_bf16 v[112:115], v[152:155], v[176:179], v[112:115]
    v_max3_u32 v14, v14, v189, v190
    v_max3_u32 v14, v14, v191, v192
    v_mfma_f32_16x16x32_bf16 v[116:119], v[156:159], v[176:179], v[116:119]
    v_max3_u32 v14, v14, v193, v194
    v_max_u32 v14, v14, v195
    v_mfma_f32_16x16x32_bf16 v[120:123], v[160:163], v[176:179], v[120:123]
    v_cmp_eq_u32 vcc, -1, v14
    s_cbranch_vccnz SLOW_202
BACK_203:
    s_waitcnt lgkmcnt(8)
    v_mfma_f32_16x16x32_bf16 v[44:47], v[124:127], v[180:183], v[44:47]
    s_add_u32 s54, s37, 10
    s_sub_u32 s38, s54, 12
    s_cmp_ge_u32 s54, 12
    s_cselect_b32 s54, s38, s54
    s_mul_i32 s54, s54, 131072
    s_add_u32 s54, s54, s53
    buffer_load_dwordx4 v[164:167], v4, s[32:35], s54 offen sc1
    s_waitcnt lgkmcnt(6)
    v_mfma_f32_16x16x32_bf16 v[48:51], v[128:131], v[180:183], v[48:51]
    s_waitcnt lgkmcnt(4)
    v_mfma_f32_16x16x32_bf16 v[52:55], v[132:135], v[180:183], v[52:55]
    buffer_load_dwordx4 v[168:171], v5, s[32:35], s54 offen sc1
    s_waitcnt lgkmcnt(2)
    v_mfma_f32_16x16x32_bf16 v[56:59], v[136:139], v[180:183], v[56:59]
    s_waitcnt lgkmcnt(0)
    v_mfma_f32_16x16x32_bf16 v[60:63], v[140:143], v[180:183], v[60:63]
    buffer_load_dwordx4 v[172:175], v6, s[32:35], s54 offen sc1
    v_mfma_f32_16x16x32_bf16 v[64:67], v[124:127], v[184:187], v[64:67]
    s_waitcnt lgkmcnt(0)
    s_barrier
    ds_read_b64_tr_b16 v[144:145], v24 offset:49152
    v_mfma_f32_16x16x32_bf16 v[68:71], v[128:131], v[184:187], v[68:71]
    buffer_load_dwordx4 v[176:179], v7, s[32:35], s54 offen sc1
    ds_read_b64_tr_b16 v[146:147], v25 offset:49152
    v_mfma_f32_16x16x32_bf16 v[72:75], v[132:135], v[184:187], v[72:75]
    ds_read_b64_tr_b16 v[148:149], v24 offset:49184
    v_mfma_f32_16x16x32_bf16 v[76:79], v[136:139], v[184:187], v[76:79]
    ds_read_b64_tr_b16 v[150:151], v25 offset:49184
    v_mfma_f32_16x16x32_bf16 v[80:83], v[140:143], v[184:187], v[80:83]
    ds_read_b64_tr_b16 v[152:153], v24 offset:49216
    v_mfma_f32_16x16x32_bf16 v[84:87], v[124:127], v[188:191], v[84:87]
    ds_read_b64_tr_b16 v[154:155], v25 offset:49216
    v_mfma_f32_16x16x32_bf16 v[88:91], v[128:131], v[188:191], v[88:91]
    ds_read_b64_tr_b16 v[156:157], v24 offset:49248
    v_mfma_f32_16x16x32_bf16 v[92:95], v[132:135], v[188:191], v[92:95]
    ds_read_b64_tr_b16 v[158:159], v25 offset:49248
    v_mfma_f32_16x16x32_bf16 v[96:99], v[136:139], v[188:191], v[96:99]
    ds_read_b64_tr_b16 v[160:161], v24 offset:49280
    v_mfma_f32_16x16x32_bf16 v[100:103], v[140:143], v[188:191], v[100:103]
    ds_read_b64_tr_b16 v[162:163], v25 offset:49280
    v_mfma_f32_16x16x32_bf16 v[104:107], v[124:127], v[192:195], v[104:107]
    s_waitcnt vmcnt(12)
    v_max3_u32 v14, v196, v197, v198
    v_max3_u32 v14, v14, v199, v200
    v_mfma_f32_16x16x32_bf16 v[108:111], v[128:131], v[192:195], v[108:111]
    v_max3_u32 v14, v14, v201, v202
    v_max3_u32 v14, v14, v203, v204
    v_mfma_f32_16x16x32_bf16 v[112:115], v[132:135], v[192:195], v[112:115]
    v_max3_u32 v14, v14, v205, v206
    v_max3_u32 v14, v14, v207, v208
    v_mfma_f32_16x16x32_bf16 v[116:119], v[136:139], v[192:195], v[116:119]
    v_max3_u32 v14, v14, v209, v210
    v_max_u32 v14, v14, v211
    v_mfma_f32_16x16x32_bf16 v[120:123], v[140:143], v[192:195], v[120:123]
    v_cmp_eq_u32 vcc, -1, v14
    s_cbranch_vccnz SLOW_205
BACK_206:
    s_waitcnt lgkmcnt(8)
    v_mfma_f32_16x16x32_bf16 v[44:47], v[144:147], v[196:199], v[44:47]
    s_add_u32 s54, s37, 11
    s_sub_u32 s38, s54, 12
    s_cmp_ge_u32 s54, 12
    s_cselect_b32 s54, s38, s54
    s_mul_i32 s54, s54, 131072
    s_add_u32 s54, s54, s53
    buffer_load_dwordx4 v[180:183], v4, s[32:35], s54 offen sc1
    s_waitcnt lgkmcnt(6)
    v_mfma_f32_16x16x32_bf16 v[48:51], v[148:151], v[196:199], v[48:51]
    s_waitcnt lgkmcnt(4)
    v_mfma_f32_16x16x32_bf16 v[52:55], v[152:155], v[196:199], v[52:55]
    buffer_load_dwordx4 v[184:187], v5, s[32:35], s54 offen sc1
    s_waitcnt lgkmcnt(2)
    v_mfma_f32_16x16x32_bf16 v[56:59], v[156:159], v[196:199], v[56:59]
    s_waitcnt lgkmcnt(0)
    v_mfma_f32_16x16x32_bf16 v[60:63], v[160:163], v[196:199], v[60:63]
    buffer_load_dwordx4 v[188:191], v6, s[32:35], s54 offen sc1
    v_mfma_f32_16x16x32_bf16 v[64:67], v[144:147], v[200:203], v[64:67]
    ds_read_b64_tr_b16 v[124:125], v26 offset:8192
    v_mfma_f32_16x16x32_bf16 v[68:71], v[148:151], v[200:203], v[68:71]
    buffer_load_dwordx4 v[192:195], v7, s[32:35], s54 offen sc1
    ds_read_b64_tr_b16 v[126:127], v27 offset:8192
    v_mfma_f32_16x16x32_bf16 v[72:75], v[152:155], v[200:203], v[72:75]
    ds_read_b64_tr_b16 v[128:129], v26 offset:8224
    v_mfma_f32_16x16x32_bf16 v[76:79], v[156:159], v[200:203], v[76:79]
    ds_read_b64_tr_b16 v[130:131], v27 offset:8224
    v_mfma_f32_16x16x32_bf16 v[80:83], v[160:163], v[200:203], v[80:83]
    ds_read_b64_tr_b16 v[132:133], v26 offset:8256
    v_mfma_f32_16x16x32_bf16 v[84:87], v[144:147], v[204:207], v[84:87]
    ds_read_b64_tr_b16 v[134:135], v27 offset:8256
    v_mfma_f32_16x16x32_bf16 v[88:91], v[148:151], v[204:207], v[88:91]
    ds_read_b64_tr_b16 v[136:137], v26 offset:8288
    v_mfma_f32_16x16x32_bf16 v[92:95], v[152:155], v[204:207], v[92:95]
    ds_read_b64_tr_b16 v[138:139], v27 offset:8288
    v_mfma_f32_16x16x32_bf16 v[96:99], v[156:159], v[204:207], v[96:99]
    ds_read_b64_tr_b16 v[140:141], v26 offset:8320
    v_mfma_f32_16x16x32_bf16 v[100:103], v[160:163], v[204:207], v[100:103]
    ds_read_b64_tr_b16 v[142:143], v27 offset:8320
    v_mfma_f32_16x16x32_bf16 v[104:107], v[144:147], v[208:211], v[104:107]
    s_waitcnt vmcnt(12)
    v_max3_u32 v14, v212, v213, v214
    v_max3_u32 v14, v14, v215, v216
    v_mfma_f32_16x16x32_bf16 v[108:111], v[148:151], v[208:211], v[108:111]
    v_max3_u32 v14, v14, v217, v218
    v_max3_u32 v14, v14, v219, v220
    v_mfma_f32_16x16x32_bf16 v[112:115], v[152:155], v[208:211], v[112:115]
    v_max3_u32 v14, v14, v221, v222
    v_max3_u32 v14, v14, v223, v224
    v_mfma_f32_16x16x32_bf16 v[116:119], v[156:159], v[208:211], v[116:119]
    v_max3_u32 v14, v14, v225, v226
    v_max_u32 v14, v14, v227
    v_mfma_f32_16x16x32_bf16 v[120:123], v[160:163], v[208:211], v[120:123]
    v_cmp_eq_u32 vcc, -1, v14
    s_cbranch_vccnz SLOW_208
BACK_209:
    s_waitcnt lgkmcnt(8)
    v_mfma_f32_16x16x32_bf16 v[44:47], v[124:127], v[212:215], v[44:47]
    s_waitcnt lgkmcnt(6)
    v_mfma_f32_16x16x32_bf16 v[48:51], v[128:131], v[212:215], v[48:51]
    s_waitcnt lgkmcnt(4)
    v_mfma_f32_16x16x32_bf16 v[52:55], v[132:135], v[212:215], v[52:55]
    s_waitcnt lgkmcnt(2)
    v_mfma_f32_16x16x32_bf16 v[56:59], v[136:139], v[212:215], v[56:59]
    s_waitcnt lgkmcnt(0)
    v_mfma_f32_16x16x32_bf16 v[60:63], v[140:143], v[212:215], v[60:63]
    v_mfma_f32_16x16x32_bf16 v[64:67], v[124:127], v[216:219], v[64:67]
    s_waitcnt lgkmcnt(0)
    s_barrier
    ds_read_b64_tr_b16 v[144:145], v26 offset:28672
    v_mfma_f32_16x16x32_bf16 v[68:71], v[128:131], v[216:219], v[68:71]
    ds_read_b64_tr_b16 v[146:147], v27 offset:28672
    v_mfma_f32_16x16x32_bf16 v[72:75], v[132:135], v[216:219], v[72:75]
    ds_read_b64_tr_b16 v[148:149], v26 offset:28704
    v_mfma_f32_16x16x32_bf16 v[76:79], v[136:139], v[216:219], v[76:79]
    ds_read_b64_tr_b16 v[150:151], v27 offset:28704
    v_mfma_f32_16x16x32_bf16 v[80:83], v[140:143], v[216:219], v[80:83]
    ds_read_b64_tr_b16 v[152:153], v26 offset:28736
    v_mfma_f32_16x16x32_bf16 v[84:87], v[124:127], v[220:223], v[84:87]
    ds_read_b64_tr_b16 v[154:155], v27 offset:28736
    v_mfma_f32_16x16x32_bf16 v[88:91], v[128:131], v[220:223], v[88:91]
    ds_read_b64_tr_b16 v[156:157], v26 offset:28768
    v_mfma_f32_16x16x32_bf16 v[92:95], v[132:135], v[220:223], v[92:95]
    ds_read_b64_tr_b16 v[158:159], v27 offset:28768
    v_mfma_f32_16x16x32_bf16 v[96:99], v[136:139], v[220:223], v[96:99]
    ds_read_b64_tr_b16 v[160:161], v26 offset:28800
    v_mfma_f32_16x16x32_bf16 v[100:103], v[140:143], v[220:223], v[100:103]
    ds_read_b64_tr_b16 v[162:163], v27 offset:28800
    v_mfma_f32_16x16x32_bf16 v[104:107], v[124:127], v[224:227], v[104:107]
    s_waitcnt vmcnt(8)
    v_max3_u32 v14, v228, v229, v230
    v_max3_u32 v14, v14, v231, v232
    v_mfma_f32_16x16x32_bf16 v[108:111], v[128:131], v[224:227], v[108:111]
    v_max3_u32 v14, v14, v233, v234
    v_max3_u32 v14, v14, v235, v236
    v_mfma_f32_16x16x32_bf16 v[112:115], v[132:135], v[224:227], v[112:115]
    v_max3_u32 v14, v14, v237, v238
    v_max3_u32 v14, v14, v239, v240
    v_mfma_f32_16x16x32_bf16 v[116:119], v[136:139], v[224:227], v[116:119]
    v_max3_u32 v14, v14, v241, v242
    v_max_u32 v14, v14, v243
    v_mfma_f32_16x16x32_bf16 v[120:123], v[140:143], v[224:227], v[120:123]
    v_cmp_eq_u32 vcc, -1, v14
    s_cbranch_vccnz SLOW_211
BACK_212:
    s_waitcnt lgkmcnt(8)
    v_mfma_f32_16x16x32_bf16 v[44:47], v[144:147], v[228:231], v[44:47]
    s_waitcnt lgkmcnt(6)
    v_mfma_f32_16x16x32_bf16 v[48:51], v[148:151], v[228:231], v[48:51]
    s_waitcnt lgkmcnt(4)
    v_mfma_f32_16x16x32_bf16 v[52:55], v[152:155], v[228:231], v[52:55]
    s_waitcnt lgkmcnt(2)
    v_mfma_f32_16x16x32_bf16 v[56:59], v[156:159], v[228:231], v[56:59]
    s_waitcnt lgkmcnt(0)
    v_mfma_f32_16x16x32_bf16 v[60:63], v[160:163], v[228:231], v[60:63]
    v_mfma_f32_16x16x32_bf16 v[64:67], v[144:147], v[232:235], v[64:67]
    ds_read_b64_tr_b16 v[124:125], v26 offset:49152
    v_mfma_f32_16x16x32_bf16 v[68:71], v[148:151], v[232:235], v[68:71]
    ds_read_b64_tr_b16 v[126:127], v27 offset:49152
    v_mfma_f32_16x16x32_bf16 v[72:75], v[152:155], v[232:235], v[72:75]
    ds_read_b64_tr_b16 v[128:129], v26 offset:49184
    v_mfma_f32_16x16x32_bf16 v[76:79], v[156:159], v[232:235], v[76:79]
    ds_read_b64_tr_b16 v[130:131], v27 offset:49184
    v_mfma_f32_16x16x32_bf16 v[80:83], v[160:163], v[232:235], v[80:83]
    ds_read_b64_tr_b16 v[132:133], v26 offset:49216
    v_mfma_f32_16x16x32_bf16 v[84:87], v[144:147], v[236:239], v[84:87]
    ds_read_b64_tr_b16 v[134:135], v27 offset:49216
    v_mfma_f32_16x16x32_bf16 v[88:91], v[148:151], v[236:239], v[88:91]
    ds_read_b64_tr_b16 v[136:137], v26 offset:49248
    v_mfma_f32_16x16x32_bf16 v[92:95], v[152:155], v[236:239], v[92:95]
    ds_read_b64_tr_b16 v[138:139], v27 offset:49248
    v_mfma_f32_16x16x32_bf16 v[96:99], v[156:159], v[236:239], v[96:99]
    ds_read_b64_tr_b16 v[140:141], v26 offset:49280
    v_mfma_f32_16x16x32_bf16 v[100:103], v[160:163], v[236:239], v[100:103]
    ds_read_b64_tr_b16 v[142:143], v27 offset:49280
    v_mfma_f32_16x16x32_bf16 v[104:107], v[144:147], v[240:243], v[104:107]
    s_waitcnt vmcnt(4)
    v_max3_u32 v14, v164, v165, v166
    v_max3_u32 v14, v14, v167, v168
    v_mfma_f32_16x16x32_bf16 v[108:111], v[148:151], v[240:243], v[108:111]
    v_max3_u32 v14, v14, v169, v170
    v_max3_u32 v14, v14, v171, v172
    v_mfma_f32_16x16x32_bf16 v[112:115], v[152:155], v[240:243], v[112:115]
    v_max3_u32 v14, v14, v173, v174
    v_max3_u32 v14, v14, v175, v176
    v_mfma_f32_16x16x32_bf16 v[116:119], v[156:159], v[240:243], v[116:119]
    v_max3_u32 v14, v14, v177, v178
    v_max_u32 v14, v14, v179
    v_mfma_f32_16x16x32_bf16 v[120:123], v[160:163], v[240:243], v[120:123]
    v_cmp_eq_u32 vcc, -1, v14
    s_cbranch_vccnz SLOW_214
BACK_215:
    s_waitcnt lgkmcnt(8)
    v_mfma_f32_16x16x32_bf16 v[44:47], v[124:127], v[164:167], v[44:47]
    s_waitcnt lgkmcnt(6)
    v_mfma_f32_16x16x32_bf16 v[48:51], v[128:131], v[164:167], v[48:51]
    s_waitcnt lgkmcnt(4)
    v_mfma_f32_16x16x32_bf16 v[52:55], v[132:135], v[164:167], v[52:55]
    s_waitcnt lgkmcnt(2)
    v_mfma_f32_16x16x32_bf16 v[56:59], v[136:139], v[164:167], v[56:59]
    s_waitcnt lgkmcnt(0)
    v_mfma_f32_16x16x32_bf16 v[60:63], v[140:143], v[164:167], v[60:63]
    v_mfma_f32_16x16x32_bf16 v[64:67], v[124:127], v[168:171], v[64:67]
    s_waitcnt lgkmcnt(0)
    s_barrier
    ds_read_b64_tr_b16 v[144:145], v28 offset:8192
    v_mfma_f32_16x16x32_bf16 v[68:71], v[128:131], v[168:171], v[68:71]
    ds_read_b64_tr_b16 v[146:147], v29 offset:8192
    v_mfma_f32_16x16x32_bf16 v[72:75], v[132:135], v[168:171], v[72:75]
    ds_read_b64_tr_b16 v[148:149], v28 offset:8224
    v_mfma_f32_16x16x32_bf16 v[76:79], v[136:139], v[168:171], v[76:79]
    ds_read_b64_tr_b16 v[150:151], v29 offset:8224
    v_mfma_f32_16x16x32_bf16 v[80:83], v[140:143], v[168:171], v[80:83]
    ds_read_b64_tr_b16 v[152:153], v28 offset:8256
    v_mfma_f32_16x16x32_bf16 v[84:87], v[124:127], v[172:175], v[84:87]
    ds_read_b64_tr_b16 v[154:155], v29 offset:8256
    v_mfma_f32_16x16x32_bf16 v[88:91], v[128:131], v[172:175], v[88:91]
    ds_read_b64_tr_b16 v[156:157], v28 offset:8288
    v_mfma_f32_16x16x32_bf16 v[92:95], v[132:135], v[172:175], v[92:95]
    ds_read_b64_tr_b16 v[158:159], v29 offset:8288
    v_mfma_f32_16x16x32_bf16 v[96:99], v[136:139], v[172:175], v[96:99]
    ds_read_b64_tr_b16 v[160:161], v28 offset:8320
    v_mfma_f32_16x16x32_bf16 v[100:103], v[140:143], v[172:175], v[100:103]
    ds_read_b64_tr_b16 v[162:163], v29 offset:8320
    v_mfma_f32_16x16x32_bf16 v[104:107], v[124:127], v[176:179], v[104:107]
    s_waitcnt vmcnt(0)
    v_max3_u32 v14, v180, v181, v182
    v_max3_u32 v14, v14, v183, v184
    v_mfma_f32_16x16x32_bf16 v[108:111], v[128:131], v[176:179], v[108:111]
    v_max3_u32 v14, v14, v185, v186
    v_max3_u32 v14, v14, v187, v188
    v_mfma_f32_16x16x32_bf16 v[112:115], v[132:135], v[176:179], v[112:115]
    v_max3_u32 v14, v14, v189, v190
    v_max3_u32 v14, v14, v191, v192
    v_mfma_f32_16x16x32_bf16 v[116:119], v[136:139], v[176:179], v[116:119]
    v_max3_u32 v14, v14, v193, v194
    v_max_u32 v14, v14, v195
    v_mfma_f32_16x16x32_bf16 v[120:123], v[140:143], v[176:179], v[120:123]
    v_cmp_eq_u32 vcc, -1, v14
    s_cbranch_vccnz SLOW_217
BACK_218:
    s_waitcnt lgkmcnt(8)
    v_mfma_f32_16x16x32_bf16 v[64:67], v[144:147], v[184:187], v[64:67]
    s_waitcnt lgkmcnt(6)
    v_mfma_f32_16x16x32_bf16 v[68:71], v[148:151], v[184:187], v[68:71]
    s_waitcnt lgkmcnt(4)
    v_mfma_f32_16x16x32_bf16 v[72:75], v[152:155], v[184:187], v[72:75]
    s_waitcnt lgkmcnt(2)
    v_mfma_f32_16x16x32_bf16 v[76:79], v[156:159], v[184:187], v[76:79]
    s_waitcnt lgkmcnt(0)
    v_mfma_f32_16x16x32_bf16 v[80:83], v[160:163], v[184:187], v[80:83]
    v_mfma_f32_16x16x32_bf16 v[84:87], v[144:147], v[188:191], v[84:87]
    v_mfma_f32_16x16x32_bf16 v[88:91], v[148:151], v[188:191], v[88:91]
    v_mfma_f32_16x16x32_bf16 v[92:95], v[152:155], v[188:191], v[92:95]
    v_mfma_f32_16x16x32_bf16 v[96:99], v[156:159], v[188:191], v[96:99]
    v_mfma_f32_16x16x32_bf16 v[100:103], v[160:163], v[188:191], v[100:103]
    ds_write_b128 v30, v[64:67] offset:0
    v_mfma_f32_16x16x32_bf16 v[104:107], v[144:147], v[192:195], v[104:107]
    ds_write_b128 v30, v[68:71] offset:1024
    v_mfma_f32_16x16x32_bf16 v[108:111], v[148:151], v[192:195], v[108:111]
    ds_write_b128 v30, v[72:75] offset:2048
    v_mfma_f32_16x16x32_bf16 v[112:115], v[152:155], v[192:195], v[112:115]
    ds_write_b128 v30, v[76:79] offset:3072
    v_mfma_f32_16x16x32_bf16 v[116:119], v[156:159], v[192:195], v[116:119]
    ds_write_b128 v30, v[80:83] offset:4096
    v_mfma_f32_16x16x32_bf16 v[120:123], v[160:163], v[192:195], v[120:123]
    ds_write_b128 v30, v[84:87] offset:20480
    v_mfma_f32_16x16x32_bf16 v[44:47], v[144:147], v[180:183], v[44:47]
    ds_write_b128 v30, v[88:91] offset:21504
    v_mfma_f32_16x16x32_bf16 v[48:51], v[148:151], v[180:183], v[48:51]
    ds_write_b128 v30, v[92:95] offset:22528
    v_mfma_f32_16x16x32_bf16 v[52:55], v[152:155], v[180:183], v[52:55]
    ds_write_b128 v30, v[96:99] offset:23552
    v_mfma_f32_16x16x32_bf16 v[56:59], v[156:159], v[180:183], v[56:59]
    ds_write_b128 v30, v[100:103] offset:24576
    v_mfma_f32_16x16x32_bf16 v[60:63], v[160:163], v[180:183], v[60:63]
    ds_write_b128 v30, v[104:107] offset:49152
    ds_write_b128 v30, v[108:111] offset:50176
    ds_write_b128 v30, v[112:115] offset:51200
    ds_write_b128 v30, v[116:119] offset:52224
    ds_write_b128 v30, v[120:123] offset:53248
    s_mul_i32 s48, s45, 160
    s_mul_i32 s49, s46, 1280
    s_add_u32 s48, s48, s49
    s_waitcnt lgkmcnt(0)
    s_barrier
    ds_read_b128 v[124:127], v31 offset:0
    ds_read_b128 v[144:147], v32 offset:20480
    ds_read_b128 v[164:167], v33 offset:49152
    ds_read_b128 v[128:131], v31 offset:1024
    ds_read_b128 v[148:151], v32 offset:21504
    ds_read_b128 v[168:171], v33 offset:50176
    ds_read_b128 v[132:135], v31 offset:2048
    ds_read_b128 v[152:155], v32 offset:22528
    ds_read_b128 v[172:175], v33 offset:51200
    ds_read_b128 v[136:139], v31 offset:3072
    ds_read_b128 v[156:159], v32 offset:23552
    ds_read_b128 v[176:179], v33 offset:52224
    ds_read_b128 v[140:143], v31 offset:4096
    ds_read_b128 v[160:163], v32 offset:24576
    ds_read_b128 v[180:183], v33 offset:53248
    s_waitcnt lgkmcnt(12)
    v_pk_add_f32 v[124:125], v[124:125], v[144:145]
    v_pk_add_f32 v[44:45], v[44:45], v[164:165]
    v_pk_add_f32 v[126:127], v[126:127], v[146:147]
    v_pk_add_f32 v[46:47], v[46:47], v[166:167]
    v_pk_add_f32 v[44:45], v[44:45], v[124:125]
    v_pk_add_f32 v[46:47], v[46:47], v[126:127]
    v_cvt_pk_bf16_f32 v190, v44, v45
    v_cvt_pk_bf16_f32 v191, v46, v47
    ds_write_b64 v34, v[190:191] offset:0
    s_waitcnt lgkmcnt(10)
    v_pk_add_f32 v[128:129], v[128:129], v[148:149]
    v_pk_add_f32 v[48:49], v[48:49], v[168:169]
    v_pk_add_f32 v[130:131], v[130:131], v[150:151]
    v_pk_add_f32 v[50:51], v[50:51], v[170:171]
    v_pk_add_f32 v[48:49], v[48:49], v[128:129]
    v_pk_add_f32 v[50:51], v[50:51], v[130:131]
    v_cvt_pk_bf16_f32 v192, v48, v49
    v_cvt_pk_bf16_f32 v193, v50, v51
    ds_write_b64 v34, v[192:193] offset:32
    s_waitcnt lgkmcnt(8)
    v_pk_add_f32 v[132:133], v[132:133], v[152:153]
    v_pk_add_f32 v[52:53], v[52:53], v[172:173]
    v_pk_add_f32 v[134:135], v[134:135], v[154:155]
    v_pk_add_f32 v[54:55], v[54:55], v[174:175]
    v_pk_add_f32 v[52:53], v[52:53], v[132:133]
    v_pk_add_f32 v[54:55], v[54:55], v[134:135]
    v_cvt_pk_bf16_f32 v194, v52, v53
    v_cvt_pk_bf16_f32 v195, v54, v55
    ds_write_b64 v34, v[194:195] offset:64
    s_waitcnt lgkmcnt(6)
    v_pk_add_f32 v[136:137], v[136:137], v[156:157]
    v_pk_add_f32 v[56:57], v[56:57], v[176:177]
    v_pk_add_f32 v[138:139], v[138:139], v[158:159]
    v_pk_add_f32 v[58:59], v[58:59], v[178:179]
    v_pk_add_f32 v[56:57], v[56:57], v[136:137]
    v_pk_add_f32 v[58:59], v[58:59], v[138:139]
    v_cvt_pk_bf16_f32 v196, v56, v57
    v_cvt_pk_bf16_f32 v197, v58, v59
    ds_write_b64 v34, v[196:197] offset:96
    s_waitcnt lgkmcnt(4)
    v_pk_add_f32 v[140:141], v[140:141], v[160:161]
    v_pk_add_f32 v[60:61], v[60:61], v[180:181]
    v_pk_add_f32 v[142:143], v[142:143], v[162:163]
    v_pk_add_f32 v[62:63], v[62:63], v[182:183]
    v_pk_add_f32 v[60:61], v[60:61], v[140:141]
    v_pk_add_f32 v[62:63], v[62:63], v[142:143]
    v_cvt_pk_bf16_f32 v198, v60, v61
    v_cvt_pk_bf16_f32 v199, v62, v63
    ds_write_b64 v34, v[198:199] offset:128
    s_waitcnt lgkmcnt(0)
    ds_read_b128 v[168:171], v35
    ds_read_b128 v[172:175], v36
    ds_read_b128 v[176:179], v37
    s_waitcnt lgkmcnt(2)
    buffer_store_dwordx4 v[168:171], v38, s[28:31], s48 offen nt
    s_waitcnt lgkmcnt(1)
    buffer_store_dwordx4 v[172:175], v39, s[28:31], s48 offen nt
    s_waitcnt lgkmcnt(0)
    v_cmp_gt_u32 vcc, 32, v1
    s_nop 0
    s_mov_b64 exec, vcc
    buffer_store_dwordx4 v[176:179], v40, s[28:31], s48 offen nt
    s_mov_b64 exec, -1
    s_branch FIN_4
L3_3:
    s_barrier
    s_and_b32 s68, s41, 1
    s_lshl_b32 s68, s68, 3
    s_and_b32 s61, s42, 7
    s_add_u32 s61, s61, s68
    s_lshr_b32 s68, s41, 1
    s_lshl_b32 s68, s68, 2
    s_lshr_b32 s60, s42, 3
    s_add_u32 s60, s60, s68
    s_mul_i32 s76, s60, 3
    s_add_u32 s76, s76, s61
    s_mul_i32 s77, s76, 6554
    s_lshr_b32 s77, s77, 16
    s_mul_i32 s77, s77, 10
    s_sub_u32 s76, s76, s77
    s_cmp_lt_u32 s43, 2
    s_cselect_b32 s64, s16, s20
    s_cselect_b32 s65, s17, s21
    s_mov_b32 s66, 1966080
    s_mov_b32 s67, 0x00020000
    s_and_b32 s61, s43, 1
    s_mul_i32 s61, s61, 98304
    s_mul_i32 s60, s60, 192
    s_add_u32 s60, s60, s61
    v_add_u32 v56, 0, v1
    v_mul_u32_u24 v57, 5462, v56
    v_lshrrev_b32 v57, 16, v57
    v_mul_u32_u24 v58, 12, v57
    v_sub_u32 v58, v56, v58
    v_mul_u32_u24 v57, 3072, v57
    v_lshl_add_u32 v2, v58, 4, v57
    v_add_u32 v2, s60, v2
    v_add_u32 v56, 64, v1
    v_mul_u32_u24 v57, 5462, v56
    v_lshrrev_b32 v57, 16, v57
    v_mul_u32_u24 v58, 12, v57
    v_sub_u32 v58, v56, v58
    v_mul_u32_u24 v57, 3072, v57
    v_lshl_add_u32 v3, v58, 4, v57
    v_add_u32 v3, s60, v3
    v_subrev_u32 v3, 1024, v3
    v_add_u32 v56, 128, v1
    v_mul_u32_u24 v57, 5462, v56
    v_lshrrev_b32 v57, 16, v57
    v_mul_u32_u24 v58, 12, v57
    v_sub_u32 v58, v56, v58
    v_mul_u32_u24 v57, 3072, v57
    v_lshl_add_u32 v4, v58, 4, v57
    v_add_u32 v4, s60, v4
    v_subrev_u32 v4, 2048, v4
    s_mul_i32 s68, s43, 6144
    s_add_u32 s69, s76, 0
    s_sub_u32 s77, s69, 10
    s_cmp_ge_u32 s69, 10
    s_cselect_b32 s69, s77, s69
    s_mul_i32 s69, s69, 196608
    s_add_u32 m0, s68, 102400
    s_nop 0
    buffer_load_dwordx4 v2, s[64:67], s69 offen offset:0 lds
    buffer_load_dwordx4 v3, s[64:67], s69 offen offset:1024 lds
    buffer_load_dwordx4 v4, s[64:67], s69 offen offset:2048 lds
    s_add_u32 m0, s68, 105472
    s_add_u32 s69, s69, 49152
    buffer_load_dwordx4 v2, s[64:67], s69 offen offset:0 lds
    buffer_load_dwordx4 v3, s[64:67], s69 offen offset:1024 lds
    buffer_load_dwordx4 v4, s[64:67], s69 offen offset:2048 lds
    s_add_u32 s69, s76, 1
    s_sub_u32 s77, s69, 10
    s_cmp_ge_u32 s69, 10
    s_cselect_b32 s69, s77, s69
    s_mul_i32 s69, s69, 196608
    s_add_u32 m0, s68, 126976
    s_nop 0
    buffer_load_dwordx4 v2, s[64:67], s69 offen offset:0 lds
    buffer_load_dwordx4 v3, s[64:67], s69 offen offset:1024 lds
    buffer_load_dwordx4 v4, s[64:67], s69 offen offset:2048 lds
    s_add_u32 m0, s68, 130048
    s_add_u32 s69, s69, 49152
    buffer_load_dwordx4 v2, s[64:67], s69 offen offset:0 lds
    buffer_load_dwordx4 v3, s[64:67], s69 offen offset:1024 lds
    buffer_load_dwordx4 v4, s[64:67], s69 offen offset:2048 lds
    s_and_b32 s46, s41, 1
    s_lshl_b32 s46, s46, 3
    s_and_b32 s44, s42, 7
    s_add_u32 s44, s44, s46
    s_lshr_b32 s46, s41, 1
    s_lshl_b32 s46, s46, 2
    s_lshr_b32 s45, s42, 3
    s_add_u32 s45, s45, s46
    s_and_b32 s70, s41, 3
    s_lshl_b32 s70, s70, 3
    s_and_b32 s61, s42, 7
    s_add_u32 s61, s61, s70
    s_lshr_b32 s70, s41, 2
    s_lshl_b32 s70, s70, 2
    s_lshr_b32 s60, s42, 3
    s_add_u32 s60, s60, s70
    s_mul_i32 s37, s60, 3
    s_lshr_b32 s37, s37, 1
    s_mul_i32 s60, s60, 160
    s_mul_i32 s71, s43, 491520
    s_add_u32 s60, s60, s71
    v_add_u32 v40, 0, v1
    v_mul_u32_u24 v41, 6554, v40
    v_lshrrev_b32 v41, 16, v41
    v_mul_u32_u24 v42, 10, v41
    v_sub_u32 v42, v40, v42
    v_bfe_u32 v43, v41, 3, 1
    v_lshlrev_b32 v43, 2, v43
    v_xor_b32 v41, v41, v43
    v_mul_u32_u24 v41, 1280, v41
    v_lshl_add_u32 v54, v42, 4, v41
    v_add_u32 v54, s60, v54
    v_add_u32 v40, 64, v1
    v_mul_u32_u24 v41, 6554, v40
    v_lshrrev_b32 v41, 16, v41
    v_mul_u32_u24 v42, 10, v41
    v_sub_u32 v42, v40, v42
    v_bfe_u32 v43, v41, 3, 1
    v_lshlrev_b32 v43, 2, v43
    v_xor_b32 v41, v41, v43
    v_mul_u32_u24 v41, 1280, v41
    v_lshl_add_u32 v55, v42, 4, v41
    v_add_u32 v55, s60, v55
    v_subrev_u32 v55, 1024, v55
    v_add_u32 v40, 128, v1
    v_mul_u32_u24 v41, 6554, v40
    v_lshrrev_b32 v41, 16, v41
    v_mul_u32_u24 v42, 10, v41
    v_sub_u32 v42, v40, v42
    v_bfe_u32 v43, v41, 3, 1
    v_lshlrev_b32 v43, 2, v43
    v_xor_b32 v41, v41, v43
    v_mul_u32_u24 v41, 1280, v41
    v_lshl_add_u32 v56, v42, 4, v41
    v_add_u32 v56, s60, v56
    v_subrev_u32 v56, 2048, v56
    v_add_u32 v40, 192, v1
    v_mul_u32_u24 v41, 6554, v40
    v_lshrrev_b32 v41, 16, v41
    v_mul_u32_u24 v42, 10, v41
    v_sub_u32 v42, v40, v42
    v_bfe_u32 v43, v41, 3, 1
    v_lshlrev_b32 v43, 2, v43
    v_xor_b32 v41, v41, v43
    v_mul_u32_u24 v41, 1280, v41
    v_lshl_add_u32 v57, v42, 4, v41
    v_add_u32 v57, s60, v57
    v_subrev_u32 v57, 3072, v57
    v_add_u32 v40, 256, v1
    v_mul_u32_u24 v41, 6554, v40
    v_lshrrev_b32 v41, 16, v41
    v_mul_u32_u24 v42, 10, v41
    v_sub_u32 v42, v40, v42
    v_bfe_u32 v43, v41, 3, 1
    v_lshlrev_b32 v43, 2, v43
    v_xor_b32 v41, v41, v43
    v_mul_u32_u24 v41, 1280, v41
    v_lshl_add_u32 v58, v42, 4, v41
    v_add_u32 v58, s60, v58
    s_mul_i32 s70, s43, 5120
    v_cmp_le_u32 vcc, 96, v0
    v_mov_b32 v16, 11904
    s_nop 0
    v_cndmask_b32 v17, 0, v16, vcc
    v_lshl_add_u32 v17, v0, 2, v17
    v_add_u32 v17, 73728, v17
    v_mov_b32 v16, 5760
    v_cndmask_b32 v18, 0, v16, vcc
    v_lshl_add_u32 v18, v0, 2, v18
    v_cmp_gt_u32 vcc, 192, v0
    s_nop 1
    v_cndmask_b32 v19, 0, v18, vcc
    v_mov_b32 v16, 1073741824
    v_cndmask_b32 v18, v16, v18, vcc
    s_mul_i32 s51, s45, 384
    s_add_u32 s51, s51, 20185088
    s_mul_i32 s52, s44, 12288
    s_add_u32 s52, s52, s51
    s_mov_b32 s47, 1073741824
    s_cmp_lt_u32 s44, 10
    s_cselect_b32 s52, s52, s47
    v_lshlrev_b32 v46, 4, v1
    v_add_u32 v46, s68, v46
    v_add_u32 v47, 102400, v46
    s_waitcnt vmcnt(6)
    ds_read_b128 v[84:87], v47 offset:0
    ds_read_b128 v[88:91], v47 offset:1024
    ds_read_b128 v[92:95], v47 offset:2048
    ds_read_b128 v[96:99], v47 offset:3072
    ds_read_b128 v[100:103], v47 offset:4096
    ds_read_b128 v[104:107], v47 offset:5120
    s_waitcnt lgkmcnt(2)
    v_lshlrev_b32 v60, 16, v84
    v_and_b32 v61, 0xffff0000, v84
    v_lshlrev_b32 v28, 16, v96
    v_and_b32 v29, 0xffff0000, v96
    v_pk_add_f32 v[60:61], v[60:61], v[28:29]
    v_lshlrev_b32 v62, 16, v85
    v_and_b32 v63, 0xffff0000, v85
    v_lshlrev_b32 v30, 16, v97
    v_and_b32 v31, 0xffff0000, v97
    v_pk_add_f32 v[62:63], v[62:63], v[30:31]
    v_lshlrev_b32 v64, 16, v86
    v_and_b32 v65, 0xffff0000, v86
    v_lshlrev_b32 v28, 16, v98
    v_and_b32 v29, 0xffff0000, v98
    v_pk_add_f32 v[64:65], v[64:65], v[28:29]
    v_lshlrev_b32 v66, 16, v87
    v_and_b32 v67, 0xffff0000, v87
    v_lshlrev_b32 v30, 16, v99
    v_and_b32 v31, 0xffff0000, v99
    v_pk_add_f32 v[66:67], v[66:67], v[30:31]
    s_waitcnt lgkmcnt(1)
    v_lshlrev_b32 v68, 16, v88
    v_and_b32 v69, 0xffff0000, v88
    v_lshlrev_b32 v28, 16, v100
    v_and_b32 v29, 0xffff0000, v100
    v_pk_add_f32 v[68:69], v[68:69], v[28:29]
    v_lshlrev_b32 v70, 16, v89
    v_and_b32 v71, 0xffff0000, v89
    v_lshlrev_b32 v30, 16, v101
    v_and_b32 v31, 0xffff0000, v101
    v_pk_add_f32 v[70:71], v[70:71], v[30:31]
    v_lshlrev_b32 v72, 16, v90
    v_and_b32 v73, 0xffff0000, v90
    v_lshlrev_b32 v28, 16, v102
    v_and_b32 v29, 0xffff0000, v102
    v_pk_add_f32 v[72:73], v[72:73], v[28:29]
    v_lshlrev_b32 v74, 16, v91
    v_and_b32 v75, 0xffff0000, v91
    v_lshlrev_b32 v30, 16, v103
    v_and_b32 v31, 0xffff0000, v103
    v_pk_add_f32 v[74:75], v[74:75], v[30:31]
    s_waitcnt lgkmcnt(0)
    v_lshlrev_b32 v76, 16, v92
    v_and_b32 v77, 0xffff0000, v92
    v_lshlrev_b32 v28, 16, v104
    v_and_b32 v29, 0xffff0000, v104
    v_pk_add_f32 v[76:77], v[76:77], v[28:29]
    v_lshlrev_b32 v78, 16, v93
    v_and_b32 v79, 0xffff0000, v93
    v_lshlrev_b32 v30, 16, v105
    v_and_b32 v31, 0xffff0000, v105
    v_pk_add_f32 v[78:79], v[78:79], v[30:31]
    v_lshlrev_b32 v80, 16, v94
    v_and_b32 v81, 0xffff0000, v94
    v_lshlrev_b32 v28, 16, v106
    v_and_b32 v29, 0xffff0000, v106
    v_pk_add_f32 v[80:81], v[80:81], v[28:29]
    v_lshlrev_b32 v82, 16, v95
    v_and_b32 v83, 0xffff0000, v95
    v_lshlrev_b32 v30, 16, v107
    v_and_b32 v31, 0xffff0000, v107
    v_pk_add_f32 v[82:83], v[82:83], v[30:31]
    s_barrier
    s_barrier
    s_add_u32 s69, s76, 2
    s_sub_u32 s77, s69, 10
    s_cmp_ge_u32 s69, 10
    s_cselect_b32 s69, s77, s69
    s_mul_i32 s69, s69, 196608
    s_add_u32 m0, s68, 0
    s_nop 0
    buffer_load_dwordx4 v2, s[64:67], s69 offen offset:0 lds
    buffer_load_dwordx4 v3, s[64:67], s69 offen offset:1024 lds
    buffer_load_dwordx4 v4, s[64:67], s69 offen offset:2048 lds
    s_add_u32 m0, s68, 3072
    s_add_u32 s69, s69, 49152
    buffer_load_dwordx4 v2, s[64:67], s69 offen offset:0 lds
    buffer_load_dwordx4 v3, s[64:67], s69 offen offset:1024 lds
    buffer_load_dwordx4 v4, s[64:67], s69 offen offset:2048 lds
    s_add_u32 s69, s76, 3
    s_sub_u32 s77, s69, 10
    s_cmp_ge_u32 s69, 10
    s_cselect_b32 s69, s77, s69
    s_mul_i32 s69, s69, 196608
    s_add_u32 m0, s68, 24576
    s_nop 0
    buffer_load_dwordx4 v2, s[64:67], s69 offen offset:0 lds
    buffer_load_dwordx4 v3, s[64:67], s69 offen offset:1024 lds
    buffer_load_dwordx4 v4, s[64:67], s69 offen offset:2048 lds
    s_add_u32 m0, s68, 27648
    s_add_u32 s69, s69, 49152
    buffer_load_dwordx4 v2, s[64:67], s69 offen offset:0 lds
    buffer_load_dwordx4 v3, s[64:67], s69 offen offset:1024 lds
    buffer_load_dwordx4 v4, s[64:67], s69 offen offset:2048 lds
    s_add_u32 s69, s76, 4
    s_sub_u32 s77, s69, 10
    s_cmp_ge_u32 s69, 10
    s_cselect_b32 s69, s77, s69
    s_mul_i32 s69, s69, 196608
    s_add_u32 m0, s68, 49152
    s_nop 0
    buffer_load_dwordx4 v2, s[64:67], s69 offen offset:0 lds
    buffer_load_dwordx4 v3, s[64:67], s69 offen offset:1024 lds
    buffer_load_dwordx4 v4, s[64:67], s69 offen offset:2048 lds
    s_add_u32 m0, s68, 52224
    s_add_u32 s69, s69, 49152
    buffer_load_dwordx4 v2, s[64:67], s69 offen offset:0 lds
    buffer_load_dwordx4 v3, s[64:67], s69 offen offset:1024 lds
    buffer_load_dwordx4 v4, s[64:67], s69 offen offset:2048 lds
    v_lshlrev_b32 v16, 5, v1
    v_add_u32 v16, s68, v16
    v_add_u32 v16, 73728, v16
    ds_write_b128 v16, v[60:63] offset:0
    ds_write_b128 v16, v[64:67] offset:16
    ds_write_b128 v16, v[68:71] offset:2048
    ds_write_b128 v16, v[72:75] offset:2064
    ds_write_b128 v16, v[76:79] offset:4096
    ds_write_b128 v16, v[80:83] offset:4112
    s_waitcnt lgkmcnt(0)
    v_lshlrev_b32 v12, 4, v1
    s_mul_i32 s46, s43, 5120
    v_add_u32 v21, s46, v12
    v_add_u32 v22, 61440, v21
    v_add_u32 v23, 122880, v21
    s_waitcnt lgkmcnt(0)
    s_barrier
    ds_read_b32 v84, v17 offset:0
    ds_read_b32 v85, v17 offset:384
    ds_read_b32 v86, v17 offset:768
    ds_read_b32 v87, v17 offset:1152
    ds_read_b32 v88, v17 offset:1536
    ds_read_b32 v89, v17 offset:1920
    ds_read_b32 v90, v17 offset:2304
    ds_read_b32 v91, v17 offset:2688
    s_waitcnt lgkmcnt(0)
    ds_read_b32 v92, v17 offset:3072
    ds_read_b32 v93, v17 offset:3456
    ds_read_b32 v94, v17 offset:3840
    ds_read_b32 v95, v17 offset:4224
    ds_read_b32 v96, v17 offset:4608
    ds_read_b32 v97, v17 offset:4992
    ds_read_b32 v98, v17 offset:5376
    ds_read_b32 v99, v17 offset:5760
    s_waitcnt lgkmcnt(0)
    ds_read_b32 v100, v17 offset:6144
    ds_read_b32 v101, v17 offset:6528
    ds_read_b32 v102, v17 offset:6912
    ds_read_b32 v103, v17 offset:7296
    ds_read_b32 v104, v17 offset:7680
    ds_read_b32 v105, v17 offset:8064
    ds_read_b32 v106, v17 offset:8448
    ds_read_b32 v107, v17 offset:8832
    s_waitcnt lgkmcnt(0)
    ds_read_b32 v108, v17 offset:9216
    ds_read_b32 v109, v17 offset:9600
    ds_read_b32 v110, v17 offset:9984
    ds_read_b32 v111, v17 offset:10368
    ds_read_b32 v112, v17 offset:10752
    ds_read_b32 v113, v17 offset:11136
    ds_read_b32 v114, v17 offset:11520
    ds_read_b32 v115, v17 offset:11904
    s_waitcnt lgkmcnt(0)
    v_add_f32 v84, v84, v100
    v_add_f32 v85, v85, v101
    v_add_f32 v86, v86, v102
    v_add_f32 v87, v87, v103
    v_add_f32 v88, v88, v104
    v_add_f32 v89, v89, v105
    v_add_f32 v90, v90, v106
    v_add_f32 v91, v91, v107
    v_add_f32 v92, v92, v108
    v_add_f32 v93, v93, v109
    v_add_f32 v94, v94, v110
    v_add_f32 v95, v95, v111
    v_add_f32 v96, v96, v112
    v_add_f32 v97, v97, v113
    v_add_f32 v98, v98, v114
    v_add_f32 v99, v99, v115
    v_add_f32 v84, v84, v92
    v_add_f32 v85, v85, v93
    v_add_f32 v86, v86, v94
    v_add_f32 v87, v87, v95
    v_add_f32 v88, v88, v96
    v_add_f32 v89, v89, v97
    v_add_f32 v90, v90, v98
    v_add_f32 v91, v91, v99
    v_add_f32 v84, v84, v88
    v_add_f32 v85, v85, v89
    v_add_f32 v86, v86, v90
    v_add_f32 v87, v87, v91
    v_add_f32 v84, v84, v86
    v_add_f32 v85, v85, v87
    v_add_f32 v84, v84, v85
    buffer_store_dword v84, v18, s[32:35], s52 offen sc1
    s_waitcnt vmcnt(19)
    s_waitcnt lgkmcnt(0)
    s_barrier
    s_add_u32 s69, s76, 5
    s_sub_u32 s77, s69, 10
    s_cmp_ge_u32 s69, 10
    s_cselect_b32 s69, s77, s69
    s_mul_i32 s69, s69, 196608
    s_add_u32 m0, s68, 73728
    s_nop 0
    buffer_load_dwordx4 v2, s[64:67], s69 offen offset:0 lds
    buffer_load_dwordx4 v3, s[64:67], s69 offen offset:1024 lds
    buffer_load_dwordx4 v4, s[64:67], s69 offen offset:2048 lds
    s_add_u32 m0, s68, 76800
    s_add_u32 s69, s69, 49152
    buffer_load_dwordx4 v2, s[64:67], s69 offen offset:0 lds
    buffer_load_dwordx4 v3, s[64:67], s69 offen offset:1024 lds
    buffer_load_dwordx4 v4, s[64:67], s69 offen offset:2048 lds
    s_add_u32 s69, s76, 6
    s_sub_u32 s77, s69, 10
    s_cmp_ge_u32 s69, 10
    s_cselect_b32 s69, s77, s69
    s_mul_i32 s69, s69, 196608
    s_add_u32 m0, s68, 102400
    s_nop 0
    buffer_load_dwordx4 v2, s[64:67], s69 offen offset:0 lds
    buffer_load_dwordx4 v3, s[64:67], s69 offen offset:1024 lds
    buffer_load_dwordx4 v4, s[64:67], s69 offen offset:2048 lds
    s_add_u32 m0, s68, 105472
    s_add_u32 s69, s69, 49152
    buffer_load_dwordx4 v2, s[64:67], s69 offen offset:0 lds
    buffer_load_dwordx4 v3, s[64:67], s69 offen offset:1024 lds
    buffer_load_dwordx4 v4, s[64:67], s69 offen offset:2048 lds
    s_waitcnt vmcnt(25)
    s_waitcnt lgkmcnt(0)
    s_barrier
    s_add_u32 s69, s76, 7
    s_sub_u32 s77, s69, 10
    s_cmp_ge_u32 s69, 10
    s_cselect_b32 s69, s77, s69
    s_mul_i32 s69, s69, 196608
    s_add_u32 m0, s68, 126976
    s_nop 0
    buffer_load_dwordx4 v2, s[64:67], s69 offen offset:0 lds
    buffer_load_dwordx4 v3, s[64:67], s69 offen offset:1024 lds
    buffer_load_dwordx4 v4, s[64:67], s69 offen offset:2048 lds
    s_add_u32 m0, s68, 130048
    s_add_u32 s69, s69, 49152
    buffer_load_dwordx4 v2, s[64:67], s69 offen offset:0 lds
    buffer_load_dwordx4 v3, s[64:67], s69 offen offset:1024 lds
    buffer_load_dwordx4 v4, s[64:67], s69 offen offset:2048 lds
    s_waitcnt vmcnt(25)
    s_waitcnt lgkmcnt(0)
    s_barrier
    s_add_u32 s69, s76, 8
    s_sub_u32 s77, s69, 10
    s_cmp_ge_u32 s69, 10
    s_cselect_b32 s69, s77, s69
    s_mul_i32 s69, s69, 196608
    s_add_u32 m0, s68, 0
    s_nop 0
    buffer_load_dwordx4 v2, s[64:67], s69 offen offset:0 lds
    buffer_load_dwordx4 v3, s[64:67], s69 offen offset:1024 lds
    buffer_load_dwordx4 v4, s[64:67], s69 offen offset:2048 lds
    s_add_u32 m0, s68, 3072
    s_add_u32 s69, s69, 49152
    buffer_load_dwordx4 v2, s[64:67], s69 offen offset:0 lds
    buffer_load_dwordx4 v3, s[64:67], s69 offen offset:1024 lds
    buffer_load_dwordx4 v4, s[64:67], s69 offen offset:2048 lds
    s_waitcnt vmcnt(25)
    s_waitcnt lgkmcnt(0)
    s_barrier
    s_add_u32 s69, s76, 9
    s_sub_u32 s77, s69, 10
    s_cmp_ge_u32 s69, 10
    s_cselect_b32 s69, s77, s69
    s_mul_i32 s69, s69, 196608
    s_add_u32 m0, s68, 24576
    s_nop 0
    buffer_load_dwordx4 v2, s[64:67], s69 offen offset:0 lds
    buffer_load_dwordx4 v3, s[64:67], s69 offen offset:1024 lds
    buffer_load_dwordx4 v4, s[64:67], s69 offen offset:2048 lds
    s_add_u32 m0, s68, 27648
    s_add_u32 s69, s69, 49152
    buffer_load_dwordx4 v2, s[64:67], s69 offen offset:0 lds
    buffer_load_dwordx4 v3, s[64:67], s69 offen offset:1024 lds
    buffer_load_dwordx4 v4, s[64:67], s69 offen offset:2048 lds
    s_add_u32 s58, s51, 0
    buffer_load_dword v24, v19, s[32:35], s58 offen sc1
    s_add_u32 s58, s51, 12288
    buffer_load_dword v25, v19, s[32:35], s58 offen sc1
    s_add_u32 s58, s51, 24576
    buffer_load_dword v26, v19, s[32:35], s58 offen sc1
    s_add_u32 s58, s51, 36864
    buffer_load_dword v27, v19, s[32:35], s58 offen sc1
    s_add_u32 s58, s51, 49152
    buffer_load_dword v28, v19, s[32:35], s58 offen sc1
    s_add_u32 s58, s51, 61440
    buffer_load_dword v29, v19, s[32:35], s58 offen sc1
    s_add_u32 s58, s51, 73728
    buffer_load_dword v30, v19, s[32:35], s58 offen sc1
    s_add_u32 s58, s51, 86016
    buffer_load_dword v31, v19, s[32:35], s58 offen sc1
    s_add_u32 s58, s51, 98304
    buffer_load_dword v32, v19, s[32:35], s58 offen sc1
    s_add_u32 s58, s51, 110592
    buffer_load_dword v33, v19, s[32:35], s58 offen sc1
    v_subrev_u32 v36, 0, v0
    v_cmp_gt_u32 vcc, 240, v36
    v_mul_u32_u24 v37, 13108, v36
    v_lshrrev_b32 v37, 16, v37
    v_mul_u32_u24 v37, 640, v37
    v_lshl_add_u32 v36, v36, 7, v37
    v_mov_b32 v37, 1073741824
    v_cndmask_b32 v36, v37, v36, vcc
    s_mul_i32 s60, s42, 61440
    s_lshr_b32 s61, s41, 2
    s_mul_i32 s61, s61, 640
    s_add_u32 s60, s60, s61
    buffer_load_dword v37, v36, s[24:27], s60 offen
    s_waitcnt vmcnt(35)
    s_waitcnt lgkmcnt(0)
    s_barrier
    s_waitcnt vmcnt(1)
    v_max3_u32 v11, v24, v25, v26
    v_max3_u32 v11, v11, v27, v28
    v_max3_u32 v11, v11, v29, v30
    v_max3_u32 v11, v11, v31, v32
    v_max_u32 v11, v11, v33
    v_cmp_eq_u32 vcc, -1, v11
    s_cbranch_vccnz SLOW_220
BACK_221:
    v_add_f32 v24, v24, v25
    v_add_f32 v24, v24, v26
    v_add_f32 v24, v24, v27
    v_add_f32 v24, v24, v28
    v_add_f32 v24, v24, v29
    v_add_f32 v24, v24, v30
    v_add_f32 v24, v24, v31
    v_add_f32 v24, v24, v32
    v_add_f32 v24, v24, v33
    v_lshlrev_b32 v16, 2, v0
    v_add_u32 v16, 159744, v16
    ds_write_b32 v16, v24
    s_waitcnt lgkmcnt(0)
    s_barrier
    s_add_u32 m0, s70, 49152
    s_add_u32 s71, s37, 0
    s_sub_u32 s38, s71, 12
    s_cmp_ge_u32 s71, 12
    s_cselect_b32 s71, s38, s71
    s_mul_i32 s71, s71, 40960
    buffer_load_dwordx4 v54, s[24:27], s71 offen offset:0 lds
    buffer_load_dwordx4 v55, s[24:27], s71 offen offset:1024 lds
    buffer_load_dwordx4 v56, s[24:27], s71 offen offset:2048 lds
    buffer_load_dwordx4 v57, s[24:27], s71 offen offset:3072 lds
    s_add_u32 m0, s70, 53248
    s_nop 0
    buffer_load_dwordx4 v58, s[24:27], s71 offen lds
    s_add_u32 m0, s70, 69632
    s_add_u32 s71, s37, 1
    s_sub_u32 s38, s71, 12
    s_cmp_ge_u32 s71, 12
    s_cselect_b32 s71, s38, s71
    s_mul_i32 s71, s71, 40960
    buffer_load_dwordx4 v54, s[24:27], s71 offen offset:0 lds
    buffer_load_dwordx4 v55, s[24:27], s71 offen offset:1024 lds
    buffer_load_dwordx4 v56, s[24:27], s71 offen offset:2048 lds
    buffer_load_dwordx4 v57, s[24:27], s71 offen offset:3072 lds
    s_add_u32 m0, s70, 73728
    s_nop 0
    buffer_load_dwordx4 v58, s[24:27], s71 offen lds
    s_add_u32 s71, s37, 2
    s_sub_u32 s38, s71, 12
    s_cmp_ge_u32 s71, 12
    s_cselect_b32 s71, s38, s71
    s_mul_i32 s71, s71, 40960
    buffer_load_dwordx4 v[60:63], v54, s[24:27], s71 offen offset:0
    buffer_load_dwordx4 v[64:67], v55, s[24:27], s71 offen offset:1024
    buffer_load_dwordx4 v[68:71], v56, s[24:27], s71 offen offset:2048
    buffer_load_dwordx4 v[72:75], v57, s[24:27], s71 offen offset:3072
    buffer_load_dwordx4 v[76:79], v58, s[24:27], s71 offen
    s_add_u32 s71, s37, 3
    s_sub_u32 s38, s71, 12
    s_cmp_ge_u32 s71, 12
    s_cselect_b32 s71, s38, s71
    s_mul_i32 s71, s71, 40960
    buffer_load_dwordx4 v[80:83], v54, s[24:27], s71 offen offset:0
    buffer_load_dwordx4 v[84:87], v55, s[24:27], s71 offen offset:1024
    buffer_load_dwordx4 v[88:91], v56, s[24:27], s71 offen offset:2048
    buffer_load_dwordx4 v[92:95], v57, s[24:27], s71 offen offset:3072
    buffer_load_dwordx4 v[96:99], v58, s[24:27], s71 offen
    s_add_u32 s71, s37, 4
    s_sub_u32 s38, s71, 12
    s_cmp_ge_u32 s71, 12
    s_cselect_b32 s71, s38, s71
    s_mul_i32 s71, s71, 40960
    buffer_load_dwordx4 v[100:103], v54, s[24:27], s71 offen offset:0
    buffer_load_dwordx4 v[104:107], v55, s[24:27], s71 offen offset:1024
    buffer_load_dwordx4 v[108:111], v56, s[24:27], s71 offen offset:2048
    buffer_load_dwordx4 v[112:115], v57, s[24:27], s71 offen offset:3072
    buffer_load_dwordx4 v[116:119], v58, s[24:27], s71 offen
    s_add_u32 s71, s37, 5
    s_sub_u32 s38, s71, 12
    s_cmp_ge_u32 s71, 12
    s_cselect_b32 s71, s38, s71
    s_mul_i32 s71, s71, 40960
    buffer_load_dwordx4 v[120:123], v54, s[24:27], s71 offen offset:0
    buffer_load_dwordx4 v[124:127], v55, s[24:27], s71 offen offset:1024
    buffer_load_dwordx4 v[128:131], v56, s[24:27], s71 offen offset:2048
    buffer_load_dwordx4 v[132:135], v57, s[24:27], s71 offen offset:3072
    buffer_load_dwordx4 v[136:139], v58, s[24:27], s71 offen
    s_add_u32 s71, s37, 6
    s_sub_u32 s38, s71, 12
    s_cmp_ge_u32 s71, 12
    s_cselect_b32 s71, s38, s71
    s_mul_i32 s71, s71, 40960
    buffer_load_dwordx4 v[140:143], v54, s[24:27], s71 offen offset:0
    buffer_load_dwordx4 v[144:147], v55, s[24:27], s71 offen offset:1024
    buffer_load_dwordx4 v[148:151], v56, s[24:27], s71 offen offset:2048
    buffer_load_dwordx4 v[152:155], v57, s[24:27], s71 offen offset:3072
    buffer_load_dwordx4 v[156:159], v58, s[24:27], s71 offen
    s_add_u32 s71, s37, 7
    s_sub_u32 s38, s71, 12
    s_cmp_ge_u32 s71, 12
    s_cselect_b32 s71, s38, s71
    s_mul_i32 s71, s71, 40960
    buffer_load_dwordx4 v[160:163], v54, s[24:27], s71 offen offset:0
    buffer_load_dwordx4 v[164:167], v55, s[24:27], s71 offen offset:1024
    buffer_load_dwordx4 v[168:171], v56, s[24:27], s71 offen offset:2048
    buffer_load_dwordx4 v[172:175], v57, s[24:27], s71 offen offset:3072
    buffer_load_dwordx4 v[176:179], v58, s[24:27], s71 offen
    v_mov_b32 v39, 162828
    s_mov_b32 s61, 200000
CW_223:
    ds_read_b32 v38, v39
    s_waitcnt lgkmcnt(0)
    v_readfirstlane_b32 s60, v38
    s_nop 0
    s_cmp_ge_u32 s60, 4
    s_nop 1
    s_cbranch_scc1 CD_224
    s_sub_u32 s61, s61, 1
    s_cmp_eq_u32 s61, 0
    s_cbranch_scc1 CD_224
    s_sleep 2
    s_branch CW_223
CD_224:
    s_waitcnt vmcnt(25)
    ds_write_b128 v22, v[60:63] offset:28672
    ds_write_b128 v22, v[64:67] offset:29696
    ds_write_b128 v22, v[68:71] offset:30720
    ds_write_b128 v22, v[72:75] offset:31744
    ds_write_b128 v22, v[76:79] offset:32768
    s_waitcnt vmcnt(20)
    ds_write_b128 v22, v[80:83] offset:49152
    ds_write_b128 v22, v[84:87] offset:50176
    ds_write_b128 v22, v[88:91] offset:51200
    ds_write_b128 v22, v[92:95] offset:52224
    ds_write_b128 v22, v[96:99] offset:53248
    s_waitcnt vmcnt(15)
    ds_write_b128 v23, v[100:103] offset:8192
    ds_write_b128 v23, v[104:107] offset:9216
    ds_write_b128 v23, v[108:111] offset:10240
    ds_write_b128 v23, v[112:115] offset:11264
    ds_write_b128 v23, v[116:119] offset:12288
    s_waitcnt vmcnt(10)
    ds_write_b128 v21, v[120:123] offset:0
    ds_write_b128 v21, v[124:127] offset:1024
    ds_write_b128 v21, v[128:131] offset:2048
    ds_write_b128 v21, v[132:135] offset:3072
    ds_write_b128 v21, v[136:139] offset:4096
    s_waitcnt vmcnt(5)
    ds_write_b128 v21, v[140:143] offset:20480
    ds_write_b128 v21, v[144:147] offset:21504
    ds_write_b128 v21, v[148:151] offset:22528
    ds_write_b128 v21, v[152:155] offset:23552
    ds_write_b128 v21, v[156:159] offset:24576
    s_add_u32 s71, s37, 8
    s_sub_u32 s38, s71, 12
    s_cmp_ge_u32 s71, 12
    s_cselect_b32 s71, s38, s71
    s_mul_i32 s71, s71, 40960
    buffer_load_dwordx4 v[180:183], v54, s[24:27], s71 offen offset:0
    buffer_load_dwordx4 v[184:187], v55, s[24:27], s71 offen offset:1024
    buffer_load_dwordx4 v[188:191], v56, s[24:27], s71 offen offset:2048
    buffer_load_dwordx4 v[192:195], v57, s[24:27], s71 offen offset:3072
    buffer_load_dwordx4 v[196:199], v58, s[24:27], s71 offen
    s_add_u32 s71, s37, 9
    s_sub_u32 s38, s71, 12
    s_cmp_ge_u32 s71, 12
    s_cselect_b32 s71, s38, s71
    s_mul_i32 s71, s71, 40960
    buffer_load_dwordx4 v[200:203], v54, s[24:27], s71 offen offset:0
    buffer_load_dwordx4 v[204:207], v55, s[24:27], s71 offen offset:1024
    buffer_load_dwordx4 v[208:211], v56, s[24:27], s71 offen offset:2048
    buffer_load_dwordx4 v[212:215], v57, s[24:27], s71 offen offset:3072
    buffer_load_dwordx4 v[216:219], v58, s[24:27], s71 offen
    s_add_u32 s71, s37, 10
    s_sub_u32 s38, s71, 12
    s_cmp_ge_u32 s71, 12
    s_cselect_b32 s71, s38, s71
    s_mul_i32 s71, s71, 40960
    buffer_load_dwordx4 v[220:223], v54, s[24:27], s71 offen offset:0
    buffer_load_dwordx4 v[224:227], v55, s[24:27], s71 offen offset:1024
    buffer_load_dwordx4 v[228:231], v56, s[24:27], s71 offen offset:2048
    buffer_load_dwordx4 v[232:235], v57, s[24:27], s71 offen offset:3072
    buffer_load_dwordx4 v[236:239], v58, s[24:27], s71 offen
    v_lshlrev_b32 v12, 4, v1
    s_mul_i32 s46, s43, 5120
    v_add_u32 v21, s46, v12
    v_add_u32 v22, 61440, v21
    v_add_u32 v23, 122880, v21
    s_waitcnt lgkmcnt(0)
    s_barrier
    s_barrier
    s_waitcnt vmcnt(15)
    ds_write_b128 v21, v[160:163] offset:49152
    ds_write_b128 v21, v[164:167] offset:50176
    ds_write_b128 v21, v[168:171] offset:51200
    ds_write_b128 v21, v[172:175] offset:52224
    ds_write_b128 v21, v[176:179] offset:53248
    s_waitcnt vmcnt(10)
    ds_write_b128 v22, v[180:183] offset:8192
    ds_write_b128 v22, v[184:187] offset:9216
    ds_write_b128 v22, v[188:191] offset:10240
    ds_write_b128 v22, v[192:195] offset:11264
    ds_write_b128 v22, v[196:199] offset:12288
    s_waitcnt vmcnt(5)
    ds_write_b128 v22, v[200:203] offset:28672
    ds_write_b128 v22, v[204:207] offset:29696
    ds_write_b128 v22, v[208:211] offset:30720
    ds_write_b128 v22, v[212:215] offset:31744
    ds_write_b128 v22, v[216:219] offset:32768
    s_barrier
    s_add_u32 m0, s70, 131072
    s_add_u32 s71, s37, 11
    s_sub_u32 s38, s71, 12
    s_cmp_ge_u32 s71, 12
    s_cselect_b32 s71, s38, s71
    s_mul_i32 s71, s71, 40960
    buffer_load_dwordx4 v54, s[24:27], s71 offen offset:0 lds
    buffer_load_dwordx4 v55, s[24:27], s71 offen offset:1024 lds
    buffer_load_dwordx4 v56, s[24:27], s71 offen offset:2048 lds
    buffer_load_dwordx4 v57, s[24:27], s71 offen offset:3072 lds
    s_add_u32 m0, s70, 135168
    s_nop 0
    buffer_load_dwordx4 v58, s[24:27], s71 offen lds
    s_waitcnt vmcnt(5)
    ds_write_b128 v22, v[220:223] offset:49152
    ds_write_b128 v22, v[224:227] offset:50176
    ds_write_b128 v22, v[228:231] offset:51200
    ds_write_b128 v22, v[232:235] offset:52224
    ds_write_b128 v22, v[236:239] offset:53248
    s_waitcnt lgkmcnt(10)
    s_barrier
    s_waitcnt lgkmcnt(0)
    s_barrier
    s_waitcnt vmcnt(0)
    s_barrier
    s_barrier
FIN_4:
K_END:
    s_endpgm
OUT_5:
    v_mov_b32 v253, 0
    buffer_load_dword v252, v253, s[36:39], 0 offen sc1
    s_nop 1
    s_branch OBK_6
OUT_10:
    v_dot2_f32_bf16 v34, v40, v37, v34
    v_dot2_f32_bf16 v35, v40, v40, v35
    v_dot2_f32_bf16 v36, v48, v37, v36
    v_dot2_f32_bf16 v34, v41, v37, v34
    v_dot2_f32_bf16 v35, v41, v41, v35
    v_dot2_f32_bf16 v36, v49, v37, v36
    v_dot2_f32_bf16 v34, v42, v37, v34
    v_dot2_f32_bf16 v35, v42, v42, v35
    v_dot2_f32_bf16 v36, v50, v37, v36
    v_dot2_f32_bf16 v34, v43, v37, v34
    v_dot2_f32_bf16 v35, v43, v43, v35
    v_dot2_f32_bf16 v36, v51, v37, v36
    s_nop 1
    s_branch OBK_11
OUT_12:
    v_dot2_f32_bf16 v34, v44, v37, v34
    v_dot2_f32_bf16 v35, v44, v44, v35
    v_dot2_f32_bf16 v36, v64, v37, v36
    v_dot2_f32_bf16 v34, v45, v37, v34
    v_dot2_f32_bf16 v35, v45, v45, v35
    v_dot2_f32_bf16 v36, v65, v37, v36
    v_dot2_f32_bf16 v34, v46, v37, v34
    v_dot2_f32_bf16 v35, v46, v46, v35
    v_dot2_f32_bf16 v36, v66, v37, v36
    v_dot2_f32_bf16 v34, v47, v37, v34
    v_dot2_f32_bf16 v35, v47, v47, v35
    v_dot2_f32_bf16 v36, v67, v37, v36
    s_nop 1
    s_branch OBK_13
OUT_14:
    v_dot2_f32_bf16 v34, v40, v37, v34
    v_dot2_f32_bf16 v35, v40, v40, v35
    v_dot2_f32_bf16 v36, v48, v37, v36
    v_dot2_f32_bf16 v34, v41, v37, v34
    v_dot2_f32_bf16 v35, v41, v41, v35
    v_dot2_f32_bf16 v36, v49, v37, v36
    v_dot2_f32_bf16 v34, v42, v37, v34
    v_dot2_f32_bf16 v35, v42, v42, v35
    v_dot2_f32_bf16 v36, v50, v37, v36
    v_dot2_f32_bf16 v34, v43, v37, v34
    v_dot2_f32_bf16 v35, v43, v43, v35
    v_dot2_f32_bf16 v36, v51, v37, v36
    s_nop 1
    s_branch OBK_15
OUT_16:
    v_dot2_f32_bf16 v34, v44, v37, v34
    v_dot2_f32_bf16 v35, v44, v44, v35
    v_dot2_f32_bf16 v36, v64, v37, v36
    v_dot2_f32_bf16 v34, v45, v37, v34
    v_dot2_f32_bf16 v35, v45, v45, v35
    v_dot2_f32_bf16 v36, v65, v37, v36
    v_dot2_f32_bf16 v34, v46, v37, v34
    v_dot2_f32_bf16 v35, v46, v46, v35
    v_dot2_f32_bf16 v36, v66, v37, v36
    v_dot2_f32_bf16 v34, v47, v37, v34
    v_dot2_f32_bf16 v35, v47, v47, v35
    v_dot2_f32_bf16 v36, v67, v37, v36
    s_nop 0
    v_mov_b32 v80, v34
    v_mov_b32 v81, v34
    s_nop 1
    v_permlane32_swap_b32 v80, v81
    v_add_f32 v34, v80, v81
    v_mov_b32 v80, v35
    v_mov_b32 v81, v35
    s_nop 1
    v_permlane32_swap_b32 v80, v81
    v_add_f32 v35, v80, v81
    v_mov_b32 v80, v36
    v_mov_b32 v81, v36
    s_nop 1
    v_permlane32_swap_b32 v80, v81
    v_add_f32 v36, v80, v81
    buffer_store_dwordx2 v[34:35], v109, s[32:35], s51 offen sc1
    buffer_store_dword v36, v102, s[32:35], s52 offen sc1
    s_nop 1
    s_branch OBK_17
OUT_18:
    v_dot2_f32_bf16 v34, v40, v37, v34
    v_dot2_f32_bf16 v35, v40, v40, v35
    v_dot2_f32_bf16 v36, v48, v37, v36
    v_dot2_f32_bf16 v34, v41, v37, v34
    v_dot2_f32_bf16 v35, v41, v41, v35
    v_dot2_f32_bf16 v36, v49, v37, v36
    v_dot2_f32_bf16 v34, v42, v37, v34
    v_dot2_f32_bf16 v35, v42, v42, v35
    v_dot2_f32_bf16 v36, v50, v37, v36
    v_dot2_f32_bf16 v34, v43, v37, v34
    v_dot2_f32_bf16 v35, v43, v43, v35
    v_dot2_f32_bf16 v36, v51, v37, v36
    s_nop 1
    s_branch OBK_19
OUT_20:
    v_dot2_f32_bf16 v34, v44, v37, v34
    v_dot2_f32_bf16 v35, v44, v44, v35
    v_dot2_f32_bf16 v36, v64, v37, v36
    v_dot2_f32_bf16 v34, v45, v37, v34
    v_dot2_f32_bf16 v35, v45, v45, v35
    v_dot2_f32_bf16 v36, v65, v37, v36
    v_dot2_f32_bf16 v34, v46, v37, v34
    v_dot2_f32_bf16 v35, v46, v46, v35
    v_dot2_f32_bf16 v36, v66, v37, v36
    v_dot2_f32_bf16 v34, v47, v37, v34
    v_dot2_f32_bf16 v35, v47, v47, v35
    v_dot2_f32_bf16 v36, v67, v37, v36
    s_nop 1
    s_branch OBK_21
OUT_22:
    v_dot2_f32_bf16 v34, v40, v37, v34
    v_dot2_f32_bf16 v35, v40, v40, v35
    v_dot2_f32_bf16 v36, v48, v37, v36
    v_dot2_f32_bf16 v34, v41, v37, v34
    v_dot2_f32_bf16 v35, v41, v41, v35
    v_dot2_f32_bf16 v36, v49, v37, v36
    v_dot2_f32_bf16 v34, v42, v37, v34
    v_dot2_f32_bf16 v35, v42, v42, v35
    v_dot2_f32_bf16 v36, v50, v37, v36
    v_dot2_f32_bf16 v34, v43, v37, v34
    v_dot2_f32_bf16 v35, v43, v43, v35
    v_dot2_f32_bf16 v36, v51, v37, v36
    s_nop 1
    s_branch OBK_23
OUT_24:
    s_branch NF_28
NL_26:
    buffer_load_dword v252, v253, s[36:39], 0 offen sc1
NF_28:
    s_waitcnt vmcnt(0)
    v_readfirstlane_b32 s3, v252
    s_nop 0
    s_cmp_lg_u32 s3, 0
    s_nop 1
    s_cbranch_scc1 ND_27
    s_cmp_eq_u32 s57, 0
    s_cbranch_scc1 ND_27
    s_sub_u32 s57, s57, 1
    s_sleep 4
    s_branch NL_26
ND_27:
    v_mov_b32 v253, 162816
    ds_write_b32 v253, v252
    s_waitcnt lgkmcnt(0)
    s_nop 1
    s_branch OBK_25
OUT_29:
    v_dot2_f32_bf16 v34, v44, v37, v34
    v_dot2_f32_bf16 v35, v44, v44, v35
    v_dot2_f32_bf16 v36, v64, v37, v36
    v_dot2_f32_bf16 v34, v45, v37, v34
    v_dot2_f32_bf16 v35, v45, v45, v35
    v_dot2_f32_bf16 v36, v65, v37, v36
    v_dot2_f32_bf16 v34, v46, v37, v34
    v_dot2_f32_bf16 v35, v46, v46, v35
    v_dot2_f32_bf16 v36, v66, v37, v36
    v_dot2_f32_bf16 v34, v47, v37, v34
    v_dot2_f32_bf16 v35, v47, v47, v35
    v_dot2_f32_bf16 v36, v67, v37, v36
    s_nop 0
    v_mov_b32 v80, v34
    v_mov_b32 v81, v34
    s_nop 1
    v_permlane32_swap_b32 v80, v81
    v_add_f32 v34, v80, v81
    v_mov_b32 v80, v35
    v_mov_b32 v81, v35
    s_nop 1
    v_permlane32_swap_b32 v80, v81
    v_add_f32 v35, v80, v81
    v_mov_b32 v80, v36
    v_mov_b32 v81, v36
    s_nop 1
    v_permlane32_swap_b32 v80, v81
    v_add_f32 v36, v80, v81
    buffer_store_dwordx2 v[34:35], v109, s[32:35], s51 offen sc1
    buffer_store_dword v36, v102, s[32:35], s52 offen sc1
    s_nop 1
    s_branch OBK_30
OUT_31:
    v_dot2_f32_bf16 v34, v40, v37, v34
    v_dot2_f32_bf16 v35, v40, v40, v35
    v_dot2_f32_bf16 v36, v48, v37, v36
    v_dot2_f32_bf16 v34, v41, v37, v34
    v_dot2_f32_bf16 v35, v41, v41, v35
    v_dot2_f32_bf16 v36, v49, v37, v36
    v_dot2_f32_bf16 v34, v42, v37, v34
    v_dot2_f32_bf16 v35, v42, v42, v35
    v_dot2_f32_bf16 v36, v50, v37, v36
    v_dot2_f32_bf16 v34, v43, v37, v34
    v_dot2_f32_bf16 v35, v43, v43, v35
    v_dot2_f32_bf16 v36, v51, v37, v36
    s_nop 1
    s_branch OBK_32
OUT_33:
    v_dot2_f32_bf16 v34, v44, v37, v34
    v_dot2_f32_bf16 v35, v44, v44, v35
    v_dot2_f32_bf16 v36, v64, v37, v36
    v_dot2_f32_bf16 v34, v45, v37, v34
    v_dot2_f32_bf16 v35, v45, v45, v35
    v_dot2_f32_bf16 v36, v65, v37, v36
    v_dot2_f32_bf16 v34, v46, v37, v34
    v_dot2_f32_bf16 v35, v46, v46, v35
    v_dot2_f32_bf16 v36, v66, v37, v36
    v_dot2_f32_bf16 v34, v47, v37, v34
    v_dot2_f32_bf16 v35, v47, v47, v35
    v_dot2_f32_bf16 v36, v67, v37, v36
    s_nop 1
    s_branch OBK_34
OUT_35:
    v_dot2_f32_bf16 v34, v40, v37, v34
    v_dot2_f32_bf16 v35, v40, v40, v35
    v_dot2_f32_bf16 v36, v48, v37, v36
    v_dot2_f32_bf16 v34, v41, v37, v34
    v_dot2_f32_bf16 v35, v41, v41, v35
    v_dot2_f32_bf16 v36, v49, v37, v36
    v_dot2_f32_bf16 v34, v42, v37, v34
    v_dot2_f32_bf16 v35, v42, v42, v35
    v_dot2_f32_bf16 v36, v50, v37, v36
    v_dot2_f32_bf16 v34, v43, v37, v34
    v_dot2_f32_bf16 v35, v43, v43, v35
    v_dot2_f32_bf16 v36, v51, v37, v36
    s_nop 1
    s_branch OBK_36
OUT_37:
    v_dot2_f32_bf16 v34, v44, v37, v34
    v_dot2_f32_bf16 v35, v44, v44, v35
    v_dot2_f32_bf16 v36, v64, v37, v36
    v_dot2_f32_bf16 v34, v45, v37, v34
    v_dot2_f32_bf16 v35, v45, v45, v35
    v_dot2_f32_bf16 v36, v65, v37, v36
    v_dot2_f32_bf16 v34, v46, v37, v34
    v_dot2_f32_bf16 v35, v46, v46, v35
    v_dot2_f32_bf16 v36, v66, v37, v36
    v_dot2_f32_bf16 v34, v47, v37, v34
    v_dot2_f32_bf16 v35, v47, v47, v35
    v_dot2_f32_bf16 v36, v67, v37, v36
    s_nop 0
    v_mov_b32 v80, v34
    v_mov_b32 v81, v34
    s_nop 1
    v_permlane32_swap_b32 v80, v81
    v_add_f32 v34, v80, v81
    v_mov_b32 v80, v35
    v_mov_b32 v81, v35
    s_nop 1
    v_permlane32_swap_b32 v80, v81
    v_add_f32 v35, v80, v81
    v_mov_b32 v80, v36
    v_mov_b32 v81, v36
    s_nop 1
    v_permlane32_swap_b32 v80, v81
    v_add_f32 v36, v80, v81
    buffer_store_dwordx2 v[34:35], v109, s[32:35], s51 offen sc1
    buffer_store_dword v36, v102, s[32:35], s52 offen sc1
    s_nop 1
    s_branch OBK_38
OUT_39:
    v_dot2_f32_bf16 v34, v40, v37, v34
    v_dot2_f32_bf16 v35, v40, v40, v35
    v_dot2_f32_bf16 v36, v48, v37, v36
    v_dot2_f32_bf16 v34, v41, v37, v34
    v_dot2_f32_bf16 v35, v41, v41, v35
    v_dot2_f32_bf16 v36, v49, v37, v36
    v_dot2_f32_bf16 v34, v42, v37, v34
    v_dot2_f32_bf16 v35, v42, v42, v35
    v_dot2_f32_bf16 v36, v50, v37, v36
    v_dot2_f32_bf16 v34, v43, v37, v34
    v_dot2_f32_bf16 v35, v43, v43, v35
    v_dot2_f32_bf16 v36, v51, v37, v36
    s_nop 1
    s_branch OBK_40
OUT_41:
    v_dot2_f32_bf16 v34, v44, v37, v34
    v_dot2_f32_bf16 v35, v44, v44, v35
    v_dot2_f32_bf16 v36, v64, v37, v36
    v_dot2_f32_bf16 v34, v45, v37, v34
    v_dot2_f32_bf16 v35, v45, v45, v35
    v_dot2_f32_bf16 v36, v65, v37, v36
    v_dot2_f32_bf16 v34, v46, v37, v34
    v_dot2_f32_bf16 v35, v46, v46, v35
    v_dot2_f32_bf16 v36, v66, v37, v36
    v_dot2_f32_bf16 v34, v47, v37, v34
    v_dot2_f32_bf16 v35, v47, v47, v35
    v_dot2_f32_bf16 v36, v67, v37, v36
    s_nop 1
    s_branch OBK_42
OUT_43:
    v_dot2_f32_bf16 v34, v40, v37, v34
    v_dot2_f32_bf16 v35, v40, v40, v35
    v_dot2_f32_bf16 v36, v48, v37, v36
    v_dot2_f32_bf16 v34, v41, v37, v34
    v_dot2_f32_bf16 v35, v41, v41, v35
    v_dot2_f32_bf16 v36, v49, v37, v36
    v_dot2_f32_bf16 v34, v42, v37, v34
    v_dot2_f32_bf16 v35, v42, v42, v35
    v_dot2_f32_bf16 v36, v50, v37, v36
    v_dot2_f32_bf16 v34, v43, v37, v34
    v_dot2_f32_bf16 v35, v43, v43, v35
    v_dot2_f32_bf16 v36, v51, v37, v36
    s_nop 1
    s_branch OBK_44
OUT_45:
    v_dot2_f32_bf16 v34, v44, v37, v34
    v_dot2_f32_bf16 v35, v44, v44, v35
    v_dot2_f32_bf16 v36, v64, v37, v36
    v_dot2_f32_bf16 v34, v45, v37, v34
    v_dot2_f32_bf16 v35, v45, v45, v35
    v_dot2_f32_bf16 v36, v65, v37, v36
    v_dot2_f32_bf16 v34, v46, v37, v34
    v_dot2_f32_bf16 v35, v46, v46, v35
    v_dot2_f32_bf16 v36, v66, v37, v36
    v_dot2_f32_bf16 v34, v47, v37, v34
    v_dot2_f32_bf16 v35, v47, v47, v35
    v_dot2_f32_bf16 v36, v67, v37, v36
    s_nop 0
    v_mov_b32 v80, v34
    v_mov_b32 v81, v34
    s_nop 1
    v_permlane32_swap_b32 v80, v81
    v_add_f32 v34, v80, v81
    v_mov_b32 v80, v35
    v_mov_b32 v81, v35
    s_nop 1
    v_permlane32_swap_b32 v80, v81
    v_add_f32 v35, v80, v81
    v_mov_b32 v80, v36
    v_mov_b32 v81, v36
    s_nop 1
    v_permlane32_swap_b32 v80, v81
    v_add_f32 v36, v80, v81
    buffer_store_dwordx2 v[34:35], v109, s[32:35], s51 offen sc1
    buffer_store_dword v36, v102, s[32:35], s52 offen sc1
    s_nop 1
    s_branch OBK_46
OUT_47:
    v_dot2_f32_bf16 v34, v40, v37, v34
    v_dot2_f32_bf16 v35, v40, v40, v35
    v_dot2_f32_bf16 v36, v48, v37, v36
    v_dot2_f32_bf16 v34, v41, v37, v34
    v_dot2_f32_bf16 v35, v41, v41, v35
    v_dot2_f32_bf16 v36, v49, v37, v36
    v_dot2_f32_bf16 v34, v42, v37, v34
    v_dot2_f32_bf16 v35, v42, v42, v35
    v_dot2_f32_bf16 v36, v50, v37, v36
    v_dot2_f32_bf16 v34, v43, v37, v34
    v_dot2_f32_bf16 v35, v43, v43, v35
    v_dot2_f32_bf16 v36, v51, v37, v36
    s_nop 1
    s_branch OBK_48
OUT_49:
    v_dot2_f32_bf16 v34, v44, v37, v34
    v_dot2_f32_bf16 v35, v44, v44, v35
    v_dot2_f32_bf16 v36, v64, v37, v36
    v_dot2_f32_bf16 v34, v45, v37, v34
    v_dot2_f32_bf16 v35, v45, v45, v35
    v_dot2_f32_bf16 v36, v65, v37, v36
    v_dot2_f32_bf16 v34, v46, v37, v34
    v_dot2_f32_bf16 v35, v46, v46, v35
    v_dot2_f32_bf16 v36, v66, v37, v36
    v_dot2_f32_bf16 v34, v47, v37, v34
    v_dot2_f32_bf16 v35, v47, v47, v35
    v_dot2_f32_bf16 v36, v67, v37, v36
    s_nop 1
    s_branch OBK_50
OUT_51:
    v_dot2_f32_bf16 v34, v40, v37, v34
    v_dot2_f32_bf16 v35, v40, v40, v35
    v_dot2_f32_bf16 v36, v48, v37, v36
    v_dot2_f32_bf16 v34, v41, v37, v34
    v_dot2_f32_bf16 v35, v41, v41, v35
    v_dot2_f32_bf16 v36, v49, v37, v36
    v_dot2_f32_bf16 v34, v42, v37, v34
    v_dot2_f32_bf16 v35, v42, v42, v35
    v_dot2_f32_bf16 v36, v50, v37, v36
    v_dot2_f32_bf16 v34, v43, v37, v34
    v_dot2_f32_bf16 v35, v43, v43, v35
    v_dot2_f32_bf16 v36, v51, v37, v36
    s_nop 1
    s_branch OBK_52
OUT_53:
    v_dot2_f32_bf16 v34, v44, v37, v34
    v_dot2_f32_bf16 v35, v44, v44, v35
    v_dot2_f32_bf16 v36, v64, v37, v36
    v_dot2_f32_bf16 v34, v45, v37, v34
    v_dot2_f32_bf16 v35, v45, v45, v35
    v_dot2_f32_bf16 v36, v65, v37, v36
    v_dot2_f32_bf16 v34, v46, v37, v34
    v_dot2_f32_bf16 v35, v46, v46, v35
    v_dot2_f32_bf16 v36, v66, v37, v36
    v_dot2_f32_bf16 v34, v47, v37, v34
    v_dot2_f32_bf16 v35, v47, v47, v35
    v_dot2_f32_bf16 v36, v67, v37, v36
    s_nop 0
    v_mov_b32 v80, v34
    v_mov_b32 v81, v34
    s_nop 1
    v_permlane32_swap_b32 v80, v81
    v_add_f32 v34, v80, v81
    v_mov_b32 v80, v35
    v_mov_b32 v81, v35
    s_nop 1
    v_permlane32_swap_b32 v80, v81
    v_add_f32 v35, v80, v81
    v_mov_b32 v80, v36
    v_mov_b32 v81, v36
    s_nop 1
    v_permlane32_swap_b32 v80, v81
    v_add_f32 v36, v80, v81
    buffer_store_dwordx2 v[34:35], v109, s[32:35], s51 offen sc1
    buffer_store_dword v36, v102, s[32:35], s52 offen sc1
    s_nop 1
    s_branch OBK_54
FSLOW_55:
    s_nop 15
    s_cmp_eq_u32 s57, 0
    s_cbranch_scc1 FBACK_56
    s_sub_u32 s57, s57, 1
    s_sleep 12
    s_mov_b32 s58, 19447808
    buffer_load_dwordx4 v[248:251], v106, s[32:35], s58 offen sc1
    s_waitcnt vmcnt(0)
    v_xor_b32 v248, s3, v248
    v_xor_b32 v249, s3, v249
    v_xor_b32 v250, s3, v250
    v_xor_b32 v251, s3, v251
    v_or3_b32 v248, v248, v249, v250
    v_or_b32 v248, v248, v251
    v_cmp_ne_u32 vcc, 0, v248
    s_nop 3
    s_cbranch_vccnz FSLOW_55
    s_branch FBACK_56
SLOW_57:
    s_nop 15
RETRY_59:
    s_cmp_eq_u32 s57, 0
    s_cbranch_scc1 BACK_58
    s_sub_u32 s57, s57, 1
    s_sleep 2
    s_add_u32 s58, s53, 0
    buffer_load_dwordx2 v[232:233], v103, s[32:35], s58 offen sc1
    s_add_u32 s58, s53, 16384
    buffer_load_dwordx2 v[234:235], v103, s[32:35], s58 offen sc1
    s_add_u32 s58, s53, 32768
    buffer_load_dwordx2 v[236:237], v103, s[32:35], s58 offen sc1
    s_add_u32 s58, s53, 49152
    buffer_load_dwordx2 v[238:239], v103, s[32:35], s58 offen sc1
    s_add_u32 s58, s53, 65536
    buffer_load_dwordx2 v[240:241], v103, s[32:35], s58 offen sc1
    s_add_u32 s58, s54, 0
    buffer_load_dword v242, v104, s[32:35], s58 offen sc1
    s_add_u32 s58, s54, 7680
    buffer_load_dword v243, v104, s[32:35], s58 offen sc1
    s_add_u32 s58, s54, 15360
    buffer_load_dword v244, v104, s[32:35], s58 offen sc1
    s_add_u32 s58, s54, 23040
    buffer_load_dword v245, v104, s[32:35], s58 offen sc1
    s_add_u32 s58, s54, 30720
    buffer_load_dword v246, v104, s[32:35], s58 offen sc1
    s_waitcnt vmcnt(0)
    v_max3_u32 v80, v232, v233, v234
    v_max3_u32 v80, v80, v235, v236
    v_max3_u32 v80, v80, v237, v238
    v_max3_u32 v80, v80, v239, v240
    v_max3_u32 v80, v80, v241, v242
    v_max3_u32 v80, v80, v243, v244
    v_max3_u32 v80, v80, v245, v246
    v_cmp_eq_u32 vcc, -1, v80
    s_nop 3
    s_cbranch_vccnz RETRY_59
    s_branch BACK_58
OUT_60:
    v_dot2_f32_bf16 v34, v40, v37, v34
    v_dot2_f32_bf16 v35, v40, v40, v35
    v_dot2_f32_bf16 v36, v48, v37, v36
    v_dot2_f32_bf16 v34, v41, v37, v34
    v_dot2_f32_bf16 v35, v41, v41, v35
    v_dot2_f32_bf16 v36, v49, v37, v36
    v_dot2_f32_bf16 v34, v42, v37, v34
    v_dot2_f32_bf16 v35, v42, v42, v35
    v_dot2_f32_bf16 v36, v50, v37, v36
    v_dot2_f32_bf16 v34, v43, v37, v34
    v_dot2_f32_bf16 v35, v43, v43, v35
    v_dot2_f32_bf16 v36, v51, v37, v36
    s_nop 1
    s_branch OBK_61
OUT_62:
    v_dot2_f32_bf16 v34, v44, v37, v34
    v_dot2_f32_bf16 v35, v44, v44, v35
    v_dot2_f32_bf16 v36, v64, v37, v36
    v_dot2_f32_bf16 v34, v45, v37, v34
    v_dot2_f32_bf16 v35, v45, v45, v35
    v_dot2_f32_bf16 v36, v65, v37, v36
    v_dot2_f32_bf16 v34, v46, v37, v34
    v_dot2_f32_bf16 v35, v46, v46, v35
    v_dot2_f32_bf16 v36, v66, v37, v36
    v_dot2_f32_bf16 v34, v47, v37, v34
    v_dot2_f32_bf16 v35, v47, v47, v35
    v_dot2_f32_bf16 v36, v67, v37, v36
    s_nop 1
    s_branch OBK_63
OUT_64:
    v_dot2_f32_bf16 v34, v40, v37, v34
    v_dot2_f32_bf16 v35, v40, v40, v35
    v_dot2_f32_bf16 v36, v48, v37, v36
    v_dot2_f32_bf16 v34, v41, v37, v34
    v_dot2_f32_bf16 v35, v41, v41, v35
    v_dot2_f32_bf16 v36, v49, v37, v36
    v_dot2_f32_bf16 v34, v42, v37, v34
    v_dot2_f32_bf16 v35, v42, v42, v35
    v_dot2_f32_bf16 v36, v50, v37, v36
    v_dot2_f32_bf16 v34, v43, v37, v34
    v_dot2_f32_bf16 v35, v43, v43, v35
    v_dot2_f32_bf16 v36, v51, v37, v36
    s_nop 1
    s_branch OBK_65
OUT_66:
    v_dot2_f32_bf16 v34, v44, v37, v34
    v_dot2_f32_bf16 v35, v44, v44, v35
    v_dot2_f32_bf16 v36, v64, v37, v36
    v_dot2_f32_bf16 v34, v45, v37, v34
    v_dot2_f32_bf16 v35, v45, v45, v35
    v_dot2_f32_bf16 v36, v65, v37, v36
    v_dot2_f32_bf16 v34, v46, v37, v34
    v_dot2_f32_bf16 v35, v46, v46, v35
    v_dot2_f32_bf16 v36, v66, v37, v36
    v_dot2_f32_bf16 v34, v47, v37, v34
    v_dot2_f32_bf16 v35, v47, v47, v35
    v_dot2_f32_bf16 v36, v67, v37, v36
    s_nop 0
    v_mov_b32 v80, v34
    v_mov_b32 v81, v34
    s_nop 1
    v_permlane32_swap_b32 v80, v81
    v_add_f32 v34, v80, v81
    v_mov_b32 v80, v35
    v_mov_b32 v81, v35
    s_nop 1
    v_permlane32_swap_b32 v80, v81
    v_add_f32 v35, v80, v81
    v_mov_b32 v80, v36
    v_mov_b32 v81, v36
    s_nop 1
    v_permlane32_swap_b32 v80, v81
    v_add_f32 v36, v80, v81
    buffer_store_dwordx2 v[34:35], v109, s[32:35], s51 offen sc1
    buffer_store_dword v36, v102, s[32:35], s52 offen sc1
    s_nop 1
    s_branch OBK_67
OUT_68:
    v_dot2_f32_bf16 v34, v40, v37, v34
    v_dot2_f32_bf16 v35, v40, v40, v35
    v_dot2_f32_bf16 v36, v48, v37, v36
    v_dot2_f32_bf16 v34, v41, v37, v34
    v_dot2_f32_bf16 v35, v41, v41, v35
    v_dot2_f32_bf16 v36, v49, v37, v36
    v_dot2_f32_bf16 v34, v42, v37, v34
    v_dot2_f32_bf16 v35, v42, v42, v35
    v_dot2_f32_bf16 v36, v50, v37, v36
    v_dot2_f32_bf16 v34, v43, v37, v34
    v_dot2_f32_bf16 v35, v43, v43, v35
    v_dot2_f32_bf16 v36, v51, v37, v36
    s_nop 1
    s_branch OBK_69
OUT_70:
    v_dot2_f32_bf16 v34, v44, v37, v34
    v_dot2_f32_bf16 v35, v44, v44, v35
    v_dot2_f32_bf16 v36, v64, v37, v36
    v_dot2_f32_bf16 v34, v45, v37, v34
    v_dot2_f32_bf16 v35, v45, v45, v35
    v_dot2_f32_bf16 v36, v65, v37, v36
    v_dot2_f32_bf16 v34, v46, v37, v34
    v_dot2_f32_bf16 v35, v46, v46, v35
    v_dot2_f32_bf16 v36, v66, v37, v36
    v_dot2_f32_bf16 v34, v47, v37, v34
    v_dot2_f32_bf16 v35, v47, v47, v35
    v_dot2_f32_bf16 v36, v67, v37, v36
    s_nop 1
    s_branch OBK_71
OUT_72:
    v_dot2_f32_bf16 v34, v40, v37, v34
    v_dot2_f32_bf16 v35, v40, v40, v35
    v_dot2_f32_bf16 v36, v48, v37, v36
    v_dot2_f32_bf16 v34, v41, v37, v34
    v_dot2_f32_bf16 v35, v41, v41, v35
    v_dot2_f32_bf16 v36, v49, v37, v36
    v_dot2_f32_bf16 v34, v42, v37, v34
    v_dot2_f32_bf16 v35, v42, v42, v35
    v_dot2_f32_bf16 v36, v50, v37, v36
    v_dot2_f32_bf16 v34, v43, v37, v34
    v_dot2_f32_bf16 v35, v43, v43, v35
    v_dot2_f32_bf16 v36, v51, v37, v36
    s_nop 1
    s_branch OBK_73
OUT_74:
    s_branch NF_78
NL_76:
    buffer_load_dword v252, v253, s[36:39], 0 offen sc1
NF_78:
    s_waitcnt vmcnt(0)
    v_readfirstlane_b32 s3, v252
    s_nop 0
    s_cmp_lg_u32 s3, 0
    s_nop 1
    s_cbranch_scc1 ND_77
    s_cmp_eq_u32 s57, 0
    s_cbranch_scc1 ND_77
    s_sub_u32 s57, s57, 1
    s_sleep 4
    s_branch NL_76
ND_77:
    v_mov_b32 v253, 162816
    ds_write_b32 v253, v252
    s_waitcnt lgkmcnt(0)
    s_nop 1
    s_branch OBK_75
OUT_79:
    v_dot2_f32_bf16 v34, v44, v37, v34
    v_dot2_f32_bf16 v35, v44, v44, v35
    v_dot2_f32_bf16 v36, v64, v37, v36
    v_dot2_f32_bf16 v34, v45, v37, v34
    v_dot2_f32_bf16 v35, v45, v45, v35
    v_dot2_f32_bf16 v36, v65, v37, v36
    v_dot2_f32_bf16 v34, v46, v37, v34
    v_dot2_f32_bf16 v35, v46, v46, v35
    v_dot2_f32_bf16 v36, v66, v37, v36
    v_dot2_f32_bf16 v34, v47, v37, v34
    v_dot2_f32_bf16 v35, v47, v47, v35
    v_dot2_f32_bf16 v36, v67, v37, v36
    s_nop 0
    v_mov_b32 v80, v34
    v_mov_b32 v81, v34
    s_nop 1
    v_permlane32_swap_b32 v80, v81
    v_add_f32 v34, v80, v81
    v_mov_b32 v80, v35
    v_mov_b32 v81, v35
    s_nop 1
    v_permlane32_swap_b32 v80, v81
    v_add_f32 v35, v80, v81
    v_mov_b32 v80, v36
    v_mov_b32 v81, v36
    s_nop 1
    v_permlane32_swap_b32 v80, v81
    v_add_f32 v36, v80, v81
    buffer_store_dwordx2 v[34:35], v109, s[32:35], s51 offen sc1
    buffer_store_dword v36, v102, s[32:35], s52 offen sc1
    s_nop 1
    s_branch OBK_80
OUT_81:
    v_dot2_f32_bf16 v34, v40, v37, v34
    v_dot2_f32_bf16 v35, v40, v40, v35
    v_dot2_f32_bf16 v36, v48, v37, v36
    v_dot2_f32_bf16 v34, v41, v37, v34
    v_dot2_f32_bf16 v35, v41, v41, v35
    v_dot2_f32_bf16 v36, v49, v37, v36
    v_dot2_f32_bf16 v34, v42, v37, v34
    v_dot2_f32_bf16 v35, v42, v42, v35
    v_dot2_f32_bf16 v36, v50, v37, v36
    v_dot2_f32_bf16 v34, v43, v37, v34
    v_dot2_f32_bf16 v35, v43, v43, v35
    v_dot2_f32_bf16 v36, v51, v37, v36
    s_nop 1
    s_branch OBK_82
OUT_83:
    v_dot2_f32_bf16 v34, v44, v37, v34
    v_dot2_f32_bf16 v35, v44, v44, v35
    v_dot2_f32_bf16 v36, v64, v37, v36
    v_dot2_f32_bf16 v34, v45, v37, v34
    v_dot2_f32_bf16 v35, v45, v45, v35
    v_dot2_f32_bf16 v36, v65, v37, v36
    v_dot2_f32_bf16 v34, v46, v37, v34
    v_dot2_f32_bf16 v35, v46, v46, v35
    v_dot2_f32_bf16 v36, v66, v37, v36
    v_dot2_f32_bf16 v34, v47, v37, v34
    v_dot2_f32_bf16 v35, v47, v47, v35
    v_dot2_f32_bf16 v36, v67, v37, v36
    s_nop 1
    s_branch OBK_84
OUT_85:
    v_dot2_f32_bf16 v34, v40, v37, v34
    v_dot2_f32_bf16 v35, v40, v40, v35
    v_dot2_f32_bf16 v36, v48, v37, v36
    v_dot2_f32_bf16 v34, v41, v37, v34
    v_dot2_f32_bf16 v35, v41, v41, v35
    v_dot2_f32_bf16 v36, v49, v37, v36
    v_dot2_f32_bf16 v34, v42, v37, v34
    v_dot2_f32_bf16 v35, v42, v42, v35
    v_dot2_f32_bf16 v36, v50, v37, v36
    v_dot2_f32_bf16 v34, v43, v37, v34
    v_dot2_f32_bf16 v35, v43, v43, v35
    v_dot2_f32_bf16 v36, v51, v37, v36
    s_nop 1
    s_branch OBK_86
OUT_87:
    v_dot2_f32_bf16 v34, v44, v37, v34
    v_dot2_f32_bf16 v35, v44, v44, v35
    v_dot2_f32_bf16 v36, v64, v37, v36
    v_dot2_f32_bf16 v34, v45, v37, v34
    v_dot2_f32_bf16 v35, v45, v45, v35
    v_dot2_f32_bf16 v36, v65, v37, v36
    v_dot2_f32_bf16 v34, v46, v37, v34
    v_dot2_f32_bf16 v35, v46, v46, v35
    v_dot2_f32_bf16 v36, v66, v37, v36
    v_dot2_f32_bf16 v34, v47, v37, v34
    v_dot2_f32_bf16 v35, v47, v47, v35
    v_dot2_f32_bf16 v36, v67, v37, v36
    s_nop 0
    v_mov_b32 v80, v34
    v_mov_b32 v81, v34
    s_nop 1
    v_permlane32_swap_b32 v80, v81
    v_add_f32 v34, v80, v81
    v_mov_b32 v80, v35
    v_mov_b32 v81, v35
    s_nop 1
    v_permlane32_swap_b32 v80, v81
    v_add_f32 v35, v80, v81
    v_mov_b32 v80, v36
    v_mov_b32 v81, v36
    s_nop 1
    v_permlane32_swap_b32 v80, v81
    v_add_f32 v36, v80, v81
    buffer_store_dwordx2 v[34:35], v109, s[32:35], s51 offen sc1
    buffer_store_dword v36, v102, s[32:35], s52 offen sc1
    s_nop 1
    s_branch OBK_88
OUT_89:
    v_dot2_f32_bf16 v34, v40, v37, v34
    v_dot2_f32_bf16 v35, v40, v40, v35
    v_dot2_f32_bf16 v36, v48, v37, v36
    v_dot2_f32_bf16 v34, v41, v37, v34
    v_dot2_f32_bf16 v35, v41, v41, v35
    v_dot2_f32_bf16 v36, v49, v37, v36
    v_dot2_f32_bf16 v34, v42, v37, v34
    v_dot2_f32_bf16 v35, v42, v42, v35
    v_dot2_f32_bf16 v36, v50, v37, v36
    v_dot2_f32_bf16 v34, v43, v37, v34
    v_dot2_f32_bf16 v35, v43, v43, v35
    v_dot2_f32_bf16 v36, v51, v37, v36
    s_nop 1
    s_branch OBK_90
OUT_91:
    v_dot2_f32_bf16 v34, v44, v37, v34
    v_dot2_f32_bf16 v35, v44, v44, v35
    v_dot2_f32_bf16 v36, v64, v37, v36
    v_dot2_f32_bf16 v34, v45, v37, v34
    v_dot2_f32_bf16 v35, v45, v45, v35
    v_dot2_f32_bf16 v36, v65, v37, v36
    v_dot2_f32_bf16 v34, v46, v37, v34
    v_dot2_f32_bf16 v35, v46, v46, v35
    v_dot2_f32_bf16 v36, v66, v37, v36
    v_dot2_f32_bf16 v34, v47, v37, v34
    v_dot2_f32_bf16 v35, v47, v47, v35
    v_dot2_f32_bf16 v36, v67, v37, v36
    s_nop 1
    s_branch OBK_92
OUT_93:
    v_dot2_f32_bf16 v34, v40, v37, v34
    v_dot2_f32_bf16 v35, v40, v40, v35
    v_dot2_f32_bf16 v36, v48, v37, v36
    v_dot2_f32_bf16 v34, v41, v37, v34
    v_dot2_f32_bf16 v35, v41, v41, v35
    v_dot2_f32_bf16 v36, v49, v37, v36
    v_dot2_f32_bf16 v34, v42, v37, v34
    v_dot2_f32_bf16 v35, v42, v42, v35
    v_dot2_f32_bf16 v36, v50, v37, v36
    v_dot2_f32_bf16 v34, v43, v37, v34
    v_dot2_f32_bf16 v35, v43, v43, v35
    v_dot2_f32_bf16 v36, v51, v37, v36
    s_nop 1
    s_branch OBK_94
OUT_95:
    v_dot2_f32_bf16 v34, v44, v37, v34
    v_dot2_f32_bf16 v35, v44, v44, v35
    v_dot2_f32_bf16 v36, v64, v37, v36
    v_dot2_f32_bf16 v34, v45, v37, v34
    v_dot2_f32_bf16 v35, v45, v45, v35
    v_dot2_f32_bf16 v36, v65, v37, v36
    v_dot2_f32_bf16 v34, v46, v37, v34
    v_dot2_f32_bf16 v35, v46, v46, v35
    v_dot2_f32_bf16 v36, v66, v37, v36
    v_dot2_f32_bf16 v34, v47, v37, v34
    v_dot2_f32_bf16 v35, v47, v47, v35
    v_dot2_f32_bf16 v36, v67, v37, v36
    s_nop 0
    v_mov_b32 v80, v34
    v_mov_b32 v81, v34
    s_nop 1
    v_permlane32_swap_b32 v80, v81
    v_add_f32 v34, v80, v81
    v_mov_b32 v80, v35
    v_mov_b32 v81, v35
    s_nop 1
    v_permlane32_swap_b32 v80, v81
    v_add_f32 v35, v80, v81
    v_mov_b32 v80, v36
    v_mov_b32 v81, v36
    s_nop 1
    v_permlane32_swap_b32 v80, v81
    v_add_f32 v36, v80, v81
    buffer_store_dwordx2 v[34:35], v109, s[32:35], s51 offen sc1
    buffer_store_dword v36, v102, s[32:35], s52 offen sc1
    s_nop 1
    s_branch OBK_96
OUT_97:
    v_dot2_f32_bf16 v34, v40, v37, v34
    v_dot2_f32_bf16 v35, v40, v40, v35
    v_dot2_f32_bf16 v36, v48, v37, v36
    v_dot2_f32_bf16 v34, v41, v37, v34
    v_dot2_f32_bf16 v35, v41, v41, v35
    v_dot2_f32_bf16 v36, v49, v37, v36
    v_dot2_f32_bf16 v34, v42, v37, v34
    v_dot2_f32_bf16 v35, v42, v42, v35
    v_dot2_f32_bf16 v36, v50, v37, v36
    v_dot2_f32_bf16 v34, v43, v37, v34
    v_dot2_f32_bf16 v35, v43, v43, v35
    v_dot2_f32_bf16 v36, v51, v37, v36
    s_nop 1
    s_branch OBK_98
OUT_99:
    v_dot2_f32_bf16 v34, v44, v37, v34
    v_dot2_f32_bf16 v35, v44, v44, v35
    v_dot2_f32_bf16 v36, v64, v37, v36
    v_dot2_f32_bf16 v34, v45, v37, v34
    v_dot2_f32_bf16 v35, v45, v45, v35
    v_dot2_f32_bf16 v36, v65, v37, v36
    v_dot2_f32_bf16 v34, v46, v37, v34
    v_dot2_f32_bf16 v35, v46, v46, v35
    v_dot2_f32_bf16 v36, v66, v37, v36
    v_dot2_f32_bf16 v34, v47, v37, v34
    v_dot2_f32_bf16 v35, v47, v47, v35
    v_dot2_f32_bf16 v36, v67, v37, v36
    s_nop 1
    s_branch OBK_100
OUT_101:
    v_dot2_f32_bf16 v34, v40, v37, v34
    v_dot2_f32_bf16 v35, v40, v40, v35
    v_dot2_f32_bf16 v36, v48, v37, v36
    v_dot2_f32_bf16 v34, v41, v37, v34
    v_dot2_f32_bf16 v35, v41, v41, v35
    v_dot2_f32_bf16 v36, v49, v37, v36
    v_dot2_f32_bf16 v34, v42, v37, v34
    v_dot2_f32_bf16 v35, v42, v42, v35
    v_dot2_f32_bf16 v36, v50, v37, v36
    v_dot2_f32_bf16 v34, v43, v37, v34
    v_dot2_f32_bf16 v35, v43, v43, v35
    v_dot2_f32_bf16 v36, v51, v37, v36
    s_nop 1
    s_branch OBK_102
OUT_103:
    v_dot2_f32_bf16 v34, v44, v37, v34
    v_dot2_f32_bf16 v35, v44, v44, v35
    v_dot2_f32_bf16 v36, v64, v37, v36
    v_dot2_f32_bf16 v34, v45, v37, v34
    v_dot2_f32_bf16 v35, v45, v45, v35
    v_dot2_f32_bf16 v36, v65, v37, v36
    v_dot2_f32_bf16 v34, v46, v37, v34
    v_dot2_f32_bf16 v35, v46, v46, v35
    v_dot2_f32_bf16 v36, v66, v37, v36
    v_dot2_f32_bf16 v34, v47, v37, v34
    v_dot2_f32_bf16 v35, v47, v47, v35
    v_dot2_f32_bf16 v36, v67, v37, v36
    s_nop 0
    v_mov_b32 v80, v34
    v_mov_b32 v81, v34
    s_nop 1
    v_permlane32_swap_b32 v80, v81
    v_add_f32 v34, v80, v81
    v_mov_b32 v80, v35
    v_mov_b32 v81, v35
    s_nop 1
    v_permlane32_swap_b32 v80, v81
    v_add_f32 v35, v80, v81
    v_mov_b32 v80, v36
    v_mov_b32 v81, v36
    s_nop 1
    v_permlane32_swap_b32 v80, v81
    v_add_f32 v36, v80, v81
    buffer_store_dwordx2 v[34:35], v109, s[32:35], s51 offen sc1
    buffer_store_dword v36, v102, s[32:35], s52 offen sc1
    s_nop 1
    s_branch OBK_104
FSLOW_105:
    s_nop 15
    s_cmp_eq_u32 s57, 0
    s_cbranch_scc1 FBACK_106
    s_sub_u32 s57, s57, 1
    s_sleep 12
    s_mov_b32 s58, 19447808
    buffer_load_dwordx4 v[248:251], v106, s[32:35], s58 offen sc1
    s_waitcnt vmcnt(0)
    v_xor_b32 v248, s3, v248
    v_xor_b32 v249, s3, v249
    v_xor_b32 v250, s3, v250
    v_xor_b32 v251, s3, v251
    v_or3_b32 v248, v248, v249, v250
    v_or_b32 v248, v248, v251
    v_cmp_ne_u32 vcc, 0, v248
    s_nop 3
    s_cbranch_vccnz FSLOW_105
    s_branch FBACK_106
SLOW_107:
    s_nop 15
RETRY_109:
    s_cmp_eq_u32 s57, 0
    s_cbranch_scc1 BACK_108
    s_sub_u32 s57, s57, 1
    s_sleep 2
    s_add_u32 s58, s53, 0
    buffer_load_dwordx2 v[232:233], v103, s[32:35], s58 offen sc1
    s_add_u32 s58, s53, 16384
    buffer_load_dwordx2 v[234:235], v103, s[32:35], s58 offen sc1
    s_add_u32 s58, s53, 32768
    buffer_load_dwordx2 v[236:237], v103, s[32:35], s58 offen sc1
    s_add_u32 s58, s53, 49152
    buffer_load_dwordx2 v[238:239], v103, s[32:35], s58 offen sc1
    s_add_u32 s58, s53, 65536
    buffer_load_dwordx2 v[240:241], v103, s[32:35], s58 offen sc1
    s_add_u32 s58, s54, 0
    buffer_load_dword v242, v104, s[32:35], s58 offen sc1
    s_add_u32 s58, s54, 7680
    buffer_load_dword v243, v104, s[32:35], s58 offen sc1
    s_add_u32 s58, s54, 15360
    buffer_load_dword v244, v104, s[32:35], s58 offen sc1
    s_add_u32 s58, s54, 23040
    buffer_load_dword v245, v104, s[32:35], s58 offen sc1
    s_add_u32 s58, s54, 30720
    buffer_load_dword v246, v104, s[32:35], s58 offen sc1
    s_waitcnt vmcnt(0)
    v_max3_u32 v80, v232, v233, v234
    v_max3_u32 v80, v80, v235, v236
    v_max3_u32 v80, v80, v237, v238
    v_max3_u32 v80, v80, v239, v240
    v_max3_u32 v80, v80, v241, v242
    v_max3_u32 v80, v80, v243, v244
    v_max3_u32 v80, v80, v245, v246
    v_cmp_eq_u32 vcc, -1, v80
    s_nop 3
    s_cbranch_vccnz RETRY_109
    s_branch BACK_108
OUT_110:
    s_branch NF_114
NL_112:
    buffer_load_dword v252, v253, s[36:39], 0 offen sc1
NF_114:
    s_waitcnt vmcnt(0)
    v_readfirstlane_b32 s3, v252
    s_nop 0
    s_cmp_lg_u32 s3, 0
    s_nop 1
    s_cbranch_scc1 ND_113
    s_cmp_eq_u32 s57, 0
    s_cbranch_scc1 ND_113
    s_sub_u32 s57, s57, 1
    s_sleep 4
    s_branch NL_112
ND_113:
    v_mov_b32 v253, 162816
    ds_write_b32 v253, v252
    s_waitcnt lgkmcnt(0)
    s_nop 1
    s_branch OBK_111
OUT_121:
    s_mov_b32 m0, s50
    s_nop 0
    buffer_load_dwordx4 v6, s[32:35], s48 offen sc1 lds
    s_add_u32 m0, m0, s56
    s_nop 0
    buffer_load_dwordx4 v7, s[32:35], s48 offen sc1 lds
    s_add_u32 m0, m0, s56
    s_nop 0
    buffer_load_dwordx4 v8, s[32:35], s48 offen sc1 lds
    s_add_u32 m0, m0, s56
    s_nop 0
    buffer_load_dwordx4 v9, s[32:35], s48 offen sc1 lds
    s_add_u32 m0, m0, s56
    s_nop 0
    buffer_load_dwordx4 v10, s[32:35], s48 offen sc1 lds
    s_branch OBK_122
OUT_123:
    s_mov_b32 m0, s50
    s_nop 0
    buffer_load_dwordx4 v6, s[32:35], s48 offen sc1 lds
    s_add_u32 m0, m0, s56
    s_nop 0
    buffer_load_dwordx4 v7, s[32:35], s48 offen sc1 lds
    s_add_u32 m0, m0, s56
    s_nop 0
    buffer_load_dwordx4 v8, s[32:35], s48 offen sc1 lds
    s_add_u32 m0, m0, s56
    s_nop 0
    buffer_load_dwordx4 v9, s[32:35], s48 offen sc1 lds
    s_add_u32 m0, m0, s56
    s_nop 0
    buffer_load_dwordx4 v10, s[32:35], s48 offen sc1 lds
    s_branch OBK_124
OUT_125:
    v_subrev_u32 v238, 0, v0
    v_cmp_gt_u32 vcc, 120, v238
    v_mul_u32_u24 v239, 10923, v238
    v_lshrrev_b32 v239, 16, v239
    v_mul_u32_u24 v239, 2304, v239
    v_lshl_add_u32 v238, v238, 7, v239
    v_mov_b32 v239, 1073741824
    v_cndmask_b32 v238, v239, v238, vcc
    s_mul_i32 s60, s42, 61440
    s_lshr_b32 s61, s41, 1
    s_mul_i32 s61, s61, 768
    s_add_u32 s60, s60, s61
    buffer_load_dword v239, v238, s[16:19], s60 offen
    buffer_load_dword v239, v238, s[20:23], s60 offen
    s_branch OBK_126
OUT_127:
    s_waitcnt vmcnt(3)
    s_barrier
    s_branch OBK_128
OUT_130:
    s_barrier
    s_branch OBK_131
FSLOW_132:
    s_nop 15
    s_cmp_eq_u32 s57, 0
    s_cbranch_scc1 FBACK_133
    s_sub_u32 s57, s57, 1
    s_sleep 12
    s_mov_b32 s58, 19431424
    buffer_load_dwordx4 v[240:243], v237, s[32:35], s58 offen sc1
    s_waitcnt vmcnt(0)
    v_xor_b32 v240, s3, v240
    v_xor_b32 v241, s3, v241
    v_xor_b32 v242, s3, v242
    v_xor_b32 v243, s3, v243
    v_or3_b32 v240, v240, v241, v242
    v_or_b32 v240, v240, v243
    v_cmp_ne_u32 vcc, 0, v240
    s_nop 3
    s_cbranch_vccnz FSLOW_132
    s_branch FBACK_133
SLOW_134:
    s_nop 15
RETRY_136:
    s_cmp_eq_u32 s57, 0
    s_cbranch_scc1 BACK_135
    s_sub_u32 s57, s57, 1
    s_sleep 2
    s_add_u32 s58, s36, 0
    s_sub_u32 s38, s58, 5
    s_cmp_ge_u32 s58, 5
    s_cselect_b32 s58, s38, s58
    s_mul_i32 s58, s58, 131072
    s_add_u32 s58, s58, s53
    buffer_load_dwordx4 v[164:167], v4, s[32:35], s58 offen sc1
    buffer_load_dwordx4 v[168:171], v5, s[32:35], s58 offen sc1
    buffer_load_dwordx4 v[172:175], v6, s[32:35], s58 offen sc1
    buffer_load_dwordx4 v[176:179], v7, s[32:35], s58 offen sc1
    s_waitcnt vmcnt(0)
    v_max3_u32 v14, v164, v165, v166
    v_max3_u32 v14, v14, v167, v168
    v_max3_u32 v14, v14, v169, v170
    v_max3_u32 v14, v14, v171, v172
    v_max3_u32 v14, v14, v173, v174
    v_max3_u32 v14, v14, v175, v176
    v_max3_u32 v14, v14, v177, v178
    v_max_u32 v14, v14, v179
    v_cmp_eq_u32 vcc, -1, v14
    s_nop 3
    s_cbranch_vccnz RETRY_136
    s_branch BACK_135
SLOW_137:
    s_nop 15
RETRY_139:
    s_cmp_eq_u32 s57, 0
    s_cbranch_scc1 BACK_138
    s_sub_u32 s57, s57, 1
    s_sleep 2
    s_add_u32 s58, s36, 1
    s_sub_u32 s38, s58, 5
    s_cmp_ge_u32 s58, 5
    s_cselect_b32 s58, s38, s58
    s_mul_i32 s58, s58, 131072
    s_add_u32 s58, s58, s53
    buffer_load_dwordx4 v[180:183], v4, s[32:35], s58 offen sc1
    buffer_load_dwordx4 v[184:187], v5, s[32:35], s58 offen sc1
    buffer_load_dwordx4 v[188:191], v6, s[32:35], s58 offen sc1
    buffer_load_dwordx4 v[192:195], v7, s[32:35], s58 offen sc1
    s_add_u32 s58, s36, 2
    s_sub_u32 s38, s58, 5
    s_cmp_ge_u32 s58, 5
    s_cselect_b32 s58, s38, s58
    s_mul_i32 s58, s58, 131072
    s_add_u32 s58, s58, s53
    buffer_load_dwordx4 v[196:199], v4, s[32:35], s58 offen sc1
    buffer_load_dwordx4 v[200:203], v5, s[32:35], s58 offen sc1
    buffer_load_dwordx4 v[204:207], v6, s[32:35], s58 offen sc1
    buffer_load_dwordx4 v[208:211], v7, s[32:35], s58 offen sc1
    s_waitcnt vmcnt(0)
    v_max3_u32 v14, v180, v181, v182
    v_max3_u32 v14, v14, v183, v184
    v_max3_u32 v14, v14, v185, v186
    v_max3_u32 v14, v14, v187, v188
    v_max3_u32 v14, v14, v189, v190
    v_max3_u32 v14, v14, v191, v192
    v_max3_u32 v14, v14, v193, v194
    v_max_u32 v14, v14, v195
    v_cmp_eq_u32 vcc, -1, v14
    s_nop 3
    s_cbranch_vccnz RETRY_139
    s_branch BACK_138
SLOW_140:
    s_nop 15
RETRY_142:
    s_cmp_eq_u32 s57, 0
    s_cbranch_scc1 BACK_141
    s_sub_u32 s57, s57, 1
    s_sleep 2
    s_add_u32 s58, s36, 2
    s_sub_u32 s38, s58, 5
    s_cmp_ge_u32 s58, 5
    s_cselect_b32 s58, s38, s58
    s_mul_i32 s58, s58, 131072
    s_add_u32 s58, s58, s53
    buffer_load_dwordx4 v[196:199], v4, s[32:35], s58 offen sc1
    buffer_load_dwordx4 v[200:203], v5, s[32:35], s58 offen sc1
    buffer_load_dwordx4 v[204:207], v6, s[32:35], s58 offen sc1
    buffer_load_dwordx4 v[208:211], v7, s[32:35], s58 offen sc1
    s_add_u32 s58, s36, 3
    s_sub_u32 s38, s58, 5
    s_cmp_ge_u32 s58, 5
    s_cselect_b32 s58, s38, s58
    s_mul_i32 s58, s58, 131072
    s_add_u32 s58, s58, s53
    buffer_load_dwordx4 v[212:215], v4, s[32:35], s58 offen sc1
    buffer_load_dwordx4 v[216:219], v5, s[32:35], s58 offen sc1
    buffer_load_dwordx4 v[220:223], v6, s[32:35], s58 offen sc1
    buffer_load_dwordx4 v[224:227], v7, s[32:35], s58 offen sc1
    s_add_u32 s58, s36, 4
    s_sub_u32 s38, s58, 5
    s_cmp_ge_u32 s58, 5
    s_cselect_b32 s58, s38, s58
    s_mul_i32 s58, s58, 131072
    s_add_u32 s58, s58, s53
    buffer_load_dwordx4 v[228:231], v4, s[32:35], s58 offen sc1
    buffer_load_dwordx4 v[232:235], v5, s[32:35], s58 offen sc1
    buffer_load_dwordx4 v[236:239], v6, s[32:35], s58 offen sc1
    buffer_load_dwordx4 v[240:243], v7, s[32:35], s58 offen sc1
    s_waitcnt vmcnt(0)
    v_max3_u32 v14, v196, v197, v198
    v_max3_u32 v14, v14, v199, v200
    v_max3_u32 v14, v14, v201, v202
    v_max3_u32 v14, v14, v203, v204
    v_max3_u32 v14, v14, v205, v206
    v_max3_u32 v14, v14, v207, v208
    v_max3_u32 v14, v14, v209, v210
    v_max_u32 v14, v14, v211
    v_cmp_eq_u32 vcc, -1, v14
    s_nop 3
    s_cbranch_vccnz RETRY_142
    s_branch BACK_141
SLOW_143:
    s_nop 15
RETRY_145:
    s_cmp_eq_u32 s57, 0
    s_cbranch_scc1 BACK_144
    s_sub_u32 s57, s57, 1
    s_sleep 2
    s_add_u32 s58, s36, 3
    s_sub_u32 s38, s58, 5
    s_cmp_ge_u32 s58, 5
    s_cselect_b32 s58, s38, s58
    s_mul_i32 s58, s58, 131072
    s_add_u32 s58, s58, s53
    buffer_load_dwordx4 v[212:215], v4, s[32:35], s58 offen sc1
    buffer_load_dwordx4 v[216:219], v5, s[32:35], s58 offen sc1
    buffer_load_dwordx4 v[220:223], v6, s[32:35], s58 offen sc1
    buffer_load_dwordx4 v[224:227], v7, s[32:35], s58 offen sc1
    s_add_u32 s58, s36, 4
    s_sub_u32 s38, s58, 5
    s_cmp_ge_u32 s58, 5
    s_cselect_b32 s58, s38, s58
    s_mul_i32 s58, s58, 131072
    s_add_u32 s58, s58, s53
    buffer_load_dwordx4 v[228:231], v4, s[32:35], s58 offen sc1
    buffer_load_dwordx4 v[232:235], v5, s[32:35], s58 offen sc1
    buffer_load_dwordx4 v[236:239], v6, s[32:35], s58 offen sc1
    buffer_load_dwordx4 v[240:243], v7, s[32:35], s58 offen sc1
    s_waitcnt vmcnt(0)
    v_max3_u32 v14, v212, v213, v214
    v_max3_u32 v14, v14, v215, v216
    v_max3_u32 v14, v14, v217, v218
    v_max3_u32 v14, v14, v219, v220
    v_max3_u32 v14, v14, v221, v222
    v_max3_u32 v14, v14, v223, v224
    v_max3_u32 v14, v14, v225, v226
    v_max_u32 v14, v14, v227
    v_cmp_eq_u32 vcc, -1, v14
    s_nop 3
    s_cbranch_vccnz RETRY_145
    s_branch BACK_144
SLOW_146:
    s_nop 15
RETRY_148:
    s_cmp_eq_u32 s57, 0
    s_cbranch_scc1 BACK_147
    s_sub_u32 s57, s57, 1
    s_sleep 2
    s_add_u32 s58, s36, 4
    s_sub_u32 s38, s58, 5
    s_cmp_ge_u32 s58, 5
    s_cselect_b32 s58, s38, s58
    s_mul_i32 s58, s58, 131072
    s_add_u32 s58, s58, s53
    buffer_load_dwordx4 v[228:231], v4, s[32:35], s58 offen sc1
    buffer_load_dwordx4 v[232:235], v5, s[32:35], s58 offen sc1
    buffer_load_dwordx4 v[236:239], v6, s[32:35], s58 offen sc1
    buffer_load_dwordx4 v[240:243], v7, s[32:35], s58 offen sc1
    s_waitcnt vmcnt(0)
    v_max3_u32 v14, v228, v229, v230
    v_max3_u32 v14, v14, v231, v232
    v_max3_u32 v14, v14, v233, v234
    v_max3_u32 v14, v14, v235, v236
    v_max3_u32 v14, v14, v237, v238
    v_max3_u32 v14, v14, v239, v240
    v_max3_u32 v14, v14, v241, v242
    v_max_u32 v14, v14, v243
    v_cmp_eq_u32 vcc, -1, v14
    s_nop 3
    s_cbranch_vccnz RETRY_148
    s_branch BACK_147
SLOW_149:
    s_nop 15
RETRY_151:
    s_cmp_eq_u32 s57, 0
    s_cbranch_scc1 BACK_150
    s_sub_u32 s57, s57, 1
    s_sleep 2
    s_add_u32 s58, s76, 0
    s_sub_u32 s59, s58, 10
    s_cmp_ge_u32 s58, 10
    s_cselect_b32 s58, s59, s58
    s_lshl_b32 s58, s58, 18
    s_add_u32 s58, s58, s50
    buffer_load_dwordx4 v[180:183], v5, s[32:35], s58 offen sc1
    s_add_u32 s58, s58, 65536
    buffer_load_dwordx4 v[184:187], v5, s[32:35], s58 offen sc1
    s_add_u32 s58, s58, 65536
    buffer_load_dwordx4 v[188:191], v5, s[32:35], s58 offen sc1
    s_add_u32 s58, s58, 65536
    buffer_load_dwordx4 v[192:195], v5, s[32:35], s58 offen sc1
    s_waitcnt vmcnt(0)
    v_max3_u32 v4, v180, v181, v182
    v_max3_u32 v4, v4, v183, v184
    v_max3_u32 v4, v4, v185, v186
    v_max3_u32 v4, v4, v187, v188
    v_max3_u32 v4, v4, v189, v190
    v_max3_u32 v4, v4, v191, v192
    v_max3_u32 v4, v4, v193, v194
    v_max_u32 v4, v4, v195
    v_cmp_eq_u32 vcc, -1, v4
    s_nop 3
    s_cbranch_vccnz RETRY_151
    s_branch BACK_150
SLOW_152:
    s_nop 15
RETRY_154:
    s_cmp_eq_u32 s57, 0
    s_cbranch_scc1 BACK_153
    s_sub_u32 s57, s57, 1
    s_sleep 2
    s_add_u32 s58, s76, 1
    s_sub_u32 s59, s58, 10
    s_cmp_ge_u32 s58, 10
    s_cselect_b32 s58, s59, s58
    s_lshl_b32 s58, s58, 18
    s_add_u32 s58, s58, s50
    buffer_load_dwordx4 v[196:199], v5, s[32:35], s58 offen sc1
    s_add_u32 s58, s58, 65536
    buffer_load_dwordx4 v[200:203], v5, s[32:35], s58 offen sc1
    s_add_u32 s58, s58, 65536
    buffer_load_dwordx4 v[204:207], v5, s[32:35], s58 offen sc1
    s_add_u32 s58, s58, 65536
    buffer_load_dwordx4 v[208:211], v5, s[32:35], s58 offen sc1
    s_add_u32 s58, s76, 2
    s_sub_u32 s59, s58, 10
    s_cmp_ge_u32 s58, 10
    s_cselect_b32 s58, s59, s58
    s_lshl_b32 s58, s58, 18
    s_add_u32 s58, s58, s50
    buffer_load_dwordx4 v[212:215], v5, s[32:35], s58 offen sc1
    s_add_u32 s58, s58, 65536
    buffer_load_dwordx4 v[216:219], v5, s[32:35], s58 offen sc1
    s_add_u32 s58, s58, 65536
    buffer_load_dwordx4 v[220:223], v5, s[32:35], s58 offen sc1
    s_add_u32 s58, s58, 65536
    buffer_load_dwordx4 v[224:227], v5, s[32:35], s58 offen sc1
    s_add_u32 s58, s76, 3
    s_sub_u32 s59, s58, 10
    s_cmp_ge_u32 s58, 10
    s_cselect_b32 s58, s59, s58
    s_lshl_b32 s58, s58, 18
    s_add_u32 s58, s58, s50
    buffer_load_dwordx4 v[228:231], v5, s[32:35], s58 offen sc1
    s_add_u32 s58, s58, 65536
    buffer_load_dwordx4 v[232:235], v5, s[32:35], s58 offen sc1
    s_add_u32 s58, s58, 65536
    buffer_load_dwordx4 v[236:239], v5, s[32:35], s58 offen sc1
    s_add_u32 s58, s58, 65536
    buffer_load_dwordx4 v[240:243], v5, s[32:35], s58 offen sc1
    s_waitcnt vmcnt(0)
    v_max3_u32 v4, v196, v197, v198
    v_max3_u32 v4, v4, v199, v200
    v_max3_u32 v4, v4, v201, v202
    v_max3_u32 v4, v4, v203, v204
    v_max3_u32 v4, v4, v205, v206
    v_max3_u32 v4, v4, v207, v208
    v_max3_u32 v4, v4, v209, v210
    v_max_u32 v4, v4, v211
    v_cmp_eq_u32 vcc, -1, v4
    s_nop 3
    s_cbranch_vccnz RETRY_154
    s_branch BACK_153
SLOW_155:
    s_nop 15
RETRY_157:
    s_cmp_eq_u32 s57, 0
    s_cbranch_scc1 BACK_156
    s_sub_u32 s57, s57, 1
    s_sleep 2
    s_add_u32 s58, s76, 2
    s_sub_u32 s59, s58, 10
    s_cmp_ge_u32 s58, 10
    s_cselect_b32 s58, s59, s58
    s_lshl_b32 s58, s58, 18
    s_add_u32 s58, s58, s50
    buffer_load_dwordx4 v[212:215], v5, s[32:35], s58 offen sc1
    s_add_u32 s58, s58, 65536
    buffer_load_dwordx4 v[216:219], v5, s[32:35], s58 offen sc1
    s_add_u32 s58, s58, 65536
    buffer_load_dwordx4 v[220:223], v5, s[32:35], s58 offen sc1
    s_add_u32 s58, s58, 65536
    buffer_load_dwordx4 v[224:227], v5, s[32:35], s58 offen sc1
    s_add_u32 s58, s76, 3
    s_sub_u32 s59, s58, 10
    s_cmp_ge_u32 s58, 10
    s_cselect_b32 s58, s59, s58
    s_lshl_b32 s58, s58, 18
    s_add_u32 s58, s58, s50
    buffer_load_dwordx4 v[228:231], v5, s[32:35], s58 offen sc1
    s_add_u32 s58, s58, 65536
    buffer_load_dwordx4 v[232:235], v5, s[32:35], s58 offen sc1
    s_add_u32 s58, s58, 65536
    buffer_load_dwordx4 v[236:239], v5, s[32:35], s58 offen sc1
    s_add_u32 s58, s58, 65536
    buffer_load_dwordx4 v[240:243], v5, s[32:35], s58 offen sc1
    s_add_u32 s58, s76, 4
    s_sub_u32 s59, s58, 10
    s_cmp_ge_u32 s58, 10
    s_cselect_b32 s58, s59, s58
    s_lshl_b32 s58, s58, 18
    s_add_u32 s58, s58, s50
    buffer_load_dwordx4 v[180:183], v5, s[32:35], s58 offen sc1
    s_add_u32 s58, s58, 65536
    buffer_load_dwordx4 v[184:187], v5, s[32:35], s58 offen sc1
    s_add_u32 s58, s58, 65536
    buffer_load_dwordx4 v[188:191], v5, s[32:35], s58 offen sc1
    s_add_u32 s58, s58, 65536
    buffer_load_dwordx4 v[192:195], v5, s[32:35], s58 offen sc1
    s_waitcnt vmcnt(0)
    v_max3_u32 v4, v212, v213, v214
    v_max3_u32 v4, v4, v215, v216
    v_max3_u32 v4, v4, v217, v218
    v_max3_u32 v4, v4, v219, v220
    v_max3_u32 v4, v4, v221, v222
    v_max3_u32 v4, v4, v223, v224
    v_max3_u32 v4, v4, v225, v226
    v_max_u32 v4, v4, v227
    v_cmp_eq_u32 vcc, -1, v4
    s_nop 3
    s_cbranch_vccnz RETRY_157
    s_branch BACK_156
SLOW_158:
    s_nop 15
RETRY_160:
    s_cmp_eq_u32 s57, 0
    s_cbranch_scc1 BACK_159
    s_sub_u32 s57, s57, 1
    s_sleep 2
    s_add_u32 s58, s76, 3
    s_sub_u32 s59, s58, 10
    s_cmp_ge_u32 s58, 10
    s_cselect_b32 s58, s59, s58
    s_lshl_b32 s58, s58, 18
    s_add_u32 s58, s58, s50
    buffer_load_dwordx4 v[228:231], v5, s[32:35], s58 offen sc1
    s_add_u32 s58, s58, 65536
    buffer_load_dwordx4 v[232:235], v5, s[32:35], s58 offen sc1
    s_add_u32 s58, s58, 65536
    buffer_load_dwordx4 v[236:239], v5, s[32:35], s58 offen sc1
    s_add_u32 s58, s58, 65536
    buffer_load_dwordx4 v[240:243], v5, s[32:35], s58 offen sc1
    s_add_u32 s58, s76, 4
    s_sub_u32 s59, s58, 10
    s_cmp_ge_u32 s58, 10
    s_cselect_b32 s58, s59, s58
    s_lshl_b32 s58, s58, 18
    s_add_u32 s58, s58, s50
    buffer_load_dwordx4 v[180:183], v5, s[32:35], s58 offen sc1
    s_add_u32 s58, s58, 65536
    buffer_load_dwordx4 v[184:187], v5, s[32:35], s58 offen sc1
    s_add_u32 s58, s58, 65536
    buffer_load_dwordx4 v[188:191], v5, s[32:35], s58 offen sc1
    s_add_u32 s58, s58, 65536
    buffer_load_dwordx4 v[192:195], v5, s[32:35], s58 offen sc1
    s_add_u32 s58, s76, 5
    s_sub_u32 s59, s58, 10
    s_cmp_ge_u32 s58, 10
    s_cselect_b32 s58, s59, s58
    s_lshl_b32 s58, s58, 18
    s_add_u32 s58, s58, s50
    buffer_load_dwordx4 v[196:199], v5, s[32:35], s58 offen sc1
    s_add_u32 s58, s58, 65536
    buffer_load_dwordx4 v[200:203], v5, s[32:35], s58 offen sc1
    s_add_u32 s58, s58, 65536
    buffer_load_dwordx4 v[204:207], v5, s[32:35], s58 offen sc1
    s_add_u32 s58, s58, 65536
    buffer_load_dwordx4 v[208:211], v5, s[32:35], s58 offen sc1
    s_waitcnt vmcnt(0)
    v_max3_u32 v4, v228, v229, v230
    v_max3_u32 v4, v4, v231, v232
    v_max3_u32 v4, v4, v233, v234
    v_max3_u32 v4, v4, v235, v236
    v_max3_u32 v4, v4, v237, v238
    v_max3_u32 v4, v4, v239, v240
    v_max3_u32 v4, v4, v241, v242
    v_max_u32 v4, v4, v243
    v_cmp_eq_u32 vcc, -1, v4
    s_nop 3
    s_cbranch_vccnz RETRY_160
    s_branch BACK_159
SLOW_161:
    s_nop 15
RETRY_163:
    s_cmp_eq_u32 s57, 0
    s_cbranch_scc1 BACK_162
    s_sub_u32 s57, s57, 1
    s_sleep 2
    s_add_u32 s58, s76, 4
    s_sub_u32 s59, s58, 10
    s_cmp_ge_u32 s58, 10
    s_cselect_b32 s58, s59, s58
    s_lshl_b32 s58, s58, 18
    s_add_u32 s58, s58, s50
    buffer_load_dwordx4 v[180:183], v5, s[32:35], s58 offen sc1
    s_add_u32 s58, s58, 65536
    buffer_load_dwordx4 v[184:187], v5, s[32:35], s58 offen sc1
    s_add_u32 s58, s58, 65536
    buffer_load_dwordx4 v[188:191], v5, s[32:35], s58 offen sc1
    s_add_u32 s58, s58, 65536
    buffer_load_dwordx4 v[192:195], v5, s[32:35], s58 offen sc1
    s_add_u32 s58, s76, 5
    s_sub_u32 s59, s58, 10
    s_cmp_ge_u32 s58, 10
    s_cselect_b32 s58, s59, s58
    s_lshl_b32 s58, s58, 18
    s_add_u32 s58, s58, s50
    buffer_load_dwordx4 v[196:199], v5, s[32:35], s58 offen sc1
    s_add_u32 s58, s58, 65536
    buffer_load_dwordx4 v[200:203], v5, s[32:35], s58 offen sc1
    s_add_u32 s58, s58, 65536
    buffer_load_dwordx4 v[204:207], v5, s[32:35], s58 offen sc1
    s_add_u32 s58, s58, 65536
    buffer_load_dwordx4 v[208:211], v5, s[32:35], s58 offen sc1
    s_add_u32 s58, s76, 6
    s_sub_u32 s59, s58, 10
    s_cmp_ge_u32 s58, 10
    s_cselect_b32 s58, s59, s58
    s_lshl_b32 s58, s58, 18
    s_add_u32 s58, s58, s50
    buffer_load_dwordx4 v[212:215], v5, s[32:35], s58 offen sc1
    s_add_u32 s58, s58, 65536
    buffer_load_dwordx4 v[216:219], v5, s[32:35], s58 offen sc1
    s_add_u32 s58, s58, 65536
    buffer_load_dwordx4 v[220:223], v5, s[32:35], s58 offen sc1
    s_add_u32 s58, s58, 65536
    buffer_load_dwordx4 v[224:227], v5, s[32:35], s58 offen sc1
    s_waitcnt vmcnt(0)
    v_max3_u32 v4, v180, v181, v182
    v_max3_u32 v4, v4, v183, v184
    v_max3_u32 v4, v4, v185, v186
    v_max3_u32 v4, v4, v187, v188
    v_max3_u32 v4, v4, v189, v190
    v_max3_u32 v4, v4, v191, v192
    v_max3_u32 v4, v4, v193, v194
    v_max_u32 v4, v4, v195
    v_cmp_eq_u32 vcc, -1, v4
    s_nop 3
    s_cbranch_vccnz RETRY_163
    s_branch BACK_162
SLOW_164:
    s_nop 15
RETRY_166:
    s_cmp_eq_u32 s57, 0
    s_cbranch_scc1 BACK_165
    s_sub_u32 s57, s57, 1
    s_sleep 2
    s_add_u32 s58, s76, 5
    s_sub_u32 s59, s58, 10
    s_cmp_ge_u32 s58, 10
    s_cselect_b32 s58, s59, s58
    s_lshl_b32 s58, s58, 18
    s_add_u32 s58, s58, s50
    buffer_load_dwordx4 v[196:199], v5, s[32:35], s58 offen sc1
    s_add_u32 s58, s58, 65536
    buffer_load_dwordx4 v[200:203], v5, s[32:35], s58 offen sc1
    s_add_u32 s58, s58, 65536
    buffer_load_dwordx4 v[204:207], v5, s[32:35], s58 offen sc1
    s_add_u32 s58, s58, 65536
    buffer_load_dwordx4 v[208:211], v5, s[32:35], s58 offen sc1
    s_add_u32 s58, s76, 6
    s_sub_u32 s59, s58, 10
    s_cmp_ge_u32 s58, 10
    s_cselect_b32 s58, s59, s58
    s_lshl_b32 s58, s58, 18
    s_add_u32 s58, s58, s50
    buffer_load_dwordx4 v[212:215], v5, s[32:35], s58 offen sc1
    s_add_u32 s58, s58, 65536
    buffer_load_dwordx4 v[216:219], v5, s[32:35], s58 offen sc1
    s_add_u32 s58, s58, 65536
    buffer_load_dwordx4 v[220:223], v5, s[32:35], s58 offen sc1
    s_add_u32 s58, s58, 65536
    buffer_load_dwordx4 v[224:227], v5, s[32:35], s58 offen sc1
    s_add_u32 s58, s76, 7
    s_sub_u32 s59, s58, 10
    s_cmp_ge_u32 s58, 10
    s_cselect_b32 s58, s59, s58
    s_lshl_b32 s58, s58, 18
    s_add_u32 s58, s58, s50
    buffer_load_dwordx4 v[228:231], v5, s[32:35], s58 offen sc1
    s_add_u32 s58, s58, 65536
    buffer_load_dwordx4 v[232:235], v5, s[32:35], s58 offen sc1
    s_add_u32 s58, s58, 65536
    buffer_load_dwordx4 v[236:239], v5, s[32:35], s58 offen sc1
    s_add_u32 s58, s58, 65536
    buffer_load_dwordx4 v[240:243], v5, s[32:35], s58 offen sc1
    s_waitcnt vmcnt(0)
    v_max3_u32 v4, v196, v197, v198
    v_max3_u32 v4, v4, v199, v200
    v_max3_u32 v4, v4, v201, v202
    v_max3_u32 v4, v4, v203, v204
    v_max3_u32 v4, v4, v205, v206
    v_max3_u32 v4, v4, v207, v208
    v_max3_u32 v4, v4, v209, v210
    v_max_u32 v4, v4, v211
    v_cmp_eq_u32 vcc, -1, v4
    s_nop 3
    s_cbranch_vccnz RETRY_166
    s_branch BACK_165
SLOW_167:
    s_nop 15
RETRY_169:
    s_cmp_eq_u32 s57, 0
    s_cbranch_scc1 BACK_168
    s_sub_u32 s57, s57, 1
    s_sleep 2
    s_add_u32 s58, s76, 6
    s_sub_u32 s59, s58, 10
    s_cmp_ge_u32 s58, 10
    s_cselect_b32 s58, s59, s58
    s_lshl_b32 s58, s58, 18
    s_add_u32 s58, s58, s50
    buffer_load_dwordx4 v[212:215], v5, s[32:35], s58 offen sc1
    s_add_u32 s58, s58, 65536
    buffer_load_dwordx4 v[216:219], v5, s[32:35], s58 offen sc1
    s_add_u32 s58, s58, 65536
    buffer_load_dwordx4 v[220:223], v5, s[32:35], s58 offen sc1
    s_add_u32 s58, s58, 65536
    buffer_load_dwordx4 v[224:227], v5, s[32:35], s58 offen sc1
    s_add_u32 s58, s76, 7
    s_sub_u32 s59, s58, 10
    s_cmp_ge_u32 s58, 10
    s_cselect_b32 s58, s59, s58
    s_lshl_b32 s58, s58, 18
    s_add_u32 s58, s58, s50
    buffer_load_dwordx4 v[228:231], v5, s[32:35], s58 offen sc1
    s_add_u32 s58, s58, 65536
    buffer_load_dwordx4 v[232:235], v5, s[32:35], s58 offen sc1
    s_add_u32 s58, s58, 65536
    buffer_load_dwordx4 v[236:239], v5, s[32:35], s58 offen sc1
    s_add_u32 s58, s58, 65536
    buffer_load_dwordx4 v[240:243], v5, s[32:35], s58 offen sc1
    s_add_u32 s58, s76, 8
    s_sub_u32 s59, s58, 10
    s_cmp_ge_u32 s58, 10
    s_cselect_b32 s58, s59, s58
    s_lshl_b32 s58, s58, 18
    s_add_u32 s58, s58, s50
    buffer_load_dwordx4 v[180:183], v5, s[32:35], s58 offen sc1
    s_add_u32 s58, s58, 65536
    buffer_load_dwordx4 v[184:187], v5, s[32:35], s58 offen sc1
    s_add_u32 s58, s58, 65536
    buffer_load_dwordx4 v[188:191], v5, s[32:35], s58 offen sc1
    s_add_u32 s58, s58, 65536
    buffer_load_dwordx4 v[192:195], v5, s[32:35], s58 offen sc1
    s_waitcnt vmcnt(0)
    v_max3_u32 v4, v212, v213, v214
    v_max3_u32 v4, v4, v215, v216
    v_max3_u32 v4, v4, v217, v218
    v_max3_u32 v4, v4, v219, v220
    v_max3_u32 v4, v4, v221, v222
    v_max3_u32 v4, v4, v223, v224
    v_max3_u32 v4, v4, v225, v226
    v_max_u32 v4, v4, v227
    v_cmp_eq_u32 vcc, -1, v4
    s_nop 3
    s_cbranch_vccnz RETRY_169
    s_branch BACK_168
SLOW_170:
    s_nop 15
RETRY_172:
    s_cmp_eq_u32 s57, 0
    s_cbranch_scc1 BACK_171
    s_sub_u32 s57, s57, 1
    s_sleep 2
    s_add_u32 s58, s76, 7
    s_sub_u32 s59, s58, 10
    s_cmp_ge_u32 s58, 10
    s_cselect_b32 s58, s59, s58
    s_lshl_b32 s58, s58, 18
    s_add_u32 s58, s58, s50
    buffer_load_dwordx4 v[228:231], v5, s[32:35], s58 offen sc1
    s_add_u32 s58, s58, 65536
    buffer_load_dwordx4 v[232:235], v5, s[32:35], s58 offen sc1
    s_add_u32 s58, s58, 65536
    buffer_load_dwordx4 v[236:239], v5, s[32:35], s58 offen sc1
    s_add_u32 s58, s58, 65536
    buffer_load_dwordx4 v[240:243], v5, s[32:35], s58 offen sc1
    s_add_u32 s58, s76, 8
    s_sub_u32 s59, s58, 10
    s_cmp_ge_u32 s58, 10
    s_cselect_b32 s58, s59, s58
    s_lshl_b32 s58, s58, 18
    s_add_u32 s58, s58, s50
    buffer_load_dwordx4 v[180:183], v5, s[32:35], s58 offen sc1
    s_add_u32 s58, s58, 65536
    buffer_load_dwordx4 v[184:187], v5, s[32:35], s58 offen sc1
    s_add_u32 s58, s58, 65536
    buffer_load_dwordx4 v[188:191], v5, s[32:35], s58 offen sc1
    s_add_u32 s58, s58, 65536
    buffer_load_dwordx4 v[192:195], v5, s[32:35], s58 offen sc1
    s_add_u32 s58, s76, 9
    s_sub_u32 s59, s58, 10
    s_cmp_ge_u32 s58, 10
    s_cselect_b32 s58, s59, s58
    s_lshl_b32 s58, s58, 18
    s_add_u32 s58, s58, s50
    buffer_load_dwordx4 v[196:199], v5, s[32:35], s58 offen sc1
    s_add_u32 s58, s58, 65536
    buffer_load_dwordx4 v[200:203], v5, s[32:35], s58 offen sc1
    s_add_u32 s58, s58, 65536
    buffer_load_dwordx4 v[204:207], v5, s[32:35], s58 offen sc1
    s_add_u32 s58, s58, 65536
    buffer_load_dwordx4 v[208:211], v5, s[32:35], s58 offen sc1
    s_waitcnt vmcnt(0)
    v_max3_u32 v4, v228, v229, v230
    v_max3_u32 v4, v4, v231, v232
    v_max3_u32 v4, v4, v233, v234
    v_max3_u32 v4, v4, v235, v236
    v_max3_u32 v4, v4, v237, v238
    v_max3_u32 v4, v4, v239, v240
    v_max3_u32 v4, v4, v241, v242
    v_max_u32 v4, v4, v243
    v_cmp_eq_u32 vcc, -1, v4
    s_nop 3
    s_cbranch_vccnz RETRY_172
    s_branch BACK_171
SLOW_173:
    s_nop 15
RETRY_175:
    s_cmp_eq_u32 s57, 0
    s_cbranch_scc1 BACK_174
    s_sub_u32 s57, s57, 1
    s_sleep 2
    s_add_u32 s58, s76, 8
    s_sub_u32 s59, s58, 10
    s_cmp_ge_u32 s58, 10
    s_cselect_b32 s58, s59, s58
    s_lshl_b32 s58, s58, 18
    s_add_u32 s58, s58, s50
    buffer_load_dwordx4 v[180:183], v5, s[32:35], s58 offen sc1
    s_add_u32 s58, s58, 65536
    buffer_load_dwordx4 v[184:187], v5, s[32:35], s58 offen sc1
    s_add_u32 s58, s58, 65536
    buffer_load_dwordx4 v[188:191], v5, s[32:35], s58 offen sc1
    s_add_u32 s58, s58, 65536
    buffer_load_dwordx4 v[192:195], v5, s[32:35], s58 offen sc1
    s_add_u32 s58, s76, 9
    s_sub_u32 s59, s58, 10
    s_cmp_ge_u32 s58, 10
    s_cselect_b32 s58, s59, s58
    s_lshl_b32 s58, s58, 18
    s_add_u32 s58, s58, s50
    buffer_load_dwordx4 v[196:199], v5, s[32:35], s58 offen sc1
    s_add_u32 s58, s58, 65536
    buffer_load_dwordx4 v[200:203], v5, s[32:35], s58 offen sc1
    s_add_u32 s58, s58, 65536
    buffer_load_dwordx4 v[204:207], v5, s[32:35], s58 offen sc1
    s_add_u32 s58, s58, 65536
    buffer_load_dwordx4 v[208:211], v5, s[32:35], s58 offen sc1
    s_waitcnt vmcnt(0)
    v_max3_u32 v4, v180, v181, v182
    v_max3_u32 v4, v4, v183, v184
    v_max3_u32 v4, v4, v185, v186
    v_max3_u32 v4, v4, v187, v188
    v_max3_u32 v4, v4, v189, v190
    v_max3_u32 v4, v4, v191, v192
    v_max3_u32 v4, v4, v193, v194
    v_max_u32 v4, v4, v195
    v_cmp_eq_u32 vcc, -1, v4
    s_nop 3
    s_cbranch_vccnz RETRY_175
    s_branch BACK_174
SLOW_176:
    s_nop 15
RETRY_178:
    s_cmp_eq_u32 s57, 0
    s_cbranch_scc1 BACK_177
    s_sub_u32 s57, s57, 1
    s_sleep 2
    s_add_u32 s58, s76, 9
    s_sub_u32 s59, s58, 10
    s_cmp_ge_u32 s58, 10
    s_cselect_b32 s58, s59, s58
    s_lshl_b32 s58, s58, 18
    s_add_u32 s58, s58, s50
    buffer_load_dwordx4 v[196:199], v5, s[32:35], s58 offen sc1
    s_add_u32 s58, s58, 65536
    buffer_load_dwordx4 v[200:203], v5, s[32:35], s58 offen sc1
    s_add_u32 s58, s58, 65536
    buffer_load_dwordx4 v[204:207], v5, s[32:35], s58 offen sc1
    s_add_u32 s58, s58, 65536
    buffer_load_dwordx4 v[208:211], v5, s[32:35], s58 offen sc1
    s_waitcnt vmcnt(0)
    v_max3_u32 v4, v196, v197, v198
    v_max3_u32 v4, v4, v199, v200
    v_max3_u32 v4, v4, v201, v202
    v_max3_u32 v4, v4, v203, v204
    v_max3_u32 v4, v4, v205, v206
    v_max3_u32 v4, v4, v207, v208
    v_max3_u32 v4, v4, v209, v210
    v_max_u32 v4, v4, v211
    v_cmp_eq_u32 vcc, -1, v4
    s_nop 3
    s_cbranch_vccnz RETRY_178
    s_branch BACK_177
SLOW_179:
    s_nop 15
RETRY_181:
    s_cmp_eq_u32 s57, 0
    s_cbranch_scc1 BACK_180
    s_sub_u32 s57, s57, 1
    s_sleep 2
    s_add_u32 s58, s51, 0
    buffer_load_dwordx2 v[20:21], v9, s[32:35], s58 offen sc1
    s_add_u32 s58, s51, 16384
    buffer_load_dwordx2 v[22:23], v9, s[32:35], s58 offen sc1
    s_add_u32 s58, s51, 32768
    buffer_load_dwordx2 v[24:25], v9, s[32:35], s58 offen sc1
    s_add_u32 s58, s51, 49152
    buffer_load_dwordx2 v[26:27], v9, s[32:35], s58 offen sc1
    s_waitcnt vmcnt(0)
    v_max3_u32 v11, v20, v21, v22
    v_max3_u32 v11, v11, v23, v24
    v_max3_u32 v11, v11, v25, v26
    v_max_u32 v11, v11, v27
    v_cmp_eq_u32 vcc, -1, v11
    s_nop 3
    s_cbranch_vccnz RETRY_181
    s_branch BACK_180
FSLOW_182:
    s_nop 15
    s_cmp_eq_u32 s57, 0
    s_cbranch_scc1 FBACK_183
    s_sub_u32 s57, s57, 1
    s_sleep 12
    s_mov_b32 s58, 19439616
    buffer_load_dwordx4 v[16:19], v12, s[32:35], s58 offen sc1
    s_waitcnt vmcnt(0)
    v_xor_b32 v16, s3, v16
    v_xor_b32 v17, s3, v17
    v_xor_b32 v18, s3, v18
    v_xor_b32 v19, s3, v19
    v_or3_b32 v16, v16, v17, v18
    v_or_b32 v16, v16, v19
    v_cmp_ne_u32 vcc, 0, v16
    s_nop 3
    s_cbranch_vccnz FSLOW_182
    s_branch FBACK_183
SLOW_184:
    s_nop 15
RETRY_186:
    s_cmp_eq_u32 s57, 0
    s_cbranch_scc1 BACK_185
    s_sub_u32 s57, s57, 1
    s_sleep 2
    s_add_u32 s58, s37, 0
    s_sub_u32 s38, s58, 12
    s_cmp_ge_u32 s58, 12
    s_cselect_b32 s58, s38, s58
    s_mul_i32 s58, s58, 131072
    s_add_u32 s58, s58, s53
    buffer_load_dwordx4 v[164:167], v4, s[32:35], s58 offen sc1
    buffer_load_dwordx4 v[168:171], v5, s[32:35], s58 offen sc1
    buffer_load_dwordx4 v[172:175], v6, s[32:35], s58 offen sc1
    buffer_load_dwordx4 v[176:179], v7, s[32:35], s58 offen sc1
    s_waitcnt vmcnt(0)
    v_max3_u32 v14, v164, v165, v166
    v_max3_u32 v14, v14, v167, v168
    v_max3_u32 v14, v14, v169, v170
    v_max3_u32 v14, v14, v171, v172
    v_max3_u32 v14, v14, v173, v174
    v_max3_u32 v14, v14, v175, v176
    v_max3_u32 v14, v14, v177, v178
    v_max_u32 v14, v14, v179
    v_cmp_eq_u32 vcc, -1, v14
    s_nop 3
    s_cbranch_vccnz RETRY_186
    s_branch BACK_185
SLOW_187:
    s_nop 15
RETRY_189:
    s_cmp_eq_u32 s57, 0
    s_cbranch_scc1 BACK_188
    s_sub_u32 s57, s57, 1
    s_sleep 2
    s_add_u32 s58, s37, 1
    s_sub_u32 s38, s58, 12
    s_cmp_ge_u32 s58, 12
    s_cselect_b32 s58, s38, s58
    s_mul_i32 s58, s58, 131072
    s_add_u32 s58, s58, s53
    buffer_load_dwordx4 v[180:183], v4, s[32:35], s58 offen sc1
    buffer_load_dwordx4 v[184:187], v5, s[32:35], s58 offen sc1
    buffer_load_dwordx4 v[188:191], v6, s[32:35], s58 offen sc1
    buffer_load_dwordx4 v[192:195], v7, s[32:35], s58 offen sc1
    s_add_u32 s58, s37, 2
    s_sub_u32 s38, s58, 12
    s_cmp_ge_u32 s58, 12
    s_cselect_b32 s58, s38, s58
    s_mul_i32 s58, s58, 131072
    s_add_u32 s58, s58, s53
    buffer_load_dwordx4 v[196:199], v4, s[32:35], s58 offen sc1
    buffer_load_dwordx4 v[200:203], v5, s[32:35], s58 offen sc1
    buffer_load_dwordx4 v[204:207], v6, s[32:35], s58 offen sc1
    buffer_load_dwordx4 v[208:211], v7, s[32:35], s58 offen sc1
    s_waitcnt vmcnt(0)
    v_max3_u32 v14, v180, v181, v182
    v_max3_u32 v14, v14, v183, v184
    v_max3_u32 v14, v14, v185, v186
    v_max3_u32 v14, v14, v187, v188
    v_max3_u32 v14, v14, v189, v190
    v_max3_u32 v14, v14, v191, v192
    v_max3_u32 v14, v14, v193, v194
    v_max_u32 v14, v14, v195
    v_cmp_eq_u32 vcc, -1, v14
    s_nop 3
    s_cbranch_vccnz RETRY_189
    s_branch BACK_188
SLOW_190:
    s_nop 15
RETRY_192:
    s_cmp_eq_u32 s57, 0
    s_cbranch_scc1 BACK_191
    s_sub_u32 s57, s57, 1
    s_sleep 2
    s_add_u32 s58, s37, 2
    s_sub_u32 s38, s58, 12
    s_cmp_ge_u32 s58, 12
    s_cselect_b32 s58, s38, s58
    s_mul_i32 s58, s58, 131072
    s_add_u32 s58, s58, s53
    buffer_load_dwordx4 v[196:199], v4, s[32:35], s58 offen sc1
    buffer_load_dwordx4 v[200:203], v5, s[32:35], s58 offen sc1
    buffer_load_dwordx4 v[204:207], v6, s[32:35], s58 offen sc1
    buffer_load_dwordx4 v[208:211], v7, s[32:35], s58 offen sc1
    s_add_u32 s58, s37, 3
    s_sub_u32 s38, s58, 12
    s_cmp_ge_u32 s58, 12
    s_cselect_b32 s58, s38, s58
    s_mul_i32 s58, s58, 131072
    s_add_u32 s58, s58, s53
    buffer_load_dwordx4 v[212:215], v4, s[32:35], s58 offen sc1
    buffer_load_dwordx4 v[216:219], v5, s[32:35], s58 offen sc1
    buffer_load_dwordx4 v[220:223], v6, s[32:35], s58 offen sc1
    buffer_load_dwordx4 v[224:227], v7, s[32:35], s58 offen sc1
    s_add_u32 s58, s37, 4
    s_sub_u32 s38, s58, 12
    s_cmp_ge_u32 s58, 12
    s_cselect_b32 s58, s38, s58
    s_mul_i32 s58, s58, 131072
    s_add_u32 s58, s58, s53
    buffer_load_dwordx4 v[228:231], v4, s[32:35], s58 offen sc1
    buffer_load_dwordx4 v[232:235], v5, s[32:35], s58 offen sc1
    buffer_load_dwordx4 v[236:239], v6, s[32:35], s58 offen sc1
    buffer_load_dwordx4 v[240:243], v7, s[32:35], s58 offen sc1
    s_waitcnt vmcnt(0)
    v_max3_u32 v14, v196, v197, v198
    v_max3_u32 v14, v14, v199, v200
    v_max3_u32 v14, v14, v201, v202
    v_max3_u32 v14, v14, v203, v204
    v_max3_u32 v14, v14, v205, v206
    v_max3_u32 v14, v14, v207, v208
    v_max3_u32 v14, v14, v209, v210
    v_max_u32 v14, v14, v211
    v_cmp_eq_u32 vcc, -1, v14
    s_nop 3
    s_cbranch_vccnz RETRY_192
    s_branch BACK_191
SLOW_193:
    s_nop 15
RETRY_195:
    s_cmp_eq_u32 s57, 0
    s_cbranch_scc1 BACK_194
    s_sub_u32 s57, s57, 1
    s_sleep 2
    s_add_u32 s58, s37, 3
    s_sub_u32 s38, s58, 12
    s_cmp_ge_u32 s58, 12
    s_cselect_b32 s58, s38, s58
    s_mul_i32 s58, s58, 131072
    s_add_u32 s58, s58, s53
    buffer_load_dwordx4 v[212:215], v4, s[32:35], s58 offen sc1
    buffer_load_dwordx4 v[216:219], v5, s[32:35], s58 offen sc1
    buffer_load_dwordx4 v[220:223], v6, s[32:35], s58 offen sc1
    buffer_load_dwordx4 v[224:227], v7, s[32:35], s58 offen sc1
    s_add_u32 s58, s37, 4
    s_sub_u32 s38, s58, 12
    s_cmp_ge_u32 s58, 12
    s_cselect_b32 s58, s38, s58
    s_mul_i32 s58, s58, 131072
    s_add_u32 s58, s58, s53
    buffer_load_dwordx4 v[228:231], v4, s[32:35], s58 offen sc1
    buffer_load_dwordx4 v[232:235], v5, s[32:35], s58 offen sc1
    buffer_load_dwordx4 v[236:239], v6, s[32:35], s58 offen sc1
    buffer_load_dwordx4 v[240:243], v7, s[32:35], s58 offen sc1
    s_add_u32 s58, s37, 5
    s_sub_u32 s38, s58, 12
    s_cmp_ge_u32 s58, 12
    s_cselect_b32 s58, s38, s58
    s_mul_i32 s58, s58, 131072
    s_add_u32 s58, s58, s53
    buffer_load_dwordx4 v[164:167], v4, s[32:35], s58 offen sc1
    buffer_load_dwordx4 v[168:171], v5, s[32:35], s58 offen sc1
    buffer_load_dwordx4 v[172:175], v6, s[32:35], s58 offen sc1
    buffer_load_dwordx4 v[176:179], v7, s[32:35], s58 offen sc1
    s_add_u32 s58, s37, 6
    s_sub_u32 s38, s58, 12
    s_cmp_ge_u32 s58, 12
    s_cselect_b32 s58, s38, s58
    s_mul_i32 s58, s58, 131072
    s_add_u32 s58, s58, s53
    buffer_load_dwordx4 v[180:183], v4, s[32:35], s58 offen sc1
    buffer_load_dwordx4 v[184:187], v5, s[32:35], s58 offen sc1
    buffer_load_dwordx4 v[188:191], v6, s[32:35], s58 offen sc1
    buffer_load_dwordx4 v[192:195], v7, s[32:35], s58 offen sc1
    s_waitcnt vmcnt(0)
    v_max3_u32 v14, v212, v213, v214
    v_max3_u32 v14, v14, v215, v216
    v_max3_u32 v14, v14, v217, v218
    v_max3_u32 v14, v14, v219, v220
    v_max3_u32 v14, v14, v221, v222
    v_max3_u32 v14, v14, v223, v224
    v_max3_u32 v14, v14, v225, v226
    v_max_u32 v14, v14, v227
    v_cmp_eq_u32 vcc, -1, v14
    s_nop 3
    s_cbranch_vccnz RETRY_195
    s_branch BACK_194
SLOW_196:
    s_nop 15
RETRY_198:
    s_cmp_eq_u32 s57, 0
    s_cbranch_scc1 BACK_197
    s_sub_u32 s57, s57, 1
    s_sleep 2
    s_add_u32 s58, s37, 4
    s_sub_u32 s38, s58, 12
    s_cmp_ge_u32 s58, 12
    s_cselect_b32 s58, s38, s58
    s_mul_i32 s58, s58, 131072
    s_add_u32 s58, s58, s53
    buffer_load_dwordx4 v[228:231], v4, s[32:35], s58 offen sc1
    buffer_load_dwordx4 v[232:235], v5, s[32:35], s58 offen sc1
    buffer_load_dwordx4 v[236:239], v6, s[32:35], s58 offen sc1
    buffer_load_dwordx4 v[240:243], v7, s[32:35], s58 offen sc1
    s_add_u32 s58, s37, 5
    s_sub_u32 s38, s58, 12
    s_cmp_ge_u32 s58, 12
    s_cselect_b32 s58, s38, s58
    s_mul_i32 s58, s58, 131072
    s_add_u32 s58, s58, s53
    buffer_load_dwordx4 v[164:167], v4, s[32:35], s58 offen sc1
    buffer_load_dwordx4 v[168:171], v5, s[32:35], s58 offen sc1
    buffer_load_dwordx4 v[172:175], v6, s[32:35], s58 offen sc1
    buffer_load_dwordx4 v[176:179], v7, s[32:35], s58 offen sc1
    s_add_u32 s58, s37, 6
    s_sub_u32 s38, s58, 12
    s_cmp_ge_u32 s58, 12
    s_cselect_b32 s58, s38, s58
    s_mul_i32 s58, s58, 131072
    s_add_u32 s58, s58, s53
    buffer_load_dwordx4 v[180:183], v4, s[32:35], s58 offen sc1
    buffer_load_dwordx4 v[184:187], v5, s[32:35], s58 offen sc1
    buffer_load_dwordx4 v[188:191], v6, s[32:35], s58 offen sc1
    buffer_load_dwordx4 v[192:195], v7, s[32:35], s58 offen sc1
    s_add_u32 s58, s37, 7
    s_sub_u32 s38, s58, 12
    s_cmp_ge_u32 s58, 12
    s_cselect_b32 s58, s38, s58
    s_mul_i32 s58, s58, 131072
    s_add_u32 s58, s58, s53
    buffer_load_dwordx4 v[196:199], v4, s[32:35], s58 offen sc1
    buffer_load_dwordx4 v[200:203], v5, s[32:35], s58 offen sc1
    buffer_load_dwordx4 v[204:207], v6, s[32:35], s58 offen sc1
    buffer_load_dwordx4 v[208:211], v7, s[32:35], s58 offen sc1
    s_waitcnt vmcnt(0)
    v_max3_u32 v14, v228, v229, v230
    v_max3_u32 v14, v14, v231, v232
    v_max3_u32 v14, v14, v233, v234
    v_max3_u32 v14, v14, v235, v236
    v_max3_u32 v14, v14, v237, v238
    v_max3_u32 v14, v14, v239, v240
    v_max3_u32 v14, v14, v241, v242
    v_max_u32 v14, v14, v243
    v_cmp_eq_u32 vcc, -1, v14
    s_nop 3
    s_cbranch_vccnz RETRY_198
    s_branch BACK_197
SLOW_199:
    s_nop 15
RETRY_201:
    s_cmp_eq_u32 s57, 0
    s_cbranch_scc1 BACK_200
    s_sub_u32 s57, s57, 1
    s_sleep 2
    s_add_u32 s58, s37, 5
    s_sub_u32 s38, s58, 12
    s_cmp_ge_u32 s58, 12
    s_cselect_b32 s58, s38, s58
    s_mul_i32 s58, s58, 131072
    s_add_u32 s58, s58, s53
    buffer_load_dwordx4 v[164:167], v4, s[32:35], s58 offen sc1
    buffer_load_dwordx4 v[168:171], v5, s[32:35], s58 offen sc1
    buffer_load_dwordx4 v[172:175], v6, s[32:35], s58 offen sc1
    buffer_load_dwordx4 v[176:179], v7, s[32:35], s58 offen sc1
    s_add_u32 s58, s37, 6
    s_sub_u32 s38, s58, 12
    s_cmp_ge_u32 s58, 12
    s_cselect_b32 s58, s38, s58
    s_mul_i32 s58, s58, 131072
    s_add_u32 s58, s58, s53
    buffer_load_dwordx4 v[180:183], v4, s[32:35], s58 offen sc1
    buffer_load_dwordx4 v[184:187], v5, s[32:35], s58 offen sc1
    buffer_load_dwordx4 v[188:191], v6, s[32:35], s58 offen sc1
    buffer_load_dwordx4 v[192:195], v7, s[32:35], s58 offen sc1
    s_add_u32 s58, s37, 7
    s_sub_u32 s38, s58, 12
    s_cmp_ge_u32 s58, 12
    s_cselect_b32 s58, s38, s58
    s_mul_i32 s58, s58, 131072
    s_add_u32 s58, s58, s53
    buffer_load_dwordx4 v[196:199], v4, s[32:35], s58 offen sc1
    buffer_load_dwordx4 v[200:203], v5, s[32:35], s58 offen sc1
    buffer_load_dwordx4 v[204:207], v6, s[32:35], s58 offen sc1
    buffer_load_dwordx4 v[208:211], v7, s[32:35], s58 offen sc1
    s_add_u32 s58, s37, 8
    s_sub_u32 s38, s58, 12
    s_cmp_ge_u32 s58, 12
    s_cselect_b32 s58, s38, s58
    s_mul_i32 s58, s58, 131072
    s_add_u32 s58, s58, s53
    buffer_load_dwordx4 v[212:215], v4, s[32:35], s58 offen sc1
    buffer_load_dwordx4 v[216:219], v5, s[32:35], s58 offen sc1
    buffer_load_dwordx4 v[220:223], v6, s[32:35], s58 offen sc1
    buffer_load_dwordx4 v[224:227], v7, s[32:35], s58 offen sc1
    s_waitcnt vmcnt(0)
    v_max3_u32 v14, v164, v165, v166
    v_max3_u32 v14, v14, v167, v168
    v_max3_u32 v14, v14, v169, v170
    v_max3_u32 v14, v14, v171, v172
    v_max3_u32 v14, v14, v173, v174
    v_max3_u32 v14, v14, v175, v176
    v_max3_u32 v14, v14, v177, v178
    v_max_u32 v14, v14, v179
    v_cmp_eq_u32 vcc, -1, v14
    s_nop 3
    s_cbranch_vccnz RETRY_201
    s_branch BACK_200
SLOW_202:
    s_nop 15
RETRY_204:
    s_cmp_eq_u32 s57, 0
    s_cbranch_scc1 BACK_203
    s_sub_u32 s57, s57, 1
    s_sleep 2
    s_add_u32 s58, s37, 6
    s_sub_u32 s38, s58, 12
    s_cmp_ge_u32 s58, 12
    s_cselect_b32 s58, s38, s58
    s_mul_i32 s58, s58, 131072
    s_add_u32 s58, s58, s53
    buffer_load_dwordx4 v[180:183], v4, s[32:35], s58 offen sc1
    buffer_load_dwordx4 v[184:187], v5, s[32:35], s58 offen sc1
    buffer_load_dwordx4 v[188:191], v6, s[32:35], s58 offen sc1
    buffer_load_dwordx4 v[192:195], v7, s[32:35], s58 offen sc1
    s_add_u32 s58, s37, 7
    s_sub_u32 s38, s58, 12
    s_cmp_ge_u32 s58, 12
    s_cselect_b32 s58, s38, s58
    s_mul_i32 s58, s58, 131072
    s_add_u32 s58, s58, s53
    buffer_load_dwordx4 v[196:199], v4, s[32:35], s58 offen sc1
    buffer_load_dwordx4 v[200:203], v5, s[32:35], s58 offen sc1
    buffer_load_dwordx4 v[204:207], v6, s[32:35], s58 offen sc1
    buffer_load_dwordx4 v[208:211], v7, s[32:35], s58 offen sc1
    s_add_u32 s58, s37, 8
    s_sub_u32 s38, s58, 12
    s_cmp_ge_u32 s58, 12
    s_cselect_b32 s58, s38, s58
    s_mul_i32 s58, s58, 131072
    s_add_u32 s58, s58, s53
    buffer_load_dwordx4 v[212:215], v4, s[32:35], s58 offen sc1
    buffer_load_dwordx4 v[216:219], v5, s[32:35], s58 offen sc1
    buffer_load_dwordx4 v[220:223], v6, s[32:35], s58 offen sc1
    buffer_load_dwordx4 v[224:227], v7, s[32:35], s58 offen sc1
    s_add_u32 s58, s37, 9
    s_sub_u32 s38, s58, 12
    s_cmp_ge_u32 s58, 12
    s_cselect_b32 s58, s38, s58
    s_mul_i32 s58, s58, 131072
    s_add_u32 s58, s58, s53
    buffer_load_dwordx4 v[228:231], v4, s[32:35], s58 offen sc1
    buffer_load_dwordx4 v[232:235], v5, s[32:35], s58 offen sc1
    buffer_load_dwordx4 v[236:239], v6, s[32:35], s58 offen sc1
    buffer_load_dwordx4 v[240:243], v7, s[32:35], s58 offen sc1
    s_waitcnt vmcnt(0)
    v_max3_u32 v14, v180, v181, v182
    v_max3_u32 v14, v14, v183, v184
    v_max3_u32 v14, v14, v185, v186
    v_max3_u32 v14, v14, v187, v188
    v_max3_u32 v14, v14, v189, v190
    v_max3_u32 v14, v14, v191, v192
    v_max3_u32 v14, v14, v193, v194
    v_max_u32 v14, v14, v195
    v_cmp_eq_u32 vcc, -1, v14
    s_nop 3
    s_cbranch_vccnz RETRY_204
    s_branch BACK_203
SLOW_205:
    s_nop 15
RETRY_207:
    s_cmp_eq_u32 s57, 0
    s_cbranch_scc1 BACK_206
    s_sub_u32 s57, s57, 1
    s_sleep 2
    s_add_u32 s58, s37, 7
    s_sub_u32 s38, s58, 12
    s_cmp_ge_u32 s58, 12
    s_cselect_b32 s58, s38, s58
    s_mul_i32 s58, s58, 131072
    s_add_u32 s58, s58, s53
    buffer_load_dwordx4 v[196:199], v4, s[32:35], s58 offen sc1
    buffer_load_dwordx4 v[200:203], v5, s[32:35], s58 offen sc1
    buffer_load_dwordx4 v[204:207], v6, s[32:35], s58 offen sc1
    buffer_load_dwordx4 v[208:211], v7, s[32:35], s58 offen sc1
    s_add_u32 s58, s37, 8
    s_sub_u32 s38, s58, 12
    s_cmp_ge_u32 s58, 12
    s_cselect_b32 s58, s38, s58
    s_mul_i32 s58, s58, 131072
    s_add_u32 s58, s58, s53
    buffer_load_dwordx4 v[212:215], v4, s[32:35], s58 offen sc1
    buffer_load_dwordx4 v[216:219], v5, s[32:35], s58 offen sc1
    buffer_load_dwordx4 v[220:223], v6, s[32:35], s58 offen sc1
    buffer_load_dwordx4 v[224:227], v7, s[32:35], s58 offen sc1
    s_add_u32 s58, s37, 9
    s_sub_u32 s38, s58, 12
    s_cmp_ge_u32 s58, 12
    s_cselect_b32 s58, s38, s58
    s_mul_i32 s58, s58, 131072
    s_add_u32 s58, s58, s53
    buffer_load_dwordx4 v[228:231], v4, s[32:35], s58 offen sc1
    buffer_load_dwordx4 v[232:235], v5, s[32:35], s58 offen sc1
    buffer_load_dwordx4 v[236:239], v6, s[32:35], s58 offen sc1
    buffer_load_dwordx4 v[240:243], v7, s[32:35], s58 offen sc1
    s_add_u32 s58, s37, 10
    s_sub_u32 s38, s58, 12
    s_cmp_ge_u32 s58, 12
    s_cselect_b32 s58, s38, s58
    s_mul_i32 s58, s58, 131072
    s_add_u32 s58, s58, s53
    buffer_load_dwordx4 v[164:167], v4, s[32:35], s58 offen sc1
    buffer_load_dwordx4 v[168:171], v5, s[32:35], s58 offen sc1
    buffer_load_dwordx4 v[172:175], v6, s[32:35], s58 offen sc1
    buffer_load_dwordx4 v[176:179], v7, s[32:35], s58 offen sc1
    s_waitcnt vmcnt(0)
    v_max3_u32 v14, v196, v197, v198
    v_max3_u32 v14, v14, v199, v200
    v_max3_u32 v14, v14, v201, v202
    v_max3_u32 v14, v14, v203, v204
    v_max3_u32 v14, v14, v205, v206
    v_max3_u32 v14, v14, v207, v208
    v_max3_u32 v14, v14, v209, v210
    v_max_u32 v14, v14, v211
    v_cmp_eq_u32 vcc, -1, v14
    s_nop 3
    s_cbranch_vccnz RETRY_207
    s_branch BACK_206
SLOW_208:
    s_nop 15
RETRY_210:
    s_cmp_eq_u32 s57, 0
    s_cbranch_scc1 BACK_209
    s_sub_u32 s57, s57, 1
    s_sleep 2
    s_add_u32 s58, s37, 8
    s_sub_u32 s38, s58, 12
    s_cmp_ge_u32 s58, 12
    s_cselect_b32 s58, s38, s58
    s_mul_i32 s58, s58, 131072
    s_add_u32 s58, s58, s53
    buffer_load_dwordx4 v[212:215], v4, s[32:35], s58 offen sc1
    buffer_load_dwordx4 v[216:219], v5, s[32:35], s58 offen sc1
    buffer_load_dwordx4 v[220:223], v6, s[32:35], s58 offen sc1
    buffer_load_dwordx4 v[224:227], v7, s[32:35], s58 offen sc1
    s_add_u32 s58, s37, 9
    s_sub_u32 s38, s58, 12
    s_cmp_ge_u32 s58, 12
    s_cselect_b32 s58, s38, s58
    s_mul_i32 s58, s58, 131072
    s_add_u32 s58, s58, s53
    buffer_load_dwordx4 v[228:231], v4, s[32:35], s58 offen sc1
    buffer_load_dwordx4 v[232:235], v5, s[32:35], s58 offen sc1
    buffer_load_dwordx4 v[236:239], v6, s[32:35], s58 offen sc1
    buffer_load_dwordx4 v[240:243], v7, s[32:35], s58 offen sc1
    s_add_u32 s58, s37, 10
    s_sub_u32 s38, s58, 12
    s_cmp_ge_u32 s58, 12
    s_cselect_b32 s58, s38, s58
    s_mul_i32 s58, s58, 131072
    s_add_u32 s58, s58, s53
    buffer_load_dwordx4 v[164:167], v4, s[32:35], s58 offen sc1
    buffer_load_dwordx4 v[168:171], v5, s[32:35], s58 offen sc1
    buffer_load_dwordx4 v[172:175], v6, s[32:35], s58 offen sc1
    buffer_load_dwordx4 v[176:179], v7, s[32:35], s58 offen sc1
    s_add_u32 s58, s37, 11
    s_sub_u32 s38, s58, 12
    s_cmp_ge_u32 s58, 12
    s_cselect_b32 s58, s38, s58
    s_mul_i32 s58, s58, 131072
    s_add_u32 s58, s58, s53
    buffer_load_dwordx4 v[180:183], v4, s[32:35], s58 offen sc1
    buffer_load_dwordx4 v[184:187], v5, s[32:35], s58 offen sc1
    buffer_load_dwordx4 v[188:191], v6, s[32:35], s58 offen sc1
    buffer_load_dwordx4 v[192:195], v7, s[32:35], s58 offen sc1
    s_waitcnt vmcnt(0)
    v_max3_u32 v14, v212, v213, v214
    v_max3_u32 v14, v14, v215, v216
    v_max3_u32 v14, v14, v217, v218
    v_max3_u32 v14, v14, v219, v220
    v_max3_u32 v14, v14, v221, v222
    v_max3_u32 v14, v14, v223, v224
    v_max3_u32 v14, v14, v225, v226
    v_max_u32 v14, v14, v227
    v_cmp_eq_u32 vcc, -1, v14
    s_nop 3
    s_cbranch_vccnz RETRY_210
    s_branch BACK_209
SLOW_211:
    s_nop 15
RETRY_213:
    s_cmp_eq_u32 s57, 0
    s_cbranch_scc1 BACK_212
    s_sub_u32 s57, s57, 1
    s_sleep 2
    s_add_u32 s58, s37, 9
    s_sub_u32 s38, s58, 12
    s_cmp_ge_u32 s58, 12
    s_cselect_b32 s58, s38, s58
    s_mul_i32 s58, s58, 131072
    s_add_u32 s58, s58, s53
    buffer_load_dwordx4 v[228:231], v4, s[32:35], s58 offen sc1
    buffer_load_dwordx4 v[232:235], v5, s[32:35], s58 offen sc1
    buffer_load_dwordx4 v[236:239], v6, s[32:35], s58 offen sc1
    buffer_load_dwordx4 v[240:243], v7, s[32:35], s58 offen sc1
    s_add_u32 s58, s37, 10
    s_sub_u32 s38, s58, 12
    s_cmp_ge_u32 s58, 12
    s_cselect_b32 s58, s38, s58
    s_mul_i32 s58, s58, 131072
    s_add_u32 s58, s58, s53
    buffer_load_dwordx4 v[164:167], v4, s[32:35], s58 offen sc1
    buffer_load_dwordx4 v[168:171], v5, s[32:35], s58 offen sc1
    buffer_load_dwordx4 v[172:175], v6, s[32:35], s58 offen sc1
    buffer_load_dwordx4 v[176:179], v7, s[32:35], s58 offen sc1
    s_add_u32 s58, s37, 11
    s_sub_u32 s38, s58, 12
    s_cmp_ge_u32 s58, 12
    s_cselect_b32 s58, s38, s58
    s_mul_i32 s58, s58, 131072
    s_add_u32 s58, s58, s53
    buffer_load_dwordx4 v[180:183], v4, s[32:35], s58 offen sc1
    buffer_load_dwordx4 v[184:187], v5, s[32:35], s58 offen sc1
    buffer_load_dwordx4 v[188:191], v6, s[32:35], s58 offen sc1
    buffer_load_dwordx4 v[192:195], v7, s[32:35], s58 offen sc1
    s_waitcnt vmcnt(0)
    v_max3_u32 v14, v228, v229, v230
    v_max3_u32 v14, v14, v231, v232
    v_max3_u32 v14, v14, v233, v234
    v_max3_u32 v14, v14, v235, v236
    v_max3_u32 v14, v14, v237, v238
    v_max3_u32 v14, v14, v239, v240
    v_max3_u32 v14, v14, v241, v242
    v_max_u32 v14, v14, v243
    v_cmp_eq_u32 vcc, -1, v14
    s_nop 3
    s_cbranch_vccnz RETRY_213
    s_branch BACK_212
SLOW_214:
    s_nop 15
RETRY_216:
    s_cmp_eq_u32 s57, 0
    s_cbranch_scc1 BACK_215
    s_sub_u32 s57, s57, 1
    s_sleep 2
    s_add_u32 s58, s37, 10
    s_sub_u32 s38, s58, 12
    s_cmp_ge_u32 s58, 12
    s_cselect_b32 s58, s38, s58
    s_mul_i32 s58, s58, 131072
    s_add_u32 s58, s58, s53
    buffer_load_dwordx4 v[164:167], v4, s[32:35], s58 offen sc1
    buffer_load_dwordx4 v[168:171], v5, s[32:35], s58 offen sc1
    buffer_load_dwordx4 v[172:175], v6, s[32:35], s58 offen sc1
    buffer_load_dwordx4 v[176:179], v7, s[32:35], s58 offen sc1
    s_add_u32 s58, s37, 11
    s_sub_u32 s38, s58, 12
    s_cmp_ge_u32 s58, 12
    s_cselect_b32 s58, s38, s58
    s_mul_i32 s58, s58, 131072
    s_add_u32 s58, s58, s53
    buffer_load_dwordx4 v[180:183], v4, s[32:35], s58 offen sc1
    buffer_load_dwordx4 v[184:187], v5, s[32:35], s58 offen sc1
    buffer_load_dwordx4 v[188:191], v6, s[32:35], s58 offen sc1
    buffer_load_dwordx4 v[192:195], v7, s[32:35], s58 offen sc1
    s_waitcnt vmcnt(0)
    v_max3_u32 v14, v164, v165, v166
    v_max3_u32 v14, v14, v167, v168
    v_max3_u32 v14, v14, v169, v170
    v_max3_u32 v14, v14, v171, v172
    v_max3_u32 v14, v14, v173, v174
    v_max3_u32 v14, v14, v175, v176
    v_max3_u32 v14, v14, v177, v178
    v_max_u32 v14, v14, v179
    v_cmp_eq_u32 vcc, -1, v14
    s_nop 3
    s_cbranch_vccnz RETRY_216
    s_branch BACK_215
SLOW_217:
    s_nop 15
RETRY_219:
    s_cmp_eq_u32 s57, 0
    s_cbranch_scc1 BACK_218
    s_sub_u32 s57, s57, 1
    s_sleep 2
    s_add_u32 s58, s37, 11
    s_sub_u32 s38, s58, 12
    s_cmp_ge_u32 s58, 12
    s_cselect_b32 s58, s38, s58
    s_mul_i32 s58, s58, 131072
    s_add_u32 s58, s58, s53
    buffer_load_dwordx4 v[180:183], v4, s[32:35], s58 offen sc1
    buffer_load_dwordx4 v[184:187], v5, s[32:35], s58 offen sc1
    buffer_load_dwordx4 v[188:191], v6, s[32:35], s58 offen sc1
    buffer_load_dwordx4 v[192:195], v7, s[32:35], s58 offen sc1
    s_waitcnt vmcnt(0)
    v_max3_u32 v14, v180, v181, v182
    v_max3_u32 v14, v14, v183, v184
    v_max3_u32 v14, v14, v185, v186
    v_max3_u32 v14, v14, v187, v188
    v_max3_u32 v14, v14, v189, v190
    v_max3_u32 v14, v14, v191, v192
    v_max3_u32 v14, v14, v193, v194
    v_max_u32 v14, v14, v195
    v_cmp_eq_u32 vcc, -1, v14
    s_nop 3
    s_cbranch_vccnz RETRY_219
    s_branch BACK_218
SLOW_220:
    s_nop 15
RETRY_222:
    s_cmp_eq_u32 s57, 0
    s_cbranch_scc1 BACK_221
    s_sub_u32 s57, s57, 1
    s_sleep 8
    s_add_u32 s58, s51, 0
    buffer_load_dword v24, v19, s[32:35], s58 offen sc1
    s_add_u32 s58, s51, 12288
    buffer_load_dword v25, v19, s[32:35], s58 offen sc1
    s_add_u32 s58, s51, 24576
    buffer_load_dword v26, v19, s[32:35], s58 offen sc1
    s_add_u32 s58, s51, 36864
    buffer_load_dword v27, v19, s[32:35], s58 offen sc1
    s_add_u32 s58, s51, 49152
    buffer_load_dword v28, v19, s[32:35], s58 offen sc1
    s_add_u32 s58, s51, 61440
    buffer_load_dword v29, v19, s[32:35], s58 offen sc1
    s_add_u32 s58, s51, 73728
    buffer_load_dword v30, v19, s[32:35], s58 offen sc1
    s_add_u32 s58, s51, 86016
    buffer_load_dword v31, v19, s[32:35], s58 offen sc1
    s_add_u32 s58, s51, 98304
    buffer_load_dword v32, v19, s[32:35], s58 offen sc1
    s_add_u32 s58, s51, 110592
    buffer_load_dword v33, v19, s[32:35], s58 offen sc1
    s_waitcnt vmcnt(0)
    v_max3_u32 v11, v24, v25, v26
    v_max3_u32 v11, v11, v27, v28
    v_max3_u32 v11, v11, v29, v30
    v_max3_u32 v11, v11, v31, v32
    v_max_u32 v11, v11, v33
    v_cmp_eq_u32 vcc, -1, v11
    s_nop 3
    s_cbranch_vccnz RETRY_222
    s_branch BACK_221
CODE_END:
.section .rodata,"a"
.p2align 6
.amdhsa_kernel sequential_preLN__sliding_block__glu_gated_geglu__prompt_kernel
  .amdhsa_next_free_vgpr 256
  .amdhsa_next_free_sgpr 102
  .amdhsa_accum_offset 256
  .amdhsa_group_segment_fixed_size 0
  .amdhsa_kernarg_size 80
  .amdhsa_user_sgpr_count 2
  .amdhsa_user_sgpr_kernarg_segment_ptr 1
  .amdhsa_system_sgpr_workgroup_id_x 1
.end_amdhsa_kernel
```
